```python
import torch

def _softmax(x, axis=-1):
    return torch.softmax(x, dim=axis)
def _gelu(x):
    return torch.nn.functional.gelu(x, approximate="tanh")
def _silu(x):
    return torch.nn.functional.silu(x)
def _sigmoid(x):
    return torch.sigmoid(x)
def _layernorm(x, axis=-1, eps=1e-5):
    m = x.mean(dim=axis, keepdim=True)
    v = x.var(dim=axis, keepdim=True, unbiased=False)
    return (x - m) / torch.sqrt(v + eps)
def _scatter_add(tgt, idx, src, axis=0):
    return tgt.clone().index_add_(axis, idx, src)
def _segment_sum(src, seg, n):
    out = torch.zeros((n,) + src.shape[1:], dtype=src.dtype)
    return out.index_add_(0, seg, src)
def _pad(x, pw):
    flat = tuple(v for pair in reversed(pw) for v in pair)
    return torch.nn.functional.pad(x, flat)

kernel_name = 'standalone__mha_block_cached__near_ridge'

def setup_inputs():

    _w = (lambda a: (lambda t: t.to(torch.bfloat16) if t.is_floating_point() else t)(torch.as_tensor(a)))
    B, Sq, D = 16, 96, 640
    H, Sk, Dh = 32, 512, 128
    return {
        "x": _w((lambda *s: torch.randn(*s, dtype=torch.bfloat16) * 0.8)(B, Sq, D)),
        "k_cache": _w((lambda *s: torch.randn(*s, dtype=torch.bfloat16) * 0.8)(B, H, Sk, Dh)),
        "v_cache": _w((lambda *s: torch.randn(*s, dtype=torch.bfloat16) * 0.05)(B, H, Sk, Dh)),
        "wq": _w((lambda *s: torch.randn(*s, dtype=torch.bfloat16) * 0.8)(D, H * Dh) * (D ** -0.5)),
        "wo": _w((lambda *s: torch.randn(*s, dtype=torch.bfloat16) * 0.05)(H * Dh, D) * ((H * Dh) ** -0.5)),
    }

def reference(x, k_cache, v_cache, wq, wo):
    B, Sq, D = x.shape
    H, Dh = 32, 128
    q = (lambda x, *d: x.permute(*d))((x @ wq).reshape(B, Sq, H, Dh), 0, 2, 1, 3)
    scores = torch.einsum("bhqd,bhkd->bhqk", q, k_cache) * (Dh ** -0.5)
    p = _softmax(scores, axis=-1)
    o = torch.einsum("bhqk,bhkd->bhqd", p, v_cache)
    return (lambda x, *d: x.permute(*d))(o, 0, 2, 1, 3).reshape(B, Sq, H * Dh) @ wo
```

```asm
; @launch grid=(256,1,1) block=(512,1,1) lds=163840
.amdgcn_target "amdgcn-amd-amdhsa--gfx950"
.text
.globl standalone__mha_block_cached__near_ridge_kernel
.p2align 8
.type standalone__mha_block_cached__near_ridge_kernel,@function
standalone__mha_block_cached__near_ridge_kernel:
    s_cmp_ge_u32 s2, 256
    s_cbranch_scc1 LA_end
    s_load_dwordx16 s[16:31], s[0:1], 0
    v_lshrrev_b32 v1, 6, v0
    v_and_b32 v0, 63, v0
    v_readfirstlane_b32 s3, v1
    v_lshlrev_b32 v2, 2, v0
    v_add_u32 v2, 163584, v2
    v_mov_b32 v3, 0
    ds_write_b32 v2, v3
    s_and_b32 s4, s2, 7
    s_lshr_b32 s5, s2, 3
    s_and_b32 s6, s4, 1
    s_lshl_b32 s6, s6, 3
    s_and_b32 s7, s5, 7
    s_add_u32 s6, s6, s7
    s_lshr_b32 s7, s4, 1
    s_lshl_b32 s7, s7, 2
    s_lshr_b32 s8, s5, 3
    s_add_u32 s7, s7, s8
    s_add_u32 s12, s7, s6
    s_lshl_b32 s7, s7, 1
    s_and_b32 s8, s3, 3
    s_lshr_b32 s9, s3, 2
    s_mul_i32 s12, s12, 0
    s_mul_i32 s13, s12, 52
    s_lshr_b32 s13, s13, 8
    s_mul_i32 s13, s13, 5
    s_sub_u32 s97, s12, s13
    s_add_u32 s98, s97, 1
    s_cmp_eq_u32 s98, 5
    s_cselect_b32 s98, 0, s98
    s_add_u32 s99, s98, 1
    s_cmp_eq_u32 s99, 5
    s_cselect_b32 s99, 0, s99
    s_add_u32 s100, s99, 1
    s_cmp_eq_u32 s100, 5
    s_cselect_b32 s100, 0, s100
    s_add_u32 s101, s100, 1
    s_cmp_eq_u32 s101, 5
    s_cselect_b32 s101, 0, s101
    s_waitcnt lgkmcnt(0)
    s_mov_b32 s48, s30
    s_and_b32 s49, s31, 0xffff
    s_mov_b32 s50, 41975808
    s_mov_b32 s51, 0x20000
    s_mov_b32 s88, s28
    s_and_b32 s89, s29, 0xffff
    s_mov_b32 s90, 256
    s_mov_b32 s91, 0x20000
    s_lshr_b32 s96, s7, 1
    s_add_u32 s96, s96, s6
    s_and_b32 s96, s96, 1
    s_and_b32 s95, s6, 1
    s_lshr_b32 s92, s4, 1
    s_lshr_b32 s93, s5, 3
    s_cmp_lt_u32 s8, 3
    s_cbranch_scc1 LA_comp
    v_lshrrev_b32 v1, 4, v0
    v_and_b32 v2, 15, v0
    v_mov_b32 v30, 0
    s_cmp_eq_u32 s9, 0
    s_nop 0
    s_cbranch_scc1 LA_kv
    s_mov_b32 s44, s22
    s_and_b32 s45, s23, 0xffff
    s_mov_b32 s46, 5242880
    s_mov_b32 s47, 0x20000
    s_lshl_b32 s14, s7, 8
    v_lshlrev_b32 v3, 2, v1
    v_xor_b32 v2, v2, v3
    v_lshlrev_b32 v2, 4, v2
    v_lshl_add_u32 v9, v1, 13, v2
    v_add_u32 v10, 31744, v9
    v_add_u32 v11, 63488, v9
    v_add_u32 v12, 95232, v9
    s_setprio 3
    v_mov_b32 v29, 163584
    s_lshl_b32 s15, s97, 20
    s_add_u32 s15, s15, s14
    s_xor_b32 s13, s95, 0
    s_lshl_b32 s13, s13, 8
    s_add_u32 s15, s15, s13
    s_mov_b32 m0, 98304
    s_add_u32 s13, s15, 0
    buffer_load_dwordx4 v9, s[44:47], s13 offen offset:0 lds
    buffer_load_dwordx4 v10, s[44:47], s13 offen offset:1024 lds
    buffer_load_dwordx4 v11, s[44:47], s13 offen offset:2048 lds
    buffer_load_dwordx4 v12, s[44:47], s13 offen offset:3072 lds
    s_mov_b32 m0, 102400
    s_add_u32 s13, s15, 131072
    buffer_load_dwordx4 v9, s[44:47], s13 offen offset:0 lds
    buffer_load_dwordx4 v10, s[44:47], s13 offen offset:1024 lds
    buffer_load_dwordx4 v11, s[44:47], s13 offen offset:2048 lds
    buffer_load_dwordx4 v12, s[44:47], s13 offen offset:3072 lds
    s_mov_b32 m0, 106496
    s_add_u32 s13, s15, 262144
    buffer_load_dwordx4 v9, s[44:47], s13 offen offset:0 lds
    buffer_load_dwordx4 v10, s[44:47], s13 offen offset:1024 lds
    buffer_load_dwordx4 v11, s[44:47], s13 offen offset:2048 lds
    buffer_load_dwordx4 v12, s[44:47], s13 offen offset:3072 lds
    s_mov_b32 m0, 110592
    s_add_u32 s13, s15, 393216
    buffer_load_dwordx4 v9, s[44:47], s13 offen offset:0 lds
    buffer_load_dwordx4 v10, s[44:47], s13 offen offset:1024 lds
    buffer_load_dwordx4 v11, s[44:47], s13 offen offset:2048 lds
    buffer_load_dwordx4 v12, s[44:47], s13 offen offset:3072 lds
    s_barrier
    s_lshl_b32 s15, s97, 20
    s_add_u32 s15, s15, s14
    s_xor_b32 s13, s95, 0
    s_lshl_b32 s13, s13, 8
    s_add_u32 s15, s15, s13
    s_mov_b32 m0, 114688
    s_add_u32 s13, s15, 524288
    buffer_load_dwordx4 v9, s[44:47], s13 offen offset:0 lds
    buffer_load_dwordx4 v10, s[44:47], s13 offen offset:1024 lds
    buffer_load_dwordx4 v11, s[44:47], s13 offen offset:2048 lds
    buffer_load_dwordx4 v12, s[44:47], s13 offen offset:3072 lds
    s_mov_b32 m0, 118784
    s_add_u32 s13, s15, 655360
    buffer_load_dwordx4 v9, s[44:47], s13 offen offset:0 lds
    buffer_load_dwordx4 v10, s[44:47], s13 offen offset:1024 lds
    buffer_load_dwordx4 v11, s[44:47], s13 offen offset:2048 lds
    buffer_load_dwordx4 v12, s[44:47], s13 offen offset:3072 lds
    s_mov_b32 m0, 122880
    s_add_u32 s13, s15, 786432
    buffer_load_dwordx4 v9, s[44:47], s13 offen offset:0 lds
    buffer_load_dwordx4 v10, s[44:47], s13 offen offset:1024 lds
    buffer_load_dwordx4 v11, s[44:47], s13 offen offset:2048 lds
    buffer_load_dwordx4 v12, s[44:47], s13 offen offset:3072 lds
    s_mov_b32 m0, 126976
    s_add_u32 s13, s15, 917504
    buffer_load_dwordx4 v9, s[44:47], s13 offen offset:0 lds
    buffer_load_dwordx4 v10, s[44:47], s13 offen offset:1024 lds
    buffer_load_dwordx4 v11, s[44:47], s13 offen offset:2048 lds
    buffer_load_dwordx4 v12, s[44:47], s13 offen offset:3072 lds
    s_waitcnt vmcnt(16)
    v_mov_b32 v31, 1
    ds_write_b32 v29, v31 offset:4
    s_lshl_b32 s15, s98, 20
    s_add_u32 s15, s15, s14
    s_xor_b32 s13, s95, 0
    s_lshl_b32 s13, s13, 8
    s_add_u32 s15, s15, s13
    s_mov_b32 m0, 131072
    s_add_u32 s13, s15, 0
    buffer_load_dwordx4 v9, s[44:47], s13 offen offset:0 lds
    buffer_load_dwordx4 v10, s[44:47], s13 offen offset:1024 lds
    buffer_load_dwordx4 v11, s[44:47], s13 offen offset:2048 lds
    buffer_load_dwordx4 v12, s[44:47], s13 offen offset:3072 lds
    s_mov_b32 m0, 135168
    s_add_u32 s13, s15, 131072
    buffer_load_dwordx4 v9, s[44:47], s13 offen offset:0 lds
    buffer_load_dwordx4 v10, s[44:47], s13 offen offset:1024 lds
    buffer_load_dwordx4 v11, s[44:47], s13 offen offset:2048 lds
    buffer_load_dwordx4 v12, s[44:47], s13 offen offset:3072 lds
    s_mov_b32 m0, 139264
    s_add_u32 s13, s15, 262144
    buffer_load_dwordx4 v9, s[44:47], s13 offen offset:0 lds
    buffer_load_dwordx4 v10, s[44:47], s13 offen offset:1024 lds
    buffer_load_dwordx4 v11, s[44:47], s13 offen offset:2048 lds
    buffer_load_dwordx4 v12, s[44:47], s13 offen offset:3072 lds
    s_mov_b32 m0, 143360
    s_add_u32 s13, s15, 393216
    buffer_load_dwordx4 v9, s[44:47], s13 offen offset:0 lds
    buffer_load_dwordx4 v10, s[44:47], s13 offen offset:1024 lds
    buffer_load_dwordx4 v11, s[44:47], s13 offen offset:2048 lds
    buffer_load_dwordx4 v12, s[44:47], s13 offen offset:3072 lds
    s_waitcnt vmcnt(16)
    v_mov_b32 v31, 2
    ds_write_b32 v29, v31 offset:4
    s_lshl_b32 s15, s98, 20
    s_add_u32 s15, s15, s14
    s_xor_b32 s13, s95, 0
    s_lshl_b32 s13, s13, 8
    s_add_u32 s15, s15, s13
    s_mov_b32 m0, 0
    s_add_u32 s13, s15, 524288
    buffer_load_dwordx4 v9, s[44:47], s13 offen offset:0 lds
    buffer_load_dwordx4 v10, s[44:47], s13 offen offset:1024 lds
    buffer_load_dwordx4 v11, s[44:47], s13 offen offset:2048 lds
    buffer_load_dwordx4 v12, s[44:47], s13 offen offset:3072 lds
    s_mov_b32 m0, 4096
    s_add_u32 s13, s15, 655360
    buffer_load_dwordx4 v9, s[44:47], s13 offen offset:0 lds
    buffer_load_dwordx4 v10, s[44:47], s13 offen offset:1024 lds
    buffer_load_dwordx4 v11, s[44:47], s13 offen offset:2048 lds
    buffer_load_dwordx4 v12, s[44:47], s13 offen offset:3072 lds
    s_mov_b32 m0, 8192
    s_add_u32 s13, s15, 786432
    buffer_load_dwordx4 v9, s[44:47], s13 offen offset:0 lds
    buffer_load_dwordx4 v10, s[44:47], s13 offen offset:1024 lds
    buffer_load_dwordx4 v11, s[44:47], s13 offen offset:2048 lds
    buffer_load_dwordx4 v12, s[44:47], s13 offen offset:3072 lds
    s_mov_b32 m0, 12288
    s_add_u32 s13, s15, 917504
    buffer_load_dwordx4 v9, s[44:47], s13 offen offset:0 lds
    buffer_load_dwordx4 v10, s[44:47], s13 offen offset:1024 lds
    buffer_load_dwordx4 v11, s[44:47], s13 offen offset:2048 lds
    buffer_load_dwordx4 v12, s[44:47], s13 offen offset:3072 lds
    s_waitcnt vmcnt(16)
    v_mov_b32 v31, 3
    ds_write_b32 v29, v31 offset:4
    s_nop 0
LP1:
    ds_read_b96 v[4:6], v29 offset:48
    s_waitcnt lgkmcnt(0)
    v_min3_u32 v4, v4, v5, v6
    s_nop 0
    v_readfirstlane_b32 s12, v4
    s_nop 0
    s_cmp_ge_u32 s12, 1
    s_nop 2
    s_cbranch_scc1 LP1_ok
    s_sleep 1
    s_branch LP1
LP1_ok:
    s_lshl_b32 s15, s99, 20
    s_add_u32 s15, s15, s14
    s_xor_b32 s13, s95, 0
    s_lshl_b32 s13, s13, 8
    s_add_u32 s15, s15, s13
    s_mov_b32 m0, 98304
    s_add_u32 s13, s15, 0
    buffer_load_dwordx4 v9, s[44:47], s13 offen offset:0 lds
    buffer_load_dwordx4 v10, s[44:47], s13 offen offset:1024 lds
    buffer_load_dwordx4 v11, s[44:47], s13 offen offset:2048 lds
    buffer_load_dwordx4 v12, s[44:47], s13 offen offset:3072 lds
    s_mov_b32 m0, 102400
    s_add_u32 s13, s15, 131072
    buffer_load_dwordx4 v9, s[44:47], s13 offen offset:0 lds
    buffer_load_dwordx4 v10, s[44:47], s13 offen offset:1024 lds
    buffer_load_dwordx4 v11, s[44:47], s13 offen offset:2048 lds
    buffer_load_dwordx4 v12, s[44:47], s13 offen offset:3072 lds
    s_mov_b32 m0, 106496
    s_add_u32 s13, s15, 262144
    buffer_load_dwordx4 v9, s[44:47], s13 offen offset:0 lds
    buffer_load_dwordx4 v10, s[44:47], s13 offen offset:1024 lds
    buffer_load_dwordx4 v11, s[44:47], s13 offen offset:2048 lds
    buffer_load_dwordx4 v12, s[44:47], s13 offen offset:3072 lds
    s_mov_b32 m0, 110592
    s_add_u32 s13, s15, 393216
    buffer_load_dwordx4 v9, s[44:47], s13 offen offset:0 lds
    buffer_load_dwordx4 v10, s[44:47], s13 offen offset:1024 lds
    buffer_load_dwordx4 v11, s[44:47], s13 offen offset:2048 lds
    buffer_load_dwordx4 v12, s[44:47], s13 offen offset:3072 lds
    s_waitcnt vmcnt(16)
    v_mov_b32 v31, 4
    ds_write_b32 v29, v31 offset:4
    s_nop 0
LP2:
    ds_read_b96 v[4:6], v29 offset:48
    s_waitcnt lgkmcnt(0)
    v_min3_u32 v4, v4, v5, v6
    s_nop 0
    v_readfirstlane_b32 s12, v4
    s_nop 0
    s_cmp_ge_u32 s12, 2
    s_nop 2
    s_cbranch_scc1 LP2_ok
    s_sleep 1
    s_branch LP2
LP2_ok:
    s_lshl_b32 s15, s99, 20
    s_add_u32 s15, s15, s14
    s_xor_b32 s13, s95, 0
    s_lshl_b32 s13, s13, 8
    s_add_u32 s15, s15, s13
    s_mov_b32 m0, 114688
    s_add_u32 s13, s15, 524288
    buffer_load_dwordx4 v9, s[44:47], s13 offen offset:0 lds
    buffer_load_dwordx4 v10, s[44:47], s13 offen offset:1024 lds
    buffer_load_dwordx4 v11, s[44:47], s13 offen offset:2048 lds
    buffer_load_dwordx4 v12, s[44:47], s13 offen offset:3072 lds
    s_mov_b32 m0, 118784
    s_add_u32 s13, s15, 655360
    buffer_load_dwordx4 v9, s[44:47], s13 offen offset:0 lds
    buffer_load_dwordx4 v10, s[44:47], s13 offen offset:1024 lds
    buffer_load_dwordx4 v11, s[44:47], s13 offen offset:2048 lds
    buffer_load_dwordx4 v12, s[44:47], s13 offen offset:3072 lds
    s_mov_b32 m0, 122880
    s_add_u32 s13, s15, 786432
    buffer_load_dwordx4 v9, s[44:47], s13 offen offset:0 lds
    buffer_load_dwordx4 v10, s[44:47], s13 offen offset:1024 lds
    buffer_load_dwordx4 v11, s[44:47], s13 offen offset:2048 lds
    buffer_load_dwordx4 v12, s[44:47], s13 offen offset:3072 lds
    s_mov_b32 m0, 126976
    s_add_u32 s13, s15, 917504
    buffer_load_dwordx4 v9, s[44:47], s13 offen offset:0 lds
    buffer_load_dwordx4 v10, s[44:47], s13 offen offset:1024 lds
    buffer_load_dwordx4 v11, s[44:47], s13 offen offset:2048 lds
    buffer_load_dwordx4 v12, s[44:47], s13 offen offset:3072 lds
    v_mov_b32 v31, 1
    ds_write_b32 v29, v31 offset:8
    s_waitcnt vmcnt(16)
    v_mov_b32 v31, 5
    ds_write_b32 v29, v31 offset:4
    s_nop 0
LP3:
    ds_read_b96 v[4:6], v29 offset:48
    s_waitcnt lgkmcnt(0)
    v_min3_u32 v4, v4, v5, v6
    s_nop 0
    v_readfirstlane_b32 s12, v4
    s_nop 0
    s_cmp_ge_u32 s12, 3
    s_nop 2
    s_cbranch_scc1 LP3_ok
    s_sleep 1
    s_branch LP3
LP3_ok:
    s_lshl_b32 s15, s100, 20
    s_add_u32 s15, s15, s14
    s_xor_b32 s13, s95, 0
    s_lshl_b32 s13, s13, 8
    s_add_u32 s15, s15, s13
    s_mov_b32 m0, 131072
    s_add_u32 s13, s15, 0
    buffer_load_dwordx4 v9, s[44:47], s13 offen offset:0 lds
    buffer_load_dwordx4 v10, s[44:47], s13 offen offset:1024 lds
    buffer_load_dwordx4 v11, s[44:47], s13 offen offset:2048 lds
    buffer_load_dwordx4 v12, s[44:47], s13 offen offset:3072 lds
    s_mov_b32 m0, 135168
    s_add_u32 s13, s15, 131072
    buffer_load_dwordx4 v9, s[44:47], s13 offen offset:0 lds
    buffer_load_dwordx4 v10, s[44:47], s13 offen offset:1024 lds
    buffer_load_dwordx4 v11, s[44:47], s13 offen offset:2048 lds
    buffer_load_dwordx4 v12, s[44:47], s13 offen offset:3072 lds
    s_mov_b32 m0, 139264
    s_add_u32 s13, s15, 262144
    buffer_load_dwordx4 v9, s[44:47], s13 offen offset:0 lds
    buffer_load_dwordx4 v10, s[44:47], s13 offen offset:1024 lds
    buffer_load_dwordx4 v11, s[44:47], s13 offen offset:2048 lds
    buffer_load_dwordx4 v12, s[44:47], s13 offen offset:3072 lds
    s_mov_b32 m0, 143360
    s_add_u32 s13, s15, 393216
    buffer_load_dwordx4 v9, s[44:47], s13 offen offset:0 lds
    buffer_load_dwordx4 v10, s[44:47], s13 offen offset:1024 lds
    buffer_load_dwordx4 v11, s[44:47], s13 offen offset:2048 lds
    buffer_load_dwordx4 v12, s[44:47], s13 offen offset:3072 lds
    s_waitcnt vmcnt(16)
    v_mov_b32 v31, 6
    ds_write_b32 v29, v31 offset:4
    s_nop 0
LP4:
    ds_read_b96 v[4:6], v29 offset:48
    s_waitcnt lgkmcnt(0)
    v_min3_u32 v4, v4, v5, v6
    s_nop 0
    v_readfirstlane_b32 s12, v4
    s_nop 0
    s_cmp_ge_u32 s12, 4
    s_nop 2
    s_cbranch_scc1 LP4_ok
    s_sleep 1
    s_branch LP4
LP4_ok:
    s_lshl_b32 s15, s100, 20
    s_add_u32 s15, s15, s14
    s_xor_b32 s13, s95, 0
    s_lshl_b32 s13, s13, 8
    s_add_u32 s15, s15, s13
    s_mov_b32 m0, 0
    s_add_u32 s13, s15, 524288
    buffer_load_dwordx4 v9, s[44:47], s13 offen offset:0 lds
    buffer_load_dwordx4 v10, s[44:47], s13 offen offset:1024 lds
    buffer_load_dwordx4 v11, s[44:47], s13 offen offset:2048 lds
    buffer_load_dwordx4 v12, s[44:47], s13 offen offset:3072 lds
    s_mov_b32 m0, 4096
    s_add_u32 s13, s15, 655360
    buffer_load_dwordx4 v9, s[44:47], s13 offen offset:0 lds
    buffer_load_dwordx4 v10, s[44:47], s13 offen offset:1024 lds
    buffer_load_dwordx4 v11, s[44:47], s13 offen offset:2048 lds
    buffer_load_dwordx4 v12, s[44:47], s13 offen offset:3072 lds
    s_mov_b32 m0, 8192
    s_add_u32 s13, s15, 786432
    buffer_load_dwordx4 v9, s[44:47], s13 offen offset:0 lds
    buffer_load_dwordx4 v10, s[44:47], s13 offen offset:1024 lds
    buffer_load_dwordx4 v11, s[44:47], s13 offen offset:2048 lds
    buffer_load_dwordx4 v12, s[44:47], s13 offen offset:3072 lds
    s_mov_b32 m0, 12288
    s_add_u32 s13, s15, 917504
    buffer_load_dwordx4 v9, s[44:47], s13 offen offset:0 lds
    buffer_load_dwordx4 v10, s[44:47], s13 offen offset:1024 lds
    buffer_load_dwordx4 v11, s[44:47], s13 offen offset:2048 lds
    buffer_load_dwordx4 v12, s[44:47], s13 offen offset:3072 lds
    s_waitcnt vmcnt(16)
    v_mov_b32 v31, 7
    ds_write_b32 v29, v31 offset:4
    s_nop 0
LP5:
    ds_read_b96 v[4:6], v29 offset:48
    s_waitcnt lgkmcnt(0)
    v_min3_u32 v4, v4, v5, v6
    s_nop 0
    v_readfirstlane_b32 s12, v4
    s_nop 0
    s_cmp_ge_u32 s12, 5
    s_nop 2
    s_cbranch_scc1 LP5_ok
    s_sleep 1
    s_branch LP5
LP5_ok:
    s_lshl_b32 s15, s101, 20
    s_add_u32 s15, s15, s14
    s_xor_b32 s13, s95, 0
    s_lshl_b32 s13, s13, 8
    s_add_u32 s15, s15, s13
    s_mov_b32 m0, 98304
    s_add_u32 s13, s15, 0
    buffer_load_dwordx4 v9, s[44:47], s13 offen offset:0 lds
    buffer_load_dwordx4 v10, s[44:47], s13 offen offset:1024 lds
    buffer_load_dwordx4 v11, s[44:47], s13 offen offset:2048 lds
    buffer_load_dwordx4 v12, s[44:47], s13 offen offset:3072 lds
    s_mov_b32 m0, 102400
    s_add_u32 s13, s15, 131072
    buffer_load_dwordx4 v9, s[44:47], s13 offen offset:0 lds
    buffer_load_dwordx4 v10, s[44:47], s13 offen offset:1024 lds
    buffer_load_dwordx4 v11, s[44:47], s13 offen offset:2048 lds
    buffer_load_dwordx4 v12, s[44:47], s13 offen offset:3072 lds
    s_mov_b32 m0, 106496
    s_add_u32 s13, s15, 262144
    buffer_load_dwordx4 v9, s[44:47], s13 offen offset:0 lds
    buffer_load_dwordx4 v10, s[44:47], s13 offen offset:1024 lds
    buffer_load_dwordx4 v11, s[44:47], s13 offen offset:2048 lds
    buffer_load_dwordx4 v12, s[44:47], s13 offen offset:3072 lds
    s_mov_b32 m0, 110592
    s_add_u32 s13, s15, 393216
    buffer_load_dwordx4 v9, s[44:47], s13 offen offset:0 lds
    buffer_load_dwordx4 v10, s[44:47], s13 offen offset:1024 lds
    buffer_load_dwordx4 v11, s[44:47], s13 offen offset:2048 lds
    buffer_load_dwordx4 v12, s[44:47], s13 offen offset:3072 lds
    s_waitcnt vmcnt(16)
    v_mov_b32 v31, 8
    ds_write_b32 v29, v31 offset:4
    s_nop 0
LP6:
    ds_read_b96 v[4:6], v29 offset:48
    s_waitcnt lgkmcnt(0)
    v_min3_u32 v4, v4, v5, v6
    s_nop 0
    v_readfirstlane_b32 s12, v4
    s_nop 0
    s_cmp_ge_u32 s12, 6
    s_nop 2
    s_cbranch_scc1 LP6_ok
    s_sleep 1
    s_branch LP6
LP6_ok:
    s_lshl_b32 s15, s101, 20
    s_add_u32 s15, s15, s14
    s_xor_b32 s13, s95, 0
    s_lshl_b32 s13, s13, 8
    s_add_u32 s15, s15, s13
    s_mov_b32 m0, 114688
    s_add_u32 s13, s15, 524288
    buffer_load_dwordx4 v9, s[44:47], s13 offen offset:0 lds
    buffer_load_dwordx4 v10, s[44:47], s13 offen offset:1024 lds
    buffer_load_dwordx4 v11, s[44:47], s13 offen offset:2048 lds
    buffer_load_dwordx4 v12, s[44:47], s13 offen offset:3072 lds
    s_mov_b32 m0, 118784
    s_add_u32 s13, s15, 655360
    buffer_load_dwordx4 v9, s[44:47], s13 offen offset:0 lds
    buffer_load_dwordx4 v10, s[44:47], s13 offen offset:1024 lds
    buffer_load_dwordx4 v11, s[44:47], s13 offen offset:2048 lds
    buffer_load_dwordx4 v12, s[44:47], s13 offen offset:3072 lds
    s_mov_b32 m0, 122880
    s_add_u32 s13, s15, 786432
    buffer_load_dwordx4 v9, s[44:47], s13 offen offset:0 lds
    buffer_load_dwordx4 v10, s[44:47], s13 offen offset:1024 lds
    buffer_load_dwordx4 v11, s[44:47], s13 offen offset:2048 lds
    buffer_load_dwordx4 v12, s[44:47], s13 offen offset:3072 lds
    s_mov_b32 m0, 126976
    s_add_u32 s13, s15, 917504
    buffer_load_dwordx4 v9, s[44:47], s13 offen offset:0 lds
    buffer_load_dwordx4 v10, s[44:47], s13 offen offset:1024 lds
    buffer_load_dwordx4 v11, s[44:47], s13 offen offset:2048 lds
    buffer_load_dwordx4 v12, s[44:47], s13 offen offset:3072 lds
    s_waitcnt vmcnt(16)
    v_mov_b32 v31, 9
    ds_write_b32 v29, v31 offset:4
    s_waitcnt vmcnt(0)
    v_mov_b32 v31, 10
    ds_write_b32 v29, v31 offset:4
    s_nop 0
LP7:
    ds_read_b96 v[4:6], v29 offset:48
    s_waitcnt lgkmcnt(0)
    v_min3_u32 v4, v4, v5, v6
    s_nop 0
    v_readfirstlane_b32 s12, v4
    s_nop 0
    s_cmp_ge_u32 s12, 7
    s_nop 2
    s_cbranch_scc1 LP7_ok
    s_sleep 1
    s_branch LP7
LP7_ok:
    s_lshl_b32 s15, s97, 20
    s_add_u32 s15, s15, s14
    s_xor_b32 s13, s95, 1
    s_lshl_b32 s13, s13, 8
    s_add_u32 s15, s15, s13
    s_mov_b32 m0, 131072
    s_add_u32 s13, s15, 0
    buffer_load_dwordx4 v9, s[44:47], s13 offen offset:0 lds
    buffer_load_dwordx4 v10, s[44:47], s13 offen offset:1024 lds
    buffer_load_dwordx4 v11, s[44:47], s13 offen offset:2048 lds
    buffer_load_dwordx4 v12, s[44:47], s13 offen offset:3072 lds
    s_mov_b32 m0, 135168
    s_add_u32 s13, s15, 131072
    buffer_load_dwordx4 v9, s[44:47], s13 offen offset:0 lds
    buffer_load_dwordx4 v10, s[44:47], s13 offen offset:1024 lds
    buffer_load_dwordx4 v11, s[44:47], s13 offen offset:2048 lds
    buffer_load_dwordx4 v12, s[44:47], s13 offen offset:3072 lds
    s_mov_b32 m0, 139264
    s_add_u32 s13, s15, 262144
    buffer_load_dwordx4 v9, s[44:47], s13 offen offset:0 lds
    buffer_load_dwordx4 v10, s[44:47], s13 offen offset:1024 lds
    buffer_load_dwordx4 v11, s[44:47], s13 offen offset:2048 lds
    buffer_load_dwordx4 v12, s[44:47], s13 offen offset:3072 lds
    s_mov_b32 m0, 143360
    s_add_u32 s13, s15, 393216
    buffer_load_dwordx4 v9, s[44:47], s13 offen offset:0 lds
    buffer_load_dwordx4 v10, s[44:47], s13 offen offset:1024 lds
    buffer_load_dwordx4 v11, s[44:47], s13 offen offset:2048 lds
    buffer_load_dwordx4 v12, s[44:47], s13 offen offset:3072 lds
LP8:
    ds_read_b96 v[4:6], v29 offset:48
    s_waitcnt lgkmcnt(0)
    v_min3_u32 v4, v4, v5, v6
    s_nop 0
    v_readfirstlane_b32 s12, v4
    s_nop 0
    s_cmp_ge_u32 s12, 9
    s_nop 2
    s_cbranch_scc1 LP8_ok
    s_sleep 1
    s_branch LP8
LP8_ok:
    s_lshl_b32 s15, s97, 20
    s_add_u32 s15, s15, s14
    s_xor_b32 s13, s95, 1
    s_lshl_b32 s13, s13, 8
    s_add_u32 s15, s15, s13
    s_mov_b32 m0, 98304
    s_add_u32 s13, s15, 524288
    buffer_load_dwordx4 v9, s[44:47], s13 offen offset:0 lds
    buffer_load_dwordx4 v10, s[44:47], s13 offen offset:1024 lds
    buffer_load_dwordx4 v11, s[44:47], s13 offen offset:2048 lds
    buffer_load_dwordx4 v12, s[44:47], s13 offen offset:3072 lds
    s_mov_b32 m0, 102400
    s_add_u32 s13, s15, 655360
    buffer_load_dwordx4 v9, s[44:47], s13 offen offset:0 lds
    buffer_load_dwordx4 v10, s[44:47], s13 offen offset:1024 lds
    buffer_load_dwordx4 v11, s[44:47], s13 offen offset:2048 lds
    buffer_load_dwordx4 v12, s[44:47], s13 offen offset:3072 lds
    s_mov_b32 m0, 106496
    s_add_u32 s13, s15, 786432
    buffer_load_dwordx4 v9, s[44:47], s13 offen offset:0 lds
    buffer_load_dwordx4 v10, s[44:47], s13 offen offset:1024 lds
    buffer_load_dwordx4 v11, s[44:47], s13 offen offset:2048 lds
    buffer_load_dwordx4 v12, s[44:47], s13 offen offset:3072 lds
    s_mov_b32 m0, 110592
    s_add_u32 s13, s15, 917504
    buffer_load_dwordx4 v9, s[44:47], s13 offen offset:0 lds
    buffer_load_dwordx4 v10, s[44:47], s13 offen offset:1024 lds
    buffer_load_dwordx4 v11, s[44:47], s13 offen offset:2048 lds
    buffer_load_dwordx4 v12, s[44:47], s13 offen offset:3072 lds
LP9:
    ds_read_b96 v[4:6], v29 offset:48
    s_waitcnt lgkmcnt(0)
    v_min3_u32 v4, v4, v5, v6
    s_nop 0
    v_readfirstlane_b32 s12, v4
    s_nop 0
    s_cmp_ge_u32 s12, 10
    s_nop 2
    s_cbranch_scc1 LP9_ok
    s_sleep 1
    s_branch LP9
LP9_ok:
    s_lshl_b32 s15, s98, 20
    s_add_u32 s15, s15, s14
    s_xor_b32 s13, s95, 1
    s_lshl_b32 s13, s13, 8
    s_add_u32 s15, s15, s13
    s_mov_b32 m0, 114688
    s_add_u32 s13, s15, 0
    buffer_load_dwordx4 v9, s[44:47], s13 offen offset:0 lds
    buffer_load_dwordx4 v10, s[44:47], s13 offen offset:1024 lds
    buffer_load_dwordx4 v11, s[44:47], s13 offen offset:2048 lds
    buffer_load_dwordx4 v12, s[44:47], s13 offen offset:3072 lds
    s_mov_b32 m0, 118784
    s_add_u32 s13, s15, 131072
    buffer_load_dwordx4 v9, s[44:47], s13 offen offset:0 lds
    buffer_load_dwordx4 v10, s[44:47], s13 offen offset:1024 lds
    buffer_load_dwordx4 v11, s[44:47], s13 offen offset:2048 lds
    buffer_load_dwordx4 v12, s[44:47], s13 offen offset:3072 lds
    s_mov_b32 m0, 122880
    s_add_u32 s13, s15, 262144
    buffer_load_dwordx4 v9, s[44:47], s13 offen offset:0 lds
    buffer_load_dwordx4 v10, s[44:47], s13 offen offset:1024 lds
    buffer_load_dwordx4 v11, s[44:47], s13 offen offset:2048 lds
    buffer_load_dwordx4 v12, s[44:47], s13 offen offset:3072 lds
    s_mov_b32 m0, 126976
    s_add_u32 s13, s15, 393216
    buffer_load_dwordx4 v9, s[44:47], s13 offen offset:0 lds
    buffer_load_dwordx4 v10, s[44:47], s13 offen offset:1024 lds
    buffer_load_dwordx4 v11, s[44:47], s13 offen offset:2048 lds
    buffer_load_dwordx4 v12, s[44:47], s13 offen offset:3072 lds
    s_waitcnt vmcnt(32)
    v_mov_b32 v31, 11
    ds_write_b32 v29, v31 offset:4
    s_nop 0
LP10:
    ds_read_b96 v[4:6], v29 offset:64
    s_waitcnt lgkmcnt(0)
    v_min3_u32 v4, v4, v5, v6
    s_nop 0
    v_readfirstlane_b32 s12, v4
    s_nop 0
    s_cmp_ge_u32 s12, 11
    s_nop 2
    s_cbranch_scc1 LP10_ok
    s_sleep 1
    s_branch LP10
LP10_ok:
    s_lshl_b32 s15, s98, 20
    s_add_u32 s15, s15, s14
    s_xor_b32 s13, s95, 1
    s_lshl_b32 s13, s13, 8
    s_add_u32 s15, s15, s13
    s_mov_b32 m0, 131072
    s_add_u32 s13, s15, 524288
    buffer_load_dwordx4 v9, s[44:47], s13 offen offset:0 lds
    buffer_load_dwordx4 v10, s[44:47], s13 offen offset:1024 lds
    buffer_load_dwordx4 v11, s[44:47], s13 offen offset:2048 lds
    buffer_load_dwordx4 v12, s[44:47], s13 offen offset:3072 lds
    s_mov_b32 m0, 135168
    s_add_u32 s13, s15, 655360
    buffer_load_dwordx4 v9, s[44:47], s13 offen offset:0 lds
    buffer_load_dwordx4 v10, s[44:47], s13 offen offset:1024 lds
    buffer_load_dwordx4 v11, s[44:47], s13 offen offset:2048 lds
    buffer_load_dwordx4 v12, s[44:47], s13 offen offset:3072 lds
    s_mov_b32 m0, 139264
    s_add_u32 s13, s15, 786432
    buffer_load_dwordx4 v9, s[44:47], s13 offen offset:0 lds
    buffer_load_dwordx4 v10, s[44:47], s13 offen offset:1024 lds
    buffer_load_dwordx4 v11, s[44:47], s13 offen offset:2048 lds
    buffer_load_dwordx4 v12, s[44:47], s13 offen offset:3072 lds
    s_mov_b32 m0, 143360
    s_add_u32 s13, s15, 917504
    buffer_load_dwordx4 v9, s[44:47], s13 offen offset:0 lds
    buffer_load_dwordx4 v10, s[44:47], s13 offen offset:1024 lds
    buffer_load_dwordx4 v11, s[44:47], s13 offen offset:2048 lds
    buffer_load_dwordx4 v12, s[44:47], s13 offen offset:3072 lds
    s_waitcnt vmcnt(32)
    v_mov_b32 v31, 12
    ds_write_b32 v29, v31 offset:4
    s_nop 0
LP11:
    ds_read_b96 v[4:6], v29 offset:64
    s_waitcnt lgkmcnt(0)
    v_min3_u32 v4, v4, v5, v6
    s_nop 0
    v_readfirstlane_b32 s12, v4
    s_nop 0
    s_cmp_ge_u32 s12, 12
    s_nop 2
    s_cbranch_scc1 LP11_ok
    s_sleep 1
    s_branch LP11
LP11_ok:
    s_lshl_b32 s15, s99, 20
    s_add_u32 s15, s15, s14
    s_xor_b32 s13, s95, 1
    s_lshl_b32 s13, s13, 8
    s_add_u32 s15, s15, s13
    s_mov_b32 m0, 98304
    s_add_u32 s13, s15, 0
    buffer_load_dwordx4 v9, s[44:47], s13 offen offset:0 lds
    buffer_load_dwordx4 v10, s[44:47], s13 offen offset:1024 lds
    buffer_load_dwordx4 v11, s[44:47], s13 offen offset:2048 lds
    buffer_load_dwordx4 v12, s[44:47], s13 offen offset:3072 lds
    s_mov_b32 m0, 102400
    s_add_u32 s13, s15, 131072
    buffer_load_dwordx4 v9, s[44:47], s13 offen offset:0 lds
    buffer_load_dwordx4 v10, s[44:47], s13 offen offset:1024 lds
    buffer_load_dwordx4 v11, s[44:47], s13 offen offset:2048 lds
    buffer_load_dwordx4 v12, s[44:47], s13 offen offset:3072 lds
    s_mov_b32 m0, 106496
    s_add_u32 s13, s15, 262144
    buffer_load_dwordx4 v9, s[44:47], s13 offen offset:0 lds
    buffer_load_dwordx4 v10, s[44:47], s13 offen offset:1024 lds
    buffer_load_dwordx4 v11, s[44:47], s13 offen offset:2048 lds
    buffer_load_dwordx4 v12, s[44:47], s13 offen offset:3072 lds
    s_mov_b32 m0, 110592
    s_add_u32 s13, s15, 393216
    buffer_load_dwordx4 v9, s[44:47], s13 offen offset:0 lds
    buffer_load_dwordx4 v10, s[44:47], s13 offen offset:1024 lds
    buffer_load_dwordx4 v11, s[44:47], s13 offen offset:2048 lds
    buffer_load_dwordx4 v12, s[44:47], s13 offen offset:3072 lds
    s_waitcnt vmcnt(32)
    v_mov_b32 v31, 13
    ds_write_b32 v29, v31 offset:4
    s_nop 0
LP12:
    ds_read_b96 v[4:6], v29 offset:64
    s_waitcnt lgkmcnt(0)
    v_min3_u32 v4, v4, v5, v6
    s_nop 0
    v_readfirstlane_b32 s12, v4
    s_nop 0
    s_cmp_ge_u32 s12, 13
    s_nop 2
    s_cbranch_scc1 LP12_ok
    s_sleep 1
    s_branch LP12
LP12_ok:
    s_lshl_b32 s15, s99, 20
    s_add_u32 s15, s15, s14
    s_xor_b32 s13, s95, 1
    s_lshl_b32 s13, s13, 8
    s_add_u32 s15, s15, s13
    s_mov_b32 m0, 114688
    s_add_u32 s13, s15, 524288
    buffer_load_dwordx4 v9, s[44:47], s13 offen offset:0 lds
    buffer_load_dwordx4 v10, s[44:47], s13 offen offset:1024 lds
    buffer_load_dwordx4 v11, s[44:47], s13 offen offset:2048 lds
    buffer_load_dwordx4 v12, s[44:47], s13 offen offset:3072 lds
    s_mov_b32 m0, 118784
    s_add_u32 s13, s15, 655360
    buffer_load_dwordx4 v9, s[44:47], s13 offen offset:0 lds
    buffer_load_dwordx4 v10, s[44:47], s13 offen offset:1024 lds
    buffer_load_dwordx4 v11, s[44:47], s13 offen offset:2048 lds
    buffer_load_dwordx4 v12, s[44:47], s13 offen offset:3072 lds
    s_mov_b32 m0, 122880
    s_add_u32 s13, s15, 786432
    buffer_load_dwordx4 v9, s[44:47], s13 offen offset:0 lds
    buffer_load_dwordx4 v10, s[44:47], s13 offen offset:1024 lds
    buffer_load_dwordx4 v11, s[44:47], s13 offen offset:2048 lds
    buffer_load_dwordx4 v12, s[44:47], s13 offen offset:3072 lds
    s_mov_b32 m0, 126976
    s_add_u32 s13, s15, 917504
    buffer_load_dwordx4 v9, s[44:47], s13 offen offset:0 lds
    buffer_load_dwordx4 v10, s[44:47], s13 offen offset:1024 lds
    buffer_load_dwordx4 v11, s[44:47], s13 offen offset:2048 lds
    buffer_load_dwordx4 v12, s[44:47], s13 offen offset:3072 lds
    s_waitcnt vmcnt(32)
    v_mov_b32 v31, 14
    ds_write_b32 v29, v31 offset:4
    s_nop 0
LP13:
    ds_read_b96 v[4:6], v29 offset:64
    s_waitcnt lgkmcnt(0)
    v_min3_u32 v4, v4, v5, v6
    s_nop 0
    v_readfirstlane_b32 s12, v4
    s_nop 0
    s_cmp_ge_u32 s12, 14
    s_nop 2
    s_cbranch_scc1 LP13_ok
    s_sleep 1
    s_branch LP13
LP13_ok:
    s_lshl_b32 s15, s100, 20
    s_add_u32 s15, s15, s14
    s_xor_b32 s13, s95, 1
    s_lshl_b32 s13, s13, 8
    s_add_u32 s15, s15, s13
    s_mov_b32 m0, 131072
    s_add_u32 s13, s15, 0
    buffer_load_dwordx4 v9, s[44:47], s13 offen offset:0 lds
    buffer_load_dwordx4 v10, s[44:47], s13 offen offset:1024 lds
    buffer_load_dwordx4 v11, s[44:47], s13 offen offset:2048 lds
    buffer_load_dwordx4 v12, s[44:47], s13 offen offset:3072 lds
    s_mov_b32 m0, 135168
    s_add_u32 s13, s15, 131072
    buffer_load_dwordx4 v9, s[44:47], s13 offen offset:0 lds
    buffer_load_dwordx4 v10, s[44:47], s13 offen offset:1024 lds
    buffer_load_dwordx4 v11, s[44:47], s13 offen offset:2048 lds
    buffer_load_dwordx4 v12, s[44:47], s13 offen offset:3072 lds
    s_mov_b32 m0, 139264
    s_add_u32 s13, s15, 262144
    buffer_load_dwordx4 v9, s[44:47], s13 offen offset:0 lds
    buffer_load_dwordx4 v10, s[44:47], s13 offen offset:1024 lds
    buffer_load_dwordx4 v11, s[44:47], s13 offen offset:2048 lds
    buffer_load_dwordx4 v12, s[44:47], s13 offen offset:3072 lds
    s_mov_b32 m0, 143360
    s_add_u32 s13, s15, 393216
    buffer_load_dwordx4 v9, s[44:47], s13 offen offset:0 lds
    buffer_load_dwordx4 v10, s[44:47], s13 offen offset:1024 lds
    buffer_load_dwordx4 v11, s[44:47], s13 offen offset:2048 lds
    buffer_load_dwordx4 v12, s[44:47], s13 offen offset:3072 lds
    s_waitcnt vmcnt(32)
    v_mov_b32 v31, 15
    ds_write_b32 v29, v31 offset:4
    s_nop 0
LP14:
    ds_read_b96 v[4:6], v29 offset:64
    s_waitcnt lgkmcnt(0)
    v_min3_u32 v4, v4, v5, v6
    s_nop 0
    v_readfirstlane_b32 s12, v4
    s_nop 0
    s_cmp_ge_u32 s12, 15
    s_nop 2
    s_cbranch_scc1 LP14_ok
    s_sleep 1
    s_branch LP14
LP14_ok:
    s_lshl_b32 s15, s100, 20
    s_add_u32 s15, s15, s14
    s_xor_b32 s13, s95, 1
    s_lshl_b32 s13, s13, 8
    s_add_u32 s15, s15, s13
    s_mov_b32 m0, 98304
    s_add_u32 s13, s15, 524288
    buffer_load_dwordx4 v9, s[44:47], s13 offen offset:0 lds
    buffer_load_dwordx4 v10, s[44:47], s13 offen offset:1024 lds
    buffer_load_dwordx4 v11, s[44:47], s13 offen offset:2048 lds
    buffer_load_dwordx4 v12, s[44:47], s13 offen offset:3072 lds
    s_mov_b32 m0, 102400
    s_add_u32 s13, s15, 655360
    buffer_load_dwordx4 v9, s[44:47], s13 offen offset:0 lds
    buffer_load_dwordx4 v10, s[44:47], s13 offen offset:1024 lds
    buffer_load_dwordx4 v11, s[44:47], s13 offen offset:2048 lds
    buffer_load_dwordx4 v12, s[44:47], s13 offen offset:3072 lds
    s_mov_b32 m0, 106496
    s_add_u32 s13, s15, 786432
    buffer_load_dwordx4 v9, s[44:47], s13 offen offset:0 lds
    buffer_load_dwordx4 v10, s[44:47], s13 offen offset:1024 lds
    buffer_load_dwordx4 v11, s[44:47], s13 offen offset:2048 lds
    buffer_load_dwordx4 v12, s[44:47], s13 offen offset:3072 lds
    s_mov_b32 m0, 110592
    s_add_u32 s13, s15, 917504
    buffer_load_dwordx4 v9, s[44:47], s13 offen offset:0 lds
    buffer_load_dwordx4 v10, s[44:47], s13 offen offset:1024 lds
    buffer_load_dwordx4 v11, s[44:47], s13 offen offset:2048 lds
    buffer_load_dwordx4 v12, s[44:47], s13 offen offset:3072 lds
    s_waitcnt vmcnt(32)
    v_mov_b32 v31, 16
    ds_write_b32 v29, v31 offset:4
    s_nop 0
LP15:
    ds_read_b96 v[4:6], v29 offset:64
    s_waitcnt lgkmcnt(0)
    v_min3_u32 v4, v4, v5, v6
    s_nop 0
    v_readfirstlane_b32 s12, v4
    s_nop 0
    s_cmp_ge_u32 s12, 16
    s_nop 2
    s_cbranch_scc1 LP15_ok
    s_sleep 1
    s_branch LP15
LP15_ok:
    s_lshl_b32 s15, s101, 20
    s_add_u32 s15, s15, s14
    s_xor_b32 s13, s95, 1
    s_lshl_b32 s13, s13, 8
    s_add_u32 s15, s15, s13
    s_mov_b32 m0, 114688
    s_add_u32 s13, s15, 0
    buffer_load_dwordx4 v9, s[44:47], s13 offen offset:0 lds
    buffer_load_dwordx4 v10, s[44:47], s13 offen offset:1024 lds
    buffer_load_dwordx4 v11, s[44:47], s13 offen offset:2048 lds
    buffer_load_dwordx4 v12, s[44:47], s13 offen offset:3072 lds
    s_mov_b32 m0, 118784
    s_add_u32 s13, s15, 131072
    buffer_load_dwordx4 v9, s[44:47], s13 offen offset:0 lds
    buffer_load_dwordx4 v10, s[44:47], s13 offen offset:1024 lds
    buffer_load_dwordx4 v11, s[44:47], s13 offen offset:2048 lds
    buffer_load_dwordx4 v12, s[44:47], s13 offen offset:3072 lds
    s_mov_b32 m0, 122880
    s_add_u32 s13, s15, 262144
    buffer_load_dwordx4 v9, s[44:47], s13 offen offset:0 lds
    buffer_load_dwordx4 v10, s[44:47], s13 offen offset:1024 lds
    buffer_load_dwordx4 v11, s[44:47], s13 offen offset:2048 lds
    buffer_load_dwordx4 v12, s[44:47], s13 offen offset:3072 lds
    s_mov_b32 m0, 126976
    s_add_u32 s13, s15, 393216
    buffer_load_dwordx4 v9, s[44:47], s13 offen offset:0 lds
    buffer_load_dwordx4 v10, s[44:47], s13 offen offset:1024 lds
    buffer_load_dwordx4 v11, s[44:47], s13 offen offset:2048 lds
    buffer_load_dwordx4 v12, s[44:47], s13 offen offset:3072 lds
    s_waitcnt vmcnt(32)
    v_mov_b32 v31, 17
    ds_write_b32 v29, v31 offset:4
    s_nop 0
LP16:
    ds_read_b96 v[4:6], v29 offset:64
    s_waitcnt lgkmcnt(0)
    v_min3_u32 v4, v4, v5, v6
    s_nop 0
    v_readfirstlane_b32 s12, v4
    s_nop 0
    s_cmp_ge_u32 s12, 17
    s_nop 2
    s_cbranch_scc1 LP16_ok
    s_sleep 1
    s_branch LP16
LP16_ok:
    s_lshl_b32 s15, s101, 20
    s_add_u32 s15, s15, s14
    s_xor_b32 s13, s95, 1
    s_lshl_b32 s13, s13, 8
    s_add_u32 s15, s15, s13
    s_mov_b32 m0, 131072
    s_add_u32 s13, s15, 524288
    buffer_load_dwordx4 v9, s[44:47], s13 offen offset:0 lds
    buffer_load_dwordx4 v10, s[44:47], s13 offen offset:1024 lds
    buffer_load_dwordx4 v11, s[44:47], s13 offen offset:2048 lds
    buffer_load_dwordx4 v12, s[44:47], s13 offen offset:3072 lds
    s_mov_b32 m0, 135168
    s_add_u32 s13, s15, 655360
    buffer_load_dwordx4 v9, s[44:47], s13 offen offset:0 lds
    buffer_load_dwordx4 v10, s[44:47], s13 offen offset:1024 lds
    buffer_load_dwordx4 v11, s[44:47], s13 offen offset:2048 lds
    buffer_load_dwordx4 v12, s[44:47], s13 offen offset:3072 lds
    s_mov_b32 m0, 139264
    s_add_u32 s13, s15, 786432
    buffer_load_dwordx4 v9, s[44:47], s13 offen offset:0 lds
    buffer_load_dwordx4 v10, s[44:47], s13 offen offset:1024 lds
    buffer_load_dwordx4 v11, s[44:47], s13 offen offset:2048 lds
    buffer_load_dwordx4 v12, s[44:47], s13 offen offset:3072 lds
    s_mov_b32 m0, 143360
    s_add_u32 s13, s15, 917504
    buffer_load_dwordx4 v9, s[44:47], s13 offen offset:0 lds
    buffer_load_dwordx4 v10, s[44:47], s13 offen offset:1024 lds
    buffer_load_dwordx4 v11, s[44:47], s13 offen offset:2048 lds
    buffer_load_dwordx4 v12, s[44:47], s13 offen offset:3072 lds
    s_waitcnt vmcnt(32)
    v_mov_b32 v31, 18
    ds_write_b32 v29, v31 offset:4
    s_waitcnt vmcnt(16)
    v_mov_b32 v31, 19
    ds_write_b32 v29, v31 offset:4
    s_waitcnt vmcnt(0)
    v_mov_b32 v31, 20
    ds_write_b32 v29, v31 offset:4
    s_mov_b32 s44, s24
    s_and_b32 s45, s25, 0xffff
    s_mov_b32 s46, 5242880
    s_mov_b32 s47, 0x20000
    s_setprio 0
    v_mul_u32_u24 v1, 13, v0
    v_lshrrev_b32 v1, 8, v1
    v_mul_u32_u24 v1, 960, v1
    v_lshl_add_u32 v9, v0, 4, v1
    s_mul_i32 s14, s93, 320
    s_mul_i32 s15, s92, 1310720
    s_add_u32 s14, s14, s15
LP17:
    ds_read_b96 v[4:6], v29 offset:64
    s_waitcnt lgkmcnt(0)
    v_min3_u32 v4, v4, v5, v6
    s_nop 0
    v_readfirstlane_b32 s12, v4
    s_nop 0
    s_cmp_ge_u32 s12, 20
    s_nop 2
    s_cbranch_scc1 LP17_ok
    s_sleep 1
    s_branch LP17
LP17_ok:
    s_add_u32 s15, s93, 0
    s_and_b32 s15, s15, 3
    s_mul_i32 s15, s15, 327680
    s_add_u32 s15, s15, s14
    s_xor_b32 s13, s95, 0
    s_mul_i32 s13, s13, 163840
    s_add_u32 s15, s15, s13
    s_mov_b32 exec_hi, 0xfffffff
    s_mov_b32 m0, 98304
    s_add_u32 s13, s15, 0
    buffer_load_dwordx4 v9, s[44:47], s13 offen lds
    s_mov_b32 m0, 99264
    s_add_u32 s13, s15, 3840
    buffer_load_dwordx4 v9, s[44:47], s13 offen lds
    s_mov_b32 m0, 100224
    s_add_u32 s13, s15, 7680
    buffer_load_dwordx4 v9, s[44:47], s13 offen lds
    s_mov_b32 m0, 101184
    s_add_u32 s13, s15, 11520
    buffer_load_dwordx4 v9, s[44:47], s13 offen lds
    s_mov_b32 m0, 102144
    s_add_u32 s13, s15, 15360
    buffer_load_dwordx4 v9, s[44:47], s13 offen lds
    s_mov_b32 m0, 103104
    s_add_u32 s13, s15, 19200
    buffer_load_dwordx4 v9, s[44:47], s13 offen lds
    s_mov_b32 m0, 104064
    s_add_u32 s13, s15, 23040
    buffer_load_dwordx4 v9, s[44:47], s13 offen lds
    s_mov_b32 m0, 105024
    s_add_u32 s13, s15, 26880
    buffer_load_dwordx4 v9, s[44:47], s13 offen lds
    s_mov_b32 m0, 105984
    s_add_u32 s13, s15, 30720
    buffer_load_dwordx4 v9, s[44:47], s13 offen lds
    s_mov_b32 m0, 106944
    s_add_u32 s13, s15, 34560
    buffer_load_dwordx4 v9, s[44:47], s13 offen lds
    s_mov_b32 m0, 107904
    s_add_u32 s13, s15, 38400
    buffer_load_dwordx4 v9, s[44:47], s13 offen lds
    s_mov_b32 m0, 108864
    s_add_u32 s13, s15, 42240
    buffer_load_dwordx4 v9, s[44:47], s13 offen lds
    s_mov_b32 m0, 109824
    s_add_u32 s13, s15, 46080
    buffer_load_dwordx4 v9, s[44:47], s13 offen lds
    s_mov_b32 m0, 110784
    s_add_u32 s13, s15, 49920
    buffer_load_dwordx4 v9, s[44:47], s13 offen lds
    s_mov_b32 m0, 111744
    s_add_u32 s13, s15, 53760
    buffer_load_dwordx4 v9, s[44:47], s13 offen lds
    s_mov_b32 m0, 112704
    s_add_u32 s13, s15, 57600
    buffer_load_dwordx4 v9, s[44:47], s13 offen lds
    s_mov_b32 m0, 113664
    s_add_u32 s13, s15, 61440
    buffer_load_dwordx4 v9, s[44:47], s13 offen lds
    s_mov_b32 m0, 114624
    s_add_u32 s13, s15, 65280
    buffer_load_dwordx4 v9, s[44:47], s13 offen lds
    s_mov_b32 m0, 115584
    s_add_u32 s13, s15, 69120
    buffer_load_dwordx4 v9, s[44:47], s13 offen lds
    s_mov_b32 m0, 116544
    s_add_u32 s13, s15, 72960
    buffer_load_dwordx4 v9, s[44:47], s13 offen lds
    s_mov_b32 m0, 117504
    s_add_u32 s13, s15, 76800
    buffer_load_dwordx4 v9, s[44:47], s13 offen lds
    s_mov_b64 exec, 0xfffff
    s_mov_b32 m0, 118464
    s_add_u32 s13, s15, 80640
    buffer_load_dwordx4 v9, s[44:47], s13 offen lds
    s_mov_b64 exec, -1
    s_add_u32 s15, s93, 0
    s_and_b32 s15, s15, 3
    s_mul_i32 s15, s15, 327680
    s_add_u32 s15, s15, s14
    s_xor_b32 s13, s95, 0
    s_mul_i32 s13, s13, 163840
    s_add_u32 s15, s15, s13
    s_mov_b32 exec_hi, 0xfffffff
    s_mov_b32 m0, 118784
    s_add_u32 s13, s15, 81920
    buffer_load_dwordx4 v9, s[44:47], s13 offen lds
    s_mov_b32 m0, 119744
    s_add_u32 s13, s15, 85760
    buffer_load_dwordx4 v9, s[44:47], s13 offen lds
    s_mov_b32 m0, 120704
    s_add_u32 s13, s15, 89600
    buffer_load_dwordx4 v9, s[44:47], s13 offen lds
    s_mov_b32 m0, 121664
    s_add_u32 s13, s15, 93440
    buffer_load_dwordx4 v9, s[44:47], s13 offen lds
    s_mov_b32 m0, 122624
    s_add_u32 s13, s15, 97280
    buffer_load_dwordx4 v9, s[44:47], s13 offen lds
    s_mov_b32 m0, 123584
    s_add_u32 s13, s15, 101120
    buffer_load_dwordx4 v9, s[44:47], s13 offen lds
    s_mov_b32 m0, 124544
    s_add_u32 s13, s15, 104960
    buffer_load_dwordx4 v9, s[44:47], s13 offen lds
    s_mov_b32 m0, 125504
    s_add_u32 s13, s15, 108800
    buffer_load_dwordx4 v9, s[44:47], s13 offen lds
    s_mov_b32 m0, 126464
    s_add_u32 s13, s15, 112640
    buffer_load_dwordx4 v9, s[44:47], s13 offen lds
    s_mov_b32 m0, 127424
    s_add_u32 s13, s15, 116480
    buffer_load_dwordx4 v9, s[44:47], s13 offen lds
    s_mov_b32 m0, 128384
    s_add_u32 s13, s15, 120320
    buffer_load_dwordx4 v9, s[44:47], s13 offen lds
    s_mov_b32 m0, 129344
    s_add_u32 s13, s15, 124160
    buffer_load_dwordx4 v9, s[44:47], s13 offen lds
    s_mov_b32 m0, 130304
    s_add_u32 s13, s15, 128000
    buffer_load_dwordx4 v9, s[44:47], s13 offen lds
    s_mov_b32 m0, 131264
    s_add_u32 s13, s15, 131840
    buffer_load_dwordx4 v9, s[44:47], s13 offen lds
    s_mov_b32 m0, 132224
    s_add_u32 s13, s15, 135680
    buffer_load_dwordx4 v9, s[44:47], s13 offen lds
    s_mov_b32 m0, 133184
    s_add_u32 s13, s15, 139520
    buffer_load_dwordx4 v9, s[44:47], s13 offen lds
    s_mov_b32 m0, 134144
    s_add_u32 s13, s15, 143360
    buffer_load_dwordx4 v9, s[44:47], s13 offen lds
    s_mov_b32 m0, 135104
    s_add_u32 s13, s15, 147200
    buffer_load_dwordx4 v9, s[44:47], s13 offen lds
    s_mov_b32 m0, 136064
    s_add_u32 s13, s15, 151040
    buffer_load_dwordx4 v9, s[44:47], s13 offen lds
    s_mov_b32 m0, 137024
    s_add_u32 s13, s15, 154880
    buffer_load_dwordx4 v9, s[44:47], s13 offen lds
    s_mov_b32 m0, 137984
    s_add_u32 s13, s15, 158720
    buffer_load_dwordx4 v9, s[44:47], s13 offen lds
    s_mov_b64 exec, 0xfffff
    s_mov_b32 m0, 138944
    s_add_u32 s13, s15, 162560
    buffer_load_dwordx4 v9, s[44:47], s13 offen lds
    s_mov_b64 exec, -1
    s_waitcnt vmcnt(22)
    v_mov_b32 v31, 1
    ds_write_b32 v29, v31 offset:108
    s_add_u32 s15, s93, 1
    s_and_b32 s15, s15, 3
    s_mul_i32 s15, s15, 327680
    s_add_u32 s15, s15, s14
    s_xor_b32 s13, s95, 0
    s_mul_i32 s13, s13, 163840
    s_add_u32 s15, s15, s13
    s_mov_b32 exec_hi, 0xfffffff
    s_mov_b32 m0, 139264
    s_add_u32 s13, s15, 0
    buffer_load_dwordx4 v9, s[44:47], s13 offen lds
    s_mov_b32 m0, 140224
    s_add_u32 s13, s15, 3840
    buffer_load_dwordx4 v9, s[44:47], s13 offen lds
    s_mov_b32 m0, 141184
    s_add_u32 s13, s15, 7680
    buffer_load_dwordx4 v9, s[44:47], s13 offen lds
    s_mov_b32 m0, 142144
    s_add_u32 s13, s15, 11520
    buffer_load_dwordx4 v9, s[44:47], s13 offen lds
    s_mov_b32 m0, 143104
    s_add_u32 s13, s15, 15360
    buffer_load_dwordx4 v9, s[44:47], s13 offen lds
    s_mov_b32 m0, 144064
    s_add_u32 s13, s15, 19200
    buffer_load_dwordx4 v9, s[44:47], s13 offen lds
    s_mov_b32 m0, 145024
    s_add_u32 s13, s15, 23040
    buffer_load_dwordx4 v9, s[44:47], s13 offen lds
    s_mov_b32 m0, 145984
    s_add_u32 s13, s15, 26880
    buffer_load_dwordx4 v9, s[44:47], s13 offen lds
    s_mov_b32 m0, 146944
    s_add_u32 s13, s15, 30720
    buffer_load_dwordx4 v9, s[44:47], s13 offen lds
    s_mov_b32 m0, 147904
    s_add_u32 s13, s15, 34560
    buffer_load_dwordx4 v9, s[44:47], s13 offen lds
    s_mov_b32 m0, 148864
    s_add_u32 s13, s15, 38400
    buffer_load_dwordx4 v9, s[44:47], s13 offen lds
    s_mov_b32 m0, 149824
    s_add_u32 s13, s15, 42240
    buffer_load_dwordx4 v9, s[44:47], s13 offen lds
    s_mov_b32 m0, 150784
    s_add_u32 s13, s15, 46080
    buffer_load_dwordx4 v9, s[44:47], s13 offen lds
    s_mov_b32 m0, 151744
    s_add_u32 s13, s15, 49920
    buffer_load_dwordx4 v9, s[44:47], s13 offen lds
    s_mov_b32 m0, 152704
    s_add_u32 s13, s15, 53760
    buffer_load_dwordx4 v9, s[44:47], s13 offen lds
    s_mov_b32 m0, 153664
    s_add_u32 s13, s15, 57600
    buffer_load_dwordx4 v9, s[44:47], s13 offen lds
    s_mov_b32 m0, 154624
    s_add_u32 s13, s15, 61440
    buffer_load_dwordx4 v9, s[44:47], s13 offen lds
    s_mov_b32 m0, 155584
    s_add_u32 s13, s15, 65280
    buffer_load_dwordx4 v9, s[44:47], s13 offen lds
    s_mov_b32 m0, 156544
    s_add_u32 s13, s15, 69120
    buffer_load_dwordx4 v9, s[44:47], s13 offen lds
    s_mov_b32 m0, 157504
    s_add_u32 s13, s15, 72960
    buffer_load_dwordx4 v9, s[44:47], s13 offen lds
    s_mov_b32 m0, 158464
    s_add_u32 s13, s15, 76800
    buffer_load_dwordx4 v9, s[44:47], s13 offen lds
    s_mov_b64 exec, 0xfffff
    s_mov_b32 m0, 159424
    s_add_u32 s13, s15, 80640
    buffer_load_dwordx4 v9, s[44:47], s13 offen lds
    s_mov_b64 exec, -1
    s_waitcnt vmcnt(22)
    v_mov_b32 v31, 2
    ds_write_b32 v29, v31 offset:108
    s_nop 0
LP18:
    ds_read_b96 v[4:6], v29 offset:48
    s_waitcnt lgkmcnt(0)
    v_min3_u32 v4, v4, v5, v6
    s_nop 0
    v_readfirstlane_b32 s12, v4
    s_nop 0
    s_cmp_ge_u32 s12, 21
    s_nop 2
    s_cbranch_scc1 LP18_ok
    s_sleep 1
    s_branch LP18
LP18_ok:
    s_add_u32 s15, s93, 1
    s_and_b32 s15, s15, 3
    s_mul_i32 s15, s15, 327680
    s_add_u32 s15, s15, s14
    s_xor_b32 s13, s95, 0
    s_mul_i32 s13, s13, 163840
    s_add_u32 s15, s15, s13
    s_mov_b32 exec_hi, 0xfffffff
    s_mov_b32 m0, 98304
    s_add_u32 s13, s15, 81920
    buffer_load_dwordx4 v9, s[44:47], s13 offen lds
    s_mov_b32 m0, 99264
    s_add_u32 s13, s15, 85760
    buffer_load_dwordx4 v9, s[44:47], s13 offen lds
    s_mov_b32 m0, 100224
    s_add_u32 s13, s15, 89600
    buffer_load_dwordx4 v9, s[44:47], s13 offen lds
    s_mov_b32 m0, 101184
    s_add_u32 s13, s15, 93440
    buffer_load_dwordx4 v9, s[44:47], s13 offen lds
    s_mov_b32 m0, 102144
    s_add_u32 s13, s15, 97280
    buffer_load_dwordx4 v9, s[44:47], s13 offen lds
    s_mov_b32 m0, 103104
    s_add_u32 s13, s15, 101120
    buffer_load_dwordx4 v9, s[44:47], s13 offen lds
    s_mov_b32 m0, 104064
    s_add_u32 s13, s15, 104960
    buffer_load_dwordx4 v9, s[44:47], s13 offen lds
    s_mov_b32 m0, 105024
    s_add_u32 s13, s15, 108800
    buffer_load_dwordx4 v9, s[44:47], s13 offen lds
    s_mov_b32 m0, 105984
    s_add_u32 s13, s15, 112640
    buffer_load_dwordx4 v9, s[44:47], s13 offen lds
    s_mov_b32 m0, 106944
    s_add_u32 s13, s15, 116480
    buffer_load_dwordx4 v9, s[44:47], s13 offen lds
    s_mov_b32 m0, 107904
    s_add_u32 s13, s15, 120320
    buffer_load_dwordx4 v9, s[44:47], s13 offen lds
    s_mov_b32 m0, 108864
    s_add_u32 s13, s15, 124160
    buffer_load_dwordx4 v9, s[44:47], s13 offen lds
    s_mov_b32 m0, 109824
    s_add_u32 s13, s15, 128000
    buffer_load_dwordx4 v9, s[44:47], s13 offen lds
    s_mov_b32 m0, 110784
    s_add_u32 s13, s15, 131840
    buffer_load_dwordx4 v9, s[44:47], s13 offen lds
    s_mov_b32 m0, 111744
    s_add_u32 s13, s15, 135680
    buffer_load_dwordx4 v9, s[44:47], s13 offen lds
    s_mov_b32 m0, 112704
    s_add_u32 s13, s15, 139520
    buffer_load_dwordx4 v9, s[44:47], s13 offen lds
    s_mov_b32 m0, 113664
    s_add_u32 s13, s15, 143360
    buffer_load_dwordx4 v9, s[44:47], s13 offen lds
    s_mov_b32 m0, 114624
    s_add_u32 s13, s15, 147200
    buffer_load_dwordx4 v9, s[44:47], s13 offen lds
    s_mov_b32 m0, 115584
    s_add_u32 s13, s15, 151040
    buffer_load_dwordx4 v9, s[44:47], s13 offen lds
    s_mov_b32 m0, 116544
    s_add_u32 s13, s15, 154880
    buffer_load_dwordx4 v9, s[44:47], s13 offen lds
    s_mov_b32 m0, 117504
    s_add_u32 s13, s15, 158720
    buffer_load_dwordx4 v9, s[44:47], s13 offen lds
    s_mov_b64 exec, 0xfffff
    s_mov_b32 m0, 118464
    s_add_u32 s13, s15, 162560
    buffer_load_dwordx4 v9, s[44:47], s13 offen lds
    s_mov_b64 exec, -1
    s_waitcnt vmcnt(22)
    v_mov_b32 v31, 3
    ds_write_b32 v29, v31 offset:108
    s_nop 0
LP19:
    ds_read_b96 v[4:6], v29 offset:48
    s_waitcnt lgkmcnt(0)
    v_min3_u32 v4, v4, v5, v6
    s_nop 0
    v_readfirstlane_b32 s12, v4
    s_nop 0
    s_cmp_ge_u32 s12, 22
    s_nop 2
    s_cbranch_scc1 LP19_ok
    s_sleep 1
    s_branch LP19
LP19_ok:
    s_add_u32 s15, s93, 2
    s_and_b32 s15, s15, 3
    s_mul_i32 s15, s15, 327680
    s_add_u32 s15, s15, s14
    s_xor_b32 s13, s95, 0
    s_mul_i32 s13, s13, 163840
    s_add_u32 s15, s15, s13
    s_mov_b32 exec_hi, 0xfffffff
    s_mov_b32 m0, 118784
    s_add_u32 s13, s15, 0
    buffer_load_dwordx4 v9, s[44:47], s13 offen lds
    s_mov_b32 m0, 119744
    s_add_u32 s13, s15, 3840
    buffer_load_dwordx4 v9, s[44:47], s13 offen lds
    s_mov_b32 m0, 120704
    s_add_u32 s13, s15, 7680
    buffer_load_dwordx4 v9, s[44:47], s13 offen lds
    s_mov_b32 m0, 121664
    s_add_u32 s13, s15, 11520
    buffer_load_dwordx4 v9, s[44:47], s13 offen lds
    s_mov_b32 m0, 122624
    s_add_u32 s13, s15, 15360
    buffer_load_dwordx4 v9, s[44:47], s13 offen lds
    s_mov_b32 m0, 123584
    s_add_u32 s13, s15, 19200
    buffer_load_dwordx4 v9, s[44:47], s13 offen lds
    s_mov_b32 m0, 124544
    s_add_u32 s13, s15, 23040
    buffer_load_dwordx4 v9, s[44:47], s13 offen lds
    s_mov_b32 m0, 125504
    s_add_u32 s13, s15, 26880
    buffer_load_dwordx4 v9, s[44:47], s13 offen lds
    s_mov_b32 m0, 126464
    s_add_u32 s13, s15, 30720
    buffer_load_dwordx4 v9, s[44:47], s13 offen lds
    s_mov_b32 m0, 127424
    s_add_u32 s13, s15, 34560
    buffer_load_dwordx4 v9, s[44:47], s13 offen lds
    s_mov_b32 m0, 128384
    s_add_u32 s13, s15, 38400
    buffer_load_dwordx4 v9, s[44:47], s13 offen lds
    s_mov_b32 m0, 129344
    s_add_u32 s13, s15, 42240
    buffer_load_dwordx4 v9, s[44:47], s13 offen lds
    s_mov_b32 m0, 130304
    s_add_u32 s13, s15, 46080
    buffer_load_dwordx4 v9, s[44:47], s13 offen lds
    s_mov_b32 m0, 131264
    s_add_u32 s13, s15, 49920
    buffer_load_dwordx4 v9, s[44:47], s13 offen lds
    s_mov_b32 m0, 132224
    s_add_u32 s13, s15, 53760
    buffer_load_dwordx4 v9, s[44:47], s13 offen lds
    s_mov_b32 m0, 133184
    s_add_u32 s13, s15, 57600
    buffer_load_dwordx4 v9, s[44:47], s13 offen lds
    s_mov_b32 m0, 134144
    s_add_u32 s13, s15, 61440
    buffer_load_dwordx4 v9, s[44:47], s13 offen lds
    s_mov_b32 m0, 135104
    s_add_u32 s13, s15, 65280
    buffer_load_dwordx4 v9, s[44:47], s13 offen lds
    s_mov_b32 m0, 136064
    s_add_u32 s13, s15, 69120
    buffer_load_dwordx4 v9, s[44:47], s13 offen lds
    s_mov_b32 m0, 137024
    s_add_u32 s13, s15, 72960
    buffer_load_dwordx4 v9, s[44:47], s13 offen lds
    s_mov_b32 m0, 137984
    s_add_u32 s13, s15, 76800
    buffer_load_dwordx4 v9, s[44:47], s13 offen lds
    s_mov_b64 exec, 0xfffff
    s_mov_b32 m0, 138944
    s_add_u32 s13, s15, 80640
    buffer_load_dwordx4 v9, s[44:47], s13 offen lds
    s_mov_b64 exec, -1
    s_waitcnt vmcnt(22)
    v_mov_b32 v31, 4
    ds_write_b32 v29, v31 offset:108
    s_nop 0
LP20:
    ds_read_b96 v[4:6], v29 offset:48
    s_waitcnt lgkmcnt(0)
    v_min3_u32 v4, v4, v5, v6
    s_nop 0
    v_readfirstlane_b32 s12, v4
    s_nop 0
    s_cmp_ge_u32 s12, 23
    s_nop 2
    s_cbranch_scc1 LP20_ok
    s_sleep 1
    s_branch LP20
LP20_ok:
    s_add_u32 s15, s93, 2
    s_and_b32 s15, s15, 3
    s_mul_i32 s15, s15, 327680
    s_add_u32 s15, s15, s14
    s_xor_b32 s13, s95, 0
    s_mul_i32 s13, s13, 163840
    s_add_u32 s15, s15, s13
    s_mov_b32 exec_hi, 0xfffffff
    s_mov_b32 m0, 139264
    s_add_u32 s13, s15, 81920
    buffer_load_dwordx4 v9, s[44:47], s13 offen lds
    s_mov_b32 m0, 140224
    s_add_u32 s13, s15, 85760
    buffer_load_dwordx4 v9, s[44:47], s13 offen lds
    s_mov_b32 m0, 141184
    s_add_u32 s13, s15, 89600
    buffer_load_dwordx4 v9, s[44:47], s13 offen lds
    s_mov_b32 m0, 142144
    s_add_u32 s13, s15, 93440
    buffer_load_dwordx4 v9, s[44:47], s13 offen lds
    s_mov_b32 m0, 143104
    s_add_u32 s13, s15, 97280
    buffer_load_dwordx4 v9, s[44:47], s13 offen lds
    s_mov_b32 m0, 144064
    s_add_u32 s13, s15, 101120
    buffer_load_dwordx4 v9, s[44:47], s13 offen lds
    s_mov_b32 m0, 145024
    s_add_u32 s13, s15, 104960
    buffer_load_dwordx4 v9, s[44:47], s13 offen lds
    s_mov_b32 m0, 145984
    s_add_u32 s13, s15, 108800
    buffer_load_dwordx4 v9, s[44:47], s13 offen lds
    s_mov_b32 m0, 146944
    s_add_u32 s13, s15, 112640
    buffer_load_dwordx4 v9, s[44:47], s13 offen lds
    s_mov_b32 m0, 147904
    s_add_u32 s13, s15, 116480
    buffer_load_dwordx4 v9, s[44:47], s13 offen lds
    s_mov_b32 m0, 148864
    s_add_u32 s13, s15, 120320
    buffer_load_dwordx4 v9, s[44:47], s13 offen lds
    s_mov_b32 m0, 149824
    s_add_u32 s13, s15, 124160
    buffer_load_dwordx4 v9, s[44:47], s13 offen lds
    s_mov_b32 m0, 150784
    s_add_u32 s13, s15, 128000
    buffer_load_dwordx4 v9, s[44:47], s13 offen lds
    s_mov_b32 m0, 151744
    s_add_u32 s13, s15, 131840
    buffer_load_dwordx4 v9, s[44:47], s13 offen lds
    s_mov_b32 m0, 152704
    s_add_u32 s13, s15, 135680
    buffer_load_dwordx4 v9, s[44:47], s13 offen lds
    s_mov_b32 m0, 153664
    s_add_u32 s13, s15, 139520
    buffer_load_dwordx4 v9, s[44:47], s13 offen lds
    s_mov_b32 m0, 154624
    s_add_u32 s13, s15, 143360
    buffer_load_dwordx4 v9, s[44:47], s13 offen lds
    s_mov_b32 m0, 155584
    s_add_u32 s13, s15, 147200
    buffer_load_dwordx4 v9, s[44:47], s13 offen lds
    s_mov_b32 m0, 156544
    s_add_u32 s13, s15, 151040
    buffer_load_dwordx4 v9, s[44:47], s13 offen lds
    s_mov_b32 m0, 157504
    s_add_u32 s13, s15, 154880
    buffer_load_dwordx4 v9, s[44:47], s13 offen lds
    s_mov_b32 m0, 158464
    s_add_u32 s13, s15, 158720
    buffer_load_dwordx4 v9, s[44:47], s13 offen lds
    s_mov_b64 exec, 0xfffff
    s_mov_b32 m0, 159424
    s_add_u32 s13, s15, 162560
    buffer_load_dwordx4 v9, s[44:47], s13 offen lds
    s_mov_b64 exec, -1
    s_waitcnt vmcnt(22)
    v_mov_b32 v31, 5
    ds_write_b32 v29, v31 offset:108
    s_nop 0
LP21:
    ds_read_b96 v[4:6], v29 offset:48
    s_waitcnt lgkmcnt(0)
    v_min3_u32 v4, v4, v5, v6
    s_nop 0
    v_readfirstlane_b32 s12, v4
    s_nop 0
    s_cmp_ge_u32 s12, 24
    s_nop 2
    s_cbranch_scc1 LP21_ok
    s_sleep 1
    s_branch LP21
LP21_ok:
    s_add_u32 s15, s93, 3
    s_and_b32 s15, s15, 3
    s_mul_i32 s15, s15, 327680
    s_add_u32 s15, s15, s14
    s_xor_b32 s13, s95, 0
    s_mul_i32 s13, s13, 163840
    s_add_u32 s15, s15, s13
    s_mov_b32 exec_hi, 0xfffffff
    s_mov_b32 m0, 98304
    s_add_u32 s13, s15, 0
    buffer_load_dwordx4 v9, s[44:47], s13 offen lds
    s_mov_b32 m0, 99264
    s_add_u32 s13, s15, 3840
    buffer_load_dwordx4 v9, s[44:47], s13 offen lds
    s_mov_b32 m0, 100224
    s_add_u32 s13, s15, 7680
    buffer_load_dwordx4 v9, s[44:47], s13 offen lds
    s_mov_b32 m0, 101184
    s_add_u32 s13, s15, 11520
    buffer_load_dwordx4 v9, s[44:47], s13 offen lds
    s_mov_b32 m0, 102144
    s_add_u32 s13, s15, 15360
    buffer_load_dwordx4 v9, s[44:47], s13 offen lds
    s_mov_b32 m0, 103104
    s_add_u32 s13, s15, 19200
    buffer_load_dwordx4 v9, s[44:47], s13 offen lds
    s_mov_b32 m0, 104064
    s_add_u32 s13, s15, 23040
    buffer_load_dwordx4 v9, s[44:47], s13 offen lds
    s_mov_b32 m0, 105024
    s_add_u32 s13, s15, 26880
    buffer_load_dwordx4 v9, s[44:47], s13 offen lds
    s_mov_b32 m0, 105984
    s_add_u32 s13, s15, 30720
    buffer_load_dwordx4 v9, s[44:47], s13 offen lds
    s_mov_b32 m0, 106944
    s_add_u32 s13, s15, 34560
    buffer_load_dwordx4 v9, s[44:47], s13 offen lds
    s_mov_b32 m0, 107904
    s_add_u32 s13, s15, 38400
    buffer_load_dwordx4 v9, s[44:47], s13 offen lds
    s_mov_b32 m0, 108864
    s_add_u32 s13, s15, 42240
    buffer_load_dwordx4 v9, s[44:47], s13 offen lds
    s_mov_b32 m0, 109824
    s_add_u32 s13, s15, 46080
    buffer_load_dwordx4 v9, s[44:47], s13 offen lds
    s_mov_b32 m0, 110784
    s_add_u32 s13, s15, 49920
    buffer_load_dwordx4 v9, s[44:47], s13 offen lds
    s_mov_b32 m0, 111744
    s_add_u32 s13, s15, 53760
    buffer_load_dwordx4 v9, s[44:47], s13 offen lds
    s_mov_b32 m0, 112704
    s_add_u32 s13, s15, 57600
    buffer_load_dwordx4 v9, s[44:47], s13 offen lds
    s_mov_b32 m0, 113664
    s_add_u32 s13, s15, 61440
    buffer_load_dwordx4 v9, s[44:47], s13 offen lds
    s_mov_b32 m0, 114624
    s_add_u32 s13, s15, 65280
    buffer_load_dwordx4 v9, s[44:47], s13 offen lds
    s_mov_b32 m0, 115584
    s_add_u32 s13, s15, 69120
    buffer_load_dwordx4 v9, s[44:47], s13 offen lds
    s_mov_b32 m0, 116544
    s_add_u32 s13, s15, 72960
    buffer_load_dwordx4 v9, s[44:47], s13 offen lds
    s_mov_b32 m0, 117504
    s_add_u32 s13, s15, 76800
    buffer_load_dwordx4 v9, s[44:47], s13 offen lds
    s_mov_b64 exec, 0xfffff
    s_mov_b32 m0, 118464
    s_add_u32 s13, s15, 80640
    buffer_load_dwordx4 v9, s[44:47], s13 offen lds
    s_mov_b64 exec, -1
    s_waitcnt vmcnt(22)
    v_mov_b32 v31, 6
    ds_write_b32 v29, v31 offset:108
    s_nop 0
LP22:
    ds_read_b96 v[4:6], v29 offset:48
    s_waitcnt lgkmcnt(0)
    v_min3_u32 v4, v4, v5, v6
    s_nop 0
    v_readfirstlane_b32 s12, v4
    s_nop 0
    s_cmp_ge_u32 s12, 25
    s_nop 2
    s_cbranch_scc1 LP22_ok
    s_sleep 1
    s_branch LP22
LP22_ok:
    s_add_u32 s15, s93, 3
    s_and_b32 s15, s15, 3
    s_mul_i32 s15, s15, 327680
    s_add_u32 s15, s15, s14
    s_xor_b32 s13, s95, 0
    s_mul_i32 s13, s13, 163840
    s_add_u32 s15, s15, s13
    s_mov_b32 exec_hi, 0xfffffff
    s_mov_b32 m0, 118784
    s_add_u32 s13, s15, 81920
    buffer_load_dwordx4 v9, s[44:47], s13 offen lds
    s_mov_b32 m0, 119744
    s_add_u32 s13, s15, 85760
    buffer_load_dwordx4 v9, s[44:47], s13 offen lds
    s_mov_b32 m0, 120704
    s_add_u32 s13, s15, 89600
    buffer_load_dwordx4 v9, s[44:47], s13 offen lds
    s_mov_b32 m0, 121664
    s_add_u32 s13, s15, 93440
    buffer_load_dwordx4 v9, s[44:47], s13 offen lds
    s_mov_b32 m0, 122624
    s_add_u32 s13, s15, 97280
    buffer_load_dwordx4 v9, s[44:47], s13 offen lds
    s_mov_b32 m0, 123584
    s_add_u32 s13, s15, 101120
    buffer_load_dwordx4 v9, s[44:47], s13 offen lds
    s_mov_b32 m0, 124544
    s_add_u32 s13, s15, 104960
    buffer_load_dwordx4 v9, s[44:47], s13 offen lds
    s_mov_b32 m0, 125504
    s_add_u32 s13, s15, 108800
    buffer_load_dwordx4 v9, s[44:47], s13 offen lds
    s_mov_b32 m0, 126464
    s_add_u32 s13, s15, 112640
    buffer_load_dwordx4 v9, s[44:47], s13 offen lds
    s_mov_b32 m0, 127424
    s_add_u32 s13, s15, 116480
    buffer_load_dwordx4 v9, s[44:47], s13 offen lds
    s_mov_b32 m0, 128384
    s_add_u32 s13, s15, 120320
    buffer_load_dwordx4 v9, s[44:47], s13 offen lds
    s_mov_b32 m0, 129344
    s_add_u32 s13, s15, 124160
    buffer_load_dwordx4 v9, s[44:47], s13 offen lds
    s_mov_b32 m0, 130304
    s_add_u32 s13, s15, 128000
    buffer_load_dwordx4 v9, s[44:47], s13 offen lds
    s_mov_b32 m0, 131264
    s_add_u32 s13, s15, 131840
    buffer_load_dwordx4 v9, s[44:47], s13 offen lds
    s_mov_b32 m0, 132224
    s_add_u32 s13, s15, 135680
    buffer_load_dwordx4 v9, s[44:47], s13 offen lds
    s_mov_b32 m0, 133184
    s_add_u32 s13, s15, 139520
    buffer_load_dwordx4 v9, s[44:47], s13 offen lds
    s_mov_b32 m0, 134144
    s_add_u32 s13, s15, 143360
    buffer_load_dwordx4 v9, s[44:47], s13 offen lds
    s_mov_b32 m0, 135104
    s_add_u32 s13, s15, 147200
    buffer_load_dwordx4 v9, s[44:47], s13 offen lds
    s_mov_b32 m0, 136064
    s_add_u32 s13, s15, 151040
    buffer_load_dwordx4 v9, s[44:47], s13 offen lds
    s_mov_b32 m0, 137024
    s_add_u32 s13, s15, 154880
    buffer_load_dwordx4 v9, s[44:47], s13 offen lds
    s_mov_b32 m0, 137984
    s_add_u32 s13, s15, 158720
    buffer_load_dwordx4 v9, s[44:47], s13 offen lds
    s_mov_b64 exec, 0xfffff
    s_mov_b32 m0, 138944
    s_add_u32 s13, s15, 162560
    buffer_load_dwordx4 v9, s[44:47], s13 offen lds
    s_mov_b64 exec, -1
    s_waitcnt vmcnt(22)
    v_mov_b32 v31, 7
    ds_write_b32 v29, v31 offset:108
    s_nop 0
LP23:
    ds_read_b96 v[4:6], v29 offset:48
    s_waitcnt lgkmcnt(0)
    v_min3_u32 v4, v4, v5, v6
    s_nop 0
    v_readfirstlane_b32 s12, v4
    s_nop 0
    s_cmp_ge_u32 s12, 26
    s_nop 2
    s_cbranch_scc1 LP23_ok
    s_sleep 1
    s_branch LP23
LP23_ok:
    s_add_u32 s15, s93, 0
    s_and_b32 s15, s15, 3
    s_mul_i32 s15, s15, 327680
    s_add_u32 s15, s15, s14
    s_xor_b32 s13, s95, 1
    s_mul_i32 s13, s13, 163840
    s_add_u32 s15, s15, s13
    s_mov_b32 exec_hi, 0xfffffff
    s_mov_b32 m0, 139264
    s_add_u32 s13, s15, 0
    buffer_load_dwordx4 v9, s[44:47], s13 offen lds
    s_mov_b32 m0, 140224
    s_add_u32 s13, s15, 3840
    buffer_load_dwordx4 v9, s[44:47], s13 offen lds
    s_mov_b32 m0, 141184
    s_add_u32 s13, s15, 7680
    buffer_load_dwordx4 v9, s[44:47], s13 offen lds
    s_mov_b32 m0, 142144
    s_add_u32 s13, s15, 11520
    buffer_load_dwordx4 v9, s[44:47], s13 offen lds
    s_mov_b32 m0, 143104
    s_add_u32 s13, s15, 15360
    buffer_load_dwordx4 v9, s[44:47], s13 offen lds
    s_mov_b32 m0, 144064
    s_add_u32 s13, s15, 19200
    buffer_load_dwordx4 v9, s[44:47], s13 offen lds
    s_mov_b32 m0, 145024
    s_add_u32 s13, s15, 23040
    buffer_load_dwordx4 v9, s[44:47], s13 offen lds
    s_mov_b32 m0, 145984
    s_add_u32 s13, s15, 26880
    buffer_load_dwordx4 v9, s[44:47], s13 offen lds
    s_mov_b32 m0, 146944
    s_add_u32 s13, s15, 30720
    buffer_load_dwordx4 v9, s[44:47], s13 offen lds
    s_mov_b32 m0, 147904
    s_add_u32 s13, s15, 34560
    buffer_load_dwordx4 v9, s[44:47], s13 offen lds
    s_mov_b32 m0, 148864
    s_add_u32 s13, s15, 38400
    buffer_load_dwordx4 v9, s[44:47], s13 offen lds
    s_mov_b32 m0, 149824
    s_add_u32 s13, s15, 42240
    buffer_load_dwordx4 v9, s[44:47], s13 offen lds
    s_mov_b32 m0, 150784
    s_add_u32 s13, s15, 46080
    buffer_load_dwordx4 v9, s[44:47], s13 offen lds
    s_mov_b32 m0, 151744
    s_add_u32 s13, s15, 49920
    buffer_load_dwordx4 v9, s[44:47], s13 offen lds
    s_mov_b32 m0, 152704
    s_add_u32 s13, s15, 53760
    buffer_load_dwordx4 v9, s[44:47], s13 offen lds
    s_mov_b32 m0, 153664
    s_add_u32 s13, s15, 57600
    buffer_load_dwordx4 v9, s[44:47], s13 offen lds
    s_mov_b32 m0, 154624
    s_add_u32 s13, s15, 61440
    buffer_load_dwordx4 v9, s[44:47], s13 offen lds
    s_mov_b32 m0, 155584
    s_add_u32 s13, s15, 65280
    buffer_load_dwordx4 v9, s[44:47], s13 offen lds
    s_mov_b32 m0, 156544
    s_add_u32 s13, s15, 69120
    buffer_load_dwordx4 v9, s[44:47], s13 offen lds
    s_mov_b32 m0, 157504
    s_add_u32 s13, s15, 72960
    buffer_load_dwordx4 v9, s[44:47], s13 offen lds
    s_mov_b32 m0, 158464
    s_add_u32 s13, s15, 76800
    buffer_load_dwordx4 v9, s[44:47], s13 offen lds
    s_mov_b64 exec, 0xfffff
    s_mov_b32 m0, 159424
    s_add_u32 s13, s15, 80640
    buffer_load_dwordx4 v9, s[44:47], s13 offen lds
    s_mov_b64 exec, -1
    s_waitcnt vmcnt(22)
    v_mov_b32 v31, 8
    ds_write_b32 v29, v31 offset:108
    s_nop 0
LP24:
    ds_read_b96 v[4:6], v29 offset:48
    s_waitcnt lgkmcnt(0)
    v_min3_u32 v4, v4, v5, v6
    s_nop 0
    v_readfirstlane_b32 s12, v4
    s_nop 0
    s_cmp_ge_u32 s12, 27
    s_nop 2
    s_cbranch_scc1 LP24_ok
    s_sleep 1
    s_branch LP24
LP24_ok:
    s_add_u32 s15, s93, 0
    s_and_b32 s15, s15, 3
    s_mul_i32 s15, s15, 327680
    s_add_u32 s15, s15, s14
    s_xor_b32 s13, s95, 1
    s_mul_i32 s13, s13, 163840
    s_add_u32 s15, s15, s13
    s_mov_b32 exec_hi, 0xfffffff
    s_mov_b32 m0, 98304
    s_add_u32 s13, s15, 81920
    buffer_load_dwordx4 v9, s[44:47], s13 offen lds
    s_mov_b32 m0, 99264
    s_add_u32 s13, s15, 85760
    buffer_load_dwordx4 v9, s[44:47], s13 offen lds
    s_mov_b32 m0, 100224
    s_add_u32 s13, s15, 89600
    buffer_load_dwordx4 v9, s[44:47], s13 offen lds
    s_mov_b32 m0, 101184
    s_add_u32 s13, s15, 93440
    buffer_load_dwordx4 v9, s[44:47], s13 offen lds
    s_mov_b32 m0, 102144
    s_add_u32 s13, s15, 97280
    buffer_load_dwordx4 v9, s[44:47], s13 offen lds
    s_mov_b32 m0, 103104
    s_add_u32 s13, s15, 101120
    buffer_load_dwordx4 v9, s[44:47], s13 offen lds
    s_mov_b32 m0, 104064
    s_add_u32 s13, s15, 104960
    buffer_load_dwordx4 v9, s[44:47], s13 offen lds
    s_mov_b32 m0, 105024
    s_add_u32 s13, s15, 108800
    buffer_load_dwordx4 v9, s[44:47], s13 offen lds
    s_mov_b32 m0, 105984
    s_add_u32 s13, s15, 112640
    buffer_load_dwordx4 v9, s[44:47], s13 offen lds
    s_mov_b32 m0, 106944
    s_add_u32 s13, s15, 116480
    buffer_load_dwordx4 v9, s[44:47], s13 offen lds
    s_mov_b32 m0, 107904
    s_add_u32 s13, s15, 120320
    buffer_load_dwordx4 v9, s[44:47], s13 offen lds
    s_mov_b32 m0, 108864
    s_add_u32 s13, s15, 124160
    buffer_load_dwordx4 v9, s[44:47], s13 offen lds
    s_mov_b32 m0, 109824
    s_add_u32 s13, s15, 128000
    buffer_load_dwordx4 v9, s[44:47], s13 offen lds
    s_mov_b32 m0, 110784
    s_add_u32 s13, s15, 131840
    buffer_load_dwordx4 v9, s[44:47], s13 offen lds
    s_mov_b32 m0, 111744
    s_add_u32 s13, s15, 135680
    buffer_load_dwordx4 v9, s[44:47], s13 offen lds
    s_mov_b32 m0, 112704
    s_add_u32 s13, s15, 139520
    buffer_load_dwordx4 v9, s[44:47], s13 offen lds
    s_mov_b32 m0, 113664
    s_add_u32 s13, s15, 143360
    buffer_load_dwordx4 v9, s[44:47], s13 offen lds
    s_mov_b32 m0, 114624
    s_add_u32 s13, s15, 147200
    buffer_load_dwordx4 v9, s[44:47], s13 offen lds
    s_mov_b32 m0, 115584
    s_add_u32 s13, s15, 151040
    buffer_load_dwordx4 v9, s[44:47], s13 offen lds
    s_mov_b32 m0, 116544
    s_add_u32 s13, s15, 154880
    buffer_load_dwordx4 v9, s[44:47], s13 offen lds
    s_mov_b32 m0, 117504
    s_add_u32 s13, s15, 158720
    buffer_load_dwordx4 v9, s[44:47], s13 offen lds
    s_mov_b64 exec, 0xfffff
    s_mov_b32 m0, 118464
    s_add_u32 s13, s15, 162560
    buffer_load_dwordx4 v9, s[44:47], s13 offen lds
    s_mov_b64 exec, -1
    s_waitcnt vmcnt(22)
    v_mov_b32 v31, 9
    ds_write_b32 v29, v31 offset:108
    s_nop 0
LP25:
    ds_read_b96 v[4:6], v29 offset:48
    s_waitcnt lgkmcnt(0)
    v_min3_u32 v4, v4, v5, v6
    s_nop 0
    v_readfirstlane_b32 s12, v4
    s_nop 0
    s_cmp_ge_u32 s12, 28
    s_nop 2
    s_cbranch_scc1 LP25_ok
    s_sleep 1
    s_branch LP25
LP25_ok:
    s_add_u32 s15, s93, 1
    s_and_b32 s15, s15, 3
    s_mul_i32 s15, s15, 327680
    s_add_u32 s15, s15, s14
    s_xor_b32 s13, s95, 1
    s_mul_i32 s13, s13, 163840
    s_add_u32 s15, s15, s13
    s_mov_b32 exec_hi, 0xfffffff
    s_mov_b32 m0, 118784
    s_add_u32 s13, s15, 0
    buffer_load_dwordx4 v9, s[44:47], s13 offen lds
    s_mov_b32 m0, 119744
    s_add_u32 s13, s15, 3840
    buffer_load_dwordx4 v9, s[44:47], s13 offen lds
    s_mov_b32 m0, 120704
    s_add_u32 s13, s15, 7680
    buffer_load_dwordx4 v9, s[44:47], s13 offen lds
    s_mov_b32 m0, 121664
    s_add_u32 s13, s15, 11520
    buffer_load_dwordx4 v9, s[44:47], s13 offen lds
    s_mov_b32 m0, 122624
    s_add_u32 s13, s15, 15360
    buffer_load_dwordx4 v9, s[44:47], s13 offen lds
    s_mov_b32 m0, 123584
    s_add_u32 s13, s15, 19200
    buffer_load_dwordx4 v9, s[44:47], s13 offen lds
    s_mov_b32 m0, 124544
    s_add_u32 s13, s15, 23040
    buffer_load_dwordx4 v9, s[44:47], s13 offen lds
    s_mov_b32 m0, 125504
    s_add_u32 s13, s15, 26880
    buffer_load_dwordx4 v9, s[44:47], s13 offen lds
    s_mov_b32 m0, 126464
    s_add_u32 s13, s15, 30720
    buffer_load_dwordx4 v9, s[44:47], s13 offen lds
    s_mov_b32 m0, 127424
    s_add_u32 s13, s15, 34560
    buffer_load_dwordx4 v9, s[44:47], s13 offen lds
    s_mov_b32 m0, 128384
    s_add_u32 s13, s15, 38400
    buffer_load_dwordx4 v9, s[44:47], s13 offen lds
    s_mov_b32 m0, 129344
    s_add_u32 s13, s15, 42240
    buffer_load_dwordx4 v9, s[44:47], s13 offen lds
    s_mov_b32 m0, 130304
    s_add_u32 s13, s15, 46080
    buffer_load_dwordx4 v9, s[44:47], s13 offen lds
    s_mov_b32 m0, 131264
    s_add_u32 s13, s15, 49920
    buffer_load_dwordx4 v9, s[44:47], s13 offen lds
    s_mov_b32 m0, 132224
    s_add_u32 s13, s15, 53760
    buffer_load_dwordx4 v9, s[44:47], s13 offen lds
    s_mov_b32 m0, 133184
    s_add_u32 s13, s15, 57600
    buffer_load_dwordx4 v9, s[44:47], s13 offen lds
    s_mov_b32 m0, 134144
    s_add_u32 s13, s15, 61440
    buffer_load_dwordx4 v9, s[44:47], s13 offen lds
    s_mov_b32 m0, 135104
    s_add_u32 s13, s15, 65280
    buffer_load_dwordx4 v9, s[44:47], s13 offen lds
    s_mov_b32 m0, 136064
    s_add_u32 s13, s15, 69120
    buffer_load_dwordx4 v9, s[44:47], s13 offen lds
    s_mov_b32 m0, 137024
    s_add_u32 s13, s15, 72960
    buffer_load_dwordx4 v9, s[44:47], s13 offen lds
    s_mov_b32 m0, 137984
    s_add_u32 s13, s15, 76800
    buffer_load_dwordx4 v9, s[44:47], s13 offen lds
    s_mov_b64 exec, 0xfffff
    s_mov_b32 m0, 138944
    s_add_u32 s13, s15, 80640
    buffer_load_dwordx4 v9, s[44:47], s13 offen lds
    s_mov_b64 exec, -1
    s_waitcnt vmcnt(22)
    v_mov_b32 v31, 10
    ds_write_b32 v29, v31 offset:108
    s_waitcnt vmcnt(0)
    v_mov_b32 v31, 11
    ds_write_b32 v29, v31 offset:108
    s_nop 0
LP26:
    ds_read_b96 v[4:6], v29 offset:32
    s_waitcnt lgkmcnt(0)
    v_min3_u32 v4, v4, v5, v6
    s_nop 0
    v_readfirstlane_b32 s12, v4
    s_nop 0
    s_cmp_ge_u32 s12, 29
    s_nop 2
    s_cbranch_scc1 LP26_ok
    s_sleep 1
    s_branch LP26
LP26_ok:
    s_add_u32 s15, s93, 1
    s_and_b32 s15, s15, 3
    s_mul_i32 s15, s15, 327680
    s_add_u32 s15, s15, s14
    s_xor_b32 s13, s95, 1
    s_mul_i32 s13, s13, 163840
    s_add_u32 s15, s15, s13
    s_mov_b32 exec_hi, 0xfffffff
    s_mov_b32 m0, 73728
    s_add_u32 s13, s15, 81920
    buffer_load_dwordx4 v9, s[44:47], s13 offen lds
    s_mov_b32 m0, 74688
    s_add_u32 s13, s15, 85760
    buffer_load_dwordx4 v9, s[44:47], s13 offen lds
    s_mov_b32 m0, 75648
    s_add_u32 s13, s15, 89600
    buffer_load_dwordx4 v9, s[44:47], s13 offen lds
    s_mov_b32 m0, 76608
    s_add_u32 s13, s15, 93440
    buffer_load_dwordx4 v9, s[44:47], s13 offen lds
    s_mov_b32 m0, 77568
    s_add_u32 s13, s15, 97280
    buffer_load_dwordx4 v9, s[44:47], s13 offen lds
    s_mov_b32 m0, 78528
    s_add_u32 s13, s15, 101120
    buffer_load_dwordx4 v9, s[44:47], s13 offen lds
    s_mov_b32 m0, 79488
    s_add_u32 s13, s15, 104960
    buffer_load_dwordx4 v9, s[44:47], s13 offen lds
    s_mov_b32 m0, 80448
    s_add_u32 s13, s15, 108800
    buffer_load_dwordx4 v9, s[44:47], s13 offen lds
    s_mov_b32 m0, 81408
    s_add_u32 s13, s15, 112640
    buffer_load_dwordx4 v9, s[44:47], s13 offen lds
    s_mov_b32 m0, 82368
    s_add_u32 s13, s15, 116480
    buffer_load_dwordx4 v9, s[44:47], s13 offen lds
    s_mov_b32 m0, 83328
    s_add_u32 s13, s15, 120320
    buffer_load_dwordx4 v9, s[44:47], s13 offen lds
    s_mov_b32 m0, 84288
    s_add_u32 s13, s15, 124160
    buffer_load_dwordx4 v9, s[44:47], s13 offen lds
    s_mov_b32 m0, 85248
    s_add_u32 s13, s15, 128000
    buffer_load_dwordx4 v9, s[44:47], s13 offen lds
    s_mov_b32 m0, 86208
    s_add_u32 s13, s15, 131840
    buffer_load_dwordx4 v9, s[44:47], s13 offen lds
    s_mov_b32 m0, 87168
    s_add_u32 s13, s15, 135680
    buffer_load_dwordx4 v9, s[44:47], s13 offen lds
    s_mov_b32 m0, 88128
    s_add_u32 s13, s15, 139520
    buffer_load_dwordx4 v9, s[44:47], s13 offen lds
    s_mov_b32 m0, 89088
    s_add_u32 s13, s15, 143360
    buffer_load_dwordx4 v9, s[44:47], s13 offen lds
    s_mov_b32 m0, 90048
    s_add_u32 s13, s15, 147200
    buffer_load_dwordx4 v9, s[44:47], s13 offen lds
    s_mov_b32 m0, 91008
    s_add_u32 s13, s15, 151040
    buffer_load_dwordx4 v9, s[44:47], s13 offen lds
    s_mov_b32 m0, 91968
    s_add_u32 s13, s15, 154880
    buffer_load_dwordx4 v9, s[44:47], s13 offen lds
    s_mov_b32 m0, 92928
    s_add_u32 s13, s15, 158720
    buffer_load_dwordx4 v9, s[44:47], s13 offen lds
    s_mov_b64 exec, 0xfffff
    s_mov_b32 m0, 93888
    s_add_u32 s13, s15, 162560
    buffer_load_dwordx4 v9, s[44:47], s13 offen lds
    s_mov_b64 exec, -1
    s_waitcnt vmcnt(0)
    v_mov_b32 v31, 12
    ds_write_b32 v29, v31 offset:108
    s_nop 0
LP27:
    ds_read_b96 v[4:6], v29 offset:32
    s_waitcnt lgkmcnt(0)
    v_min3_u32 v4, v4, v5, v6
    s_nop 0
    v_readfirstlane_b32 s12, v4
    s_nop 0
    s_cmp_ge_u32 s12, 31
    s_nop 2
    s_cbranch_scc1 LP27_ok
    s_sleep 1
    s_branch LP27
LP27_ok:
    s_add_u32 s15, s93, 2
    s_and_b32 s15, s15, 3
    s_mul_i32 s15, s15, 327680
    s_add_u32 s15, s15, s14
    s_xor_b32 s13, s95, 1
    s_mul_i32 s13, s13, 163840
    s_add_u32 s15, s15, s13
    s_mov_b32 exec_hi, 0xfffffff
    s_mov_b32 m0, 0
    s_add_u32 s13, s15, 0
    buffer_load_dwordx4 v9, s[44:47], s13 offen lds
    s_mov_b32 m0, 960
    s_add_u32 s13, s15, 3840
    buffer_load_dwordx4 v9, s[44:47], s13 offen lds
    s_mov_b32 m0, 1920
    s_add_u32 s13, s15, 7680
    buffer_load_dwordx4 v9, s[44:47], s13 offen lds
    s_mov_b32 m0, 2880
    s_add_u32 s13, s15, 11520
    buffer_load_dwordx4 v9, s[44:47], s13 offen lds
    s_mov_b32 m0, 3840
    s_add_u32 s13, s15, 15360
    buffer_load_dwordx4 v9, s[44:47], s13 offen lds
    s_mov_b32 m0, 4800
    s_add_u32 s13, s15, 19200
    buffer_load_dwordx4 v9, s[44:47], s13 offen lds
    s_mov_b32 m0, 5760
    s_add_u32 s13, s15, 23040
    buffer_load_dwordx4 v9, s[44:47], s13 offen lds
    s_mov_b32 m0, 6720
    s_add_u32 s13, s15, 26880
    buffer_load_dwordx4 v9, s[44:47], s13 offen lds
    s_mov_b32 m0, 7680
    s_add_u32 s13, s15, 30720
    buffer_load_dwordx4 v9, s[44:47], s13 offen lds
    s_mov_b32 m0, 8640
    s_add_u32 s13, s15, 34560
    buffer_load_dwordx4 v9, s[44:47], s13 offen lds
    s_mov_b32 m0, 9600
    s_add_u32 s13, s15, 38400
    buffer_load_dwordx4 v9, s[44:47], s13 offen lds
    s_mov_b32 m0, 10560
    s_add_u32 s13, s15, 42240
    buffer_load_dwordx4 v9, s[44:47], s13 offen lds
    s_mov_b32 m0, 11520
    s_add_u32 s13, s15, 46080
    buffer_load_dwordx4 v9, s[44:47], s13 offen lds
    s_mov_b32 m0, 12480
    s_add_u32 s13, s15, 49920
    buffer_load_dwordx4 v9, s[44:47], s13 offen lds
    s_mov_b32 m0, 13440
    s_add_u32 s13, s15, 53760
    buffer_load_dwordx4 v9, s[44:47], s13 offen lds
    s_mov_b32 m0, 14400
    s_add_u32 s13, s15, 57600
    buffer_load_dwordx4 v9, s[44:47], s13 offen lds
    s_mov_b32 m0, 15360
    s_add_u32 s13, s15, 61440
    buffer_load_dwordx4 v9, s[44:47], s13 offen lds
    s_mov_b32 m0, 16320
    s_add_u32 s13, s15, 65280
    buffer_load_dwordx4 v9, s[44:47], s13 offen lds
    s_mov_b32 m0, 17280
    s_add_u32 s13, s15, 69120
    buffer_load_dwordx4 v9, s[44:47], s13 offen lds
    s_mov_b32 m0, 18240
    s_add_u32 s13, s15, 72960
    buffer_load_dwordx4 v9, s[44:47], s13 offen lds
    s_mov_b32 m0, 19200
    s_add_u32 s13, s15, 76800
    buffer_load_dwordx4 v9, s[44:47], s13 offen lds
    s_mov_b64 exec, 0xfffff
    s_mov_b32 m0, 20160
    s_add_u32 s13, s15, 80640
    buffer_load_dwordx4 v9, s[44:47], s13 offen lds
    s_mov_b64 exec, -1
    s_waitcnt vmcnt(0)
    v_mov_b32 v31, 13
    ds_write_b32 v29, v31 offset:108
    s_nop 0
LP28:
    ds_read_b96 v[4:6], v29 offset:32
    s_waitcnt lgkmcnt(0)
    v_min3_u32 v4, v4, v5, v6
    s_nop 0
    v_readfirstlane_b32 s12, v4
    s_nop 0
    s_cmp_ge_u32 s12, 32
    s_nop 2
    s_cbranch_scc1 LP28_ok
    s_sleep 1
    s_branch LP28
LP28_ok:
    s_add_u32 s15, s93, 2
    s_and_b32 s15, s15, 3
    s_mul_i32 s15, s15, 327680
    s_add_u32 s15, s15, s14
    s_xor_b32 s13, s95, 1
    s_mul_i32 s13, s13, 163840
    s_add_u32 s15, s15, s13
    s_mov_b32 exec_hi, 0xfffffff
    s_mov_b32 m0, 20480
    s_add_u32 s13, s15, 81920
    buffer_load_dwordx4 v9, s[44:47], s13 offen lds
    s_mov_b32 m0, 21440
    s_add_u32 s13, s15, 85760
    buffer_load_dwordx4 v9, s[44:47], s13 offen lds
    s_mov_b32 m0, 22400
    s_add_u32 s13, s15, 89600
    buffer_load_dwordx4 v9, s[44:47], s13 offen lds
    s_mov_b32 m0, 23360
    s_add_u32 s13, s15, 93440
    buffer_load_dwordx4 v9, s[44:47], s13 offen lds
    s_mov_b32 m0, 24320
    s_add_u32 s13, s15, 97280
    buffer_load_dwordx4 v9, s[44:47], s13 offen lds
    s_mov_b32 m0, 25280
    s_add_u32 s13, s15, 101120
    buffer_load_dwordx4 v9, s[44:47], s13 offen lds
    s_mov_b32 m0, 26240
    s_add_u32 s13, s15, 104960
    buffer_load_dwordx4 v9, s[44:47], s13 offen lds
    s_mov_b32 m0, 27200
    s_add_u32 s13, s15, 108800
    buffer_load_dwordx4 v9, s[44:47], s13 offen lds
    s_mov_b32 m0, 28160
    s_add_u32 s13, s15, 112640
    buffer_load_dwordx4 v9, s[44:47], s13 offen lds
    s_mov_b32 m0, 29120
    s_add_u32 s13, s15, 116480
    buffer_load_dwordx4 v9, s[44:47], s13 offen lds
    s_mov_b32 m0, 30080
    s_add_u32 s13, s15, 120320
    buffer_load_dwordx4 v9, s[44:47], s13 offen lds
    s_mov_b32 m0, 31040
    s_add_u32 s13, s15, 124160
    buffer_load_dwordx4 v9, s[44:47], s13 offen lds
    s_mov_b32 m0, 32000
    s_add_u32 s13, s15, 128000
    buffer_load_dwordx4 v9, s[44:47], s13 offen lds
    s_mov_b32 m0, 32960
    s_add_u32 s13, s15, 131840
    buffer_load_dwordx4 v9, s[44:47], s13 offen lds
    s_mov_b32 m0, 33920
    s_add_u32 s13, s15, 135680
    buffer_load_dwordx4 v9, s[44:47], s13 offen lds
    s_mov_b32 m0, 34880
    s_add_u32 s13, s15, 139520
    buffer_load_dwordx4 v9, s[44:47], s13 offen lds
    s_mov_b32 m0, 35840
    s_add_u32 s13, s15, 143360
    buffer_load_dwordx4 v9, s[44:47], s13 offen lds
    s_mov_b32 m0, 36800
    s_add_u32 s13, s15, 147200
    buffer_load_dwordx4 v9, s[44:47], s13 offen lds
    s_mov_b32 m0, 37760
    s_add_u32 s13, s15, 151040
    buffer_load_dwordx4 v9, s[44:47], s13 offen lds
    s_mov_b32 m0, 38720
    s_add_u32 s13, s15, 154880
    buffer_load_dwordx4 v9, s[44:47], s13 offen lds
    s_mov_b32 m0, 39680
    s_add_u32 s13, s15, 158720
    buffer_load_dwordx4 v9, s[44:47], s13 offen lds
    s_mov_b64 exec, 0xfffff
    s_mov_b32 m0, 40640
    s_add_u32 s13, s15, 162560
    buffer_load_dwordx4 v9, s[44:47], s13 offen lds
    s_mov_b64 exec, -1
LP29:
    ds_read_b96 v[4:6], v29 offset:48
    s_waitcnt lgkmcnt(0)
    v_min3_u32 v4, v4, v5, v6
    s_nop 0
    v_readfirstlane_b32 s12, v4
    s_nop 0
    s_cmp_ge_u32 s12, 29
    s_nop 2
    s_cbranch_scc1 LP29_ok
    s_sleep 1
    s_branch LP29
LP29_ok:
    s_add_u32 s15, s93, 3
    s_and_b32 s15, s15, 3
    s_mul_i32 s15, s15, 327680
    s_add_u32 s15, s15, s14
    s_xor_b32 s13, s95, 1
    s_mul_i32 s13, s13, 163840
    s_add_u32 s15, s15, s13
    s_mov_b32 exec_hi, 0xfffffff
    s_mov_b32 m0, 139264
    s_add_u32 s13, s15, 0
    buffer_load_dwordx4 v9, s[44:47], s13 offen lds
    s_mov_b32 m0, 140224
    s_add_u32 s13, s15, 3840
    buffer_load_dwordx4 v9, s[44:47], s13 offen lds
    s_mov_b32 m0, 141184
    s_add_u32 s13, s15, 7680
    buffer_load_dwordx4 v9, s[44:47], s13 offen lds
    s_mov_b32 m0, 142144
    s_add_u32 s13, s15, 11520
    buffer_load_dwordx4 v9, s[44:47], s13 offen lds
    s_mov_b32 m0, 143104
    s_add_u32 s13, s15, 15360
    buffer_load_dwordx4 v9, s[44:47], s13 offen lds
    s_mov_b32 m0, 144064
    s_add_u32 s13, s15, 19200
    buffer_load_dwordx4 v9, s[44:47], s13 offen lds
    s_mov_b32 m0, 145024
    s_add_u32 s13, s15, 23040
    buffer_load_dwordx4 v9, s[44:47], s13 offen lds
    s_mov_b32 m0, 145984
    s_add_u32 s13, s15, 26880
    buffer_load_dwordx4 v9, s[44:47], s13 offen lds
    s_mov_b32 m0, 146944
    s_add_u32 s13, s15, 30720
    buffer_load_dwordx4 v9, s[44:47], s13 offen lds
    s_mov_b32 m0, 147904
    s_add_u32 s13, s15, 34560
    buffer_load_dwordx4 v9, s[44:47], s13 offen lds
    s_mov_b32 m0, 148864
    s_add_u32 s13, s15, 38400
    buffer_load_dwordx4 v9, s[44:47], s13 offen lds
    s_mov_b32 m0, 149824
    s_add_u32 s13, s15, 42240
    buffer_load_dwordx4 v9, s[44:47], s13 offen lds
    s_mov_b32 m0, 150784
    s_add_u32 s13, s15, 46080
    buffer_load_dwordx4 v9, s[44:47], s13 offen lds
    s_mov_b32 m0, 151744
    s_add_u32 s13, s15, 49920
    buffer_load_dwordx4 v9, s[44:47], s13 offen lds
    s_mov_b32 m0, 152704
    s_add_u32 s13, s15, 53760
    buffer_load_dwordx4 v9, s[44:47], s13 offen lds
    s_mov_b32 m0, 153664
    s_add_u32 s13, s15, 57600
    buffer_load_dwordx4 v9, s[44:47], s13 offen lds
    s_mov_b32 m0, 154624
    s_add_u32 s13, s15, 61440
    buffer_load_dwordx4 v9, s[44:47], s13 offen lds
    s_mov_b32 m0, 155584
    s_add_u32 s13, s15, 65280
    buffer_load_dwordx4 v9, s[44:47], s13 offen lds
    s_mov_b32 m0, 156544
    s_add_u32 s13, s15, 69120
    buffer_load_dwordx4 v9, s[44:47], s13 offen lds
    s_mov_b32 m0, 157504
    s_add_u32 s13, s15, 72960
    buffer_load_dwordx4 v9, s[44:47], s13 offen lds
    s_mov_b32 m0, 158464
    s_add_u32 s13, s15, 76800
    buffer_load_dwordx4 v9, s[44:47], s13 offen lds
    s_mov_b64 exec, 0xfffff
    s_mov_b32 m0, 159424
    s_add_u32 s13, s15, 80640
    buffer_load_dwordx4 v9, s[44:47], s13 offen lds
    s_mov_b64 exec, -1
    s_waitcnt vmcnt(22)
    v_mov_b32 v31, 14
    ds_write_b32 v29, v31 offset:108
    s_nop 0
LP30:
    ds_read_b96 v[4:6], v29 offset:48
    s_waitcnt lgkmcnt(0)
    v_min3_u32 v4, v4, v5, v6
    s_nop 0
    v_readfirstlane_b32 s12, v4
    s_nop 0
    s_cmp_ge_u32 s12, 30
    s_nop 2
    s_cbranch_scc1 LP30_ok
    s_sleep 1
    s_branch LP30
LP30_ok:
    s_add_u32 s15, s93, 3
    s_and_b32 s15, s15, 3
    s_mul_i32 s15, s15, 327680
    s_add_u32 s15, s15, s14
    s_xor_b32 s13, s95, 1
    s_mul_i32 s13, s13, 163840
    s_add_u32 s15, s15, s13
    s_mov_b32 exec_hi, 0xfffffff
    s_mov_b32 m0, 98304
    s_add_u32 s13, s15, 81920
    buffer_load_dwordx4 v9, s[44:47], s13 offen lds
    s_mov_b32 m0, 99264
    s_add_u32 s13, s15, 85760
    buffer_load_dwordx4 v9, s[44:47], s13 offen lds
    s_mov_b32 m0, 100224
    s_add_u32 s13, s15, 89600
    buffer_load_dwordx4 v9, s[44:47], s13 offen lds
    s_mov_b32 m0, 101184
    s_add_u32 s13, s15, 93440
    buffer_load_dwordx4 v9, s[44:47], s13 offen lds
    s_mov_b32 m0, 102144
    s_add_u32 s13, s15, 97280
    buffer_load_dwordx4 v9, s[44:47], s13 offen lds
    s_mov_b32 m0, 103104
    s_add_u32 s13, s15, 101120
    buffer_load_dwordx4 v9, s[44:47], s13 offen lds
    s_mov_b32 m0, 104064
    s_add_u32 s13, s15, 104960
    buffer_load_dwordx4 v9, s[44:47], s13 offen lds
    s_mov_b32 m0, 105024
    s_add_u32 s13, s15, 108800
    buffer_load_dwordx4 v9, s[44:47], s13 offen lds
    s_mov_b32 m0, 105984
    s_add_u32 s13, s15, 112640
    buffer_load_dwordx4 v9, s[44:47], s13 offen lds
    s_mov_b32 m0, 106944
    s_add_u32 s13, s15, 116480
    buffer_load_dwordx4 v9, s[44:47], s13 offen lds
    s_mov_b32 m0, 107904
    s_add_u32 s13, s15, 120320
    buffer_load_dwordx4 v9, s[44:47], s13 offen lds
    s_mov_b32 m0, 108864
    s_add_u32 s13, s15, 124160
    buffer_load_dwordx4 v9, s[44:47], s13 offen lds
    s_mov_b32 m0, 109824
    s_add_u32 s13, s15, 128000
    buffer_load_dwordx4 v9, s[44:47], s13 offen lds
    s_mov_b32 m0, 110784
    s_add_u32 s13, s15, 131840
    buffer_load_dwordx4 v9, s[44:47], s13 offen lds
    s_mov_b32 m0, 111744
    s_add_u32 s13, s15, 135680
    buffer_load_dwordx4 v9, s[44:47], s13 offen lds
    s_mov_b32 m0, 112704
    s_add_u32 s13, s15, 139520
    buffer_load_dwordx4 v9, s[44:47], s13 offen lds
    s_mov_b32 m0, 113664
    s_add_u32 s13, s15, 143360
    buffer_load_dwordx4 v9, s[44:47], s13 offen lds
    s_mov_b32 m0, 114624
    s_add_u32 s13, s15, 147200
    buffer_load_dwordx4 v9, s[44:47], s13 offen lds
    s_mov_b32 m0, 115584
    s_add_u32 s13, s15, 151040
    buffer_load_dwordx4 v9, s[44:47], s13 offen lds
    s_mov_b32 m0, 116544
    s_add_u32 s13, s15, 154880
    buffer_load_dwordx4 v9, s[44:47], s13 offen lds
    s_mov_b32 m0, 117504
    s_add_u32 s13, s15, 158720
    buffer_load_dwordx4 v9, s[44:47], s13 offen lds
    s_mov_b64 exec, 0xfffff
    s_mov_b32 m0, 118464
    s_add_u32 s13, s15, 162560
    buffer_load_dwordx4 v9, s[44:47], s13 offen lds
    s_mov_b64 exec, -1
    s_waitcnt vmcnt(22)
    v_mov_b32 v31, 15
    ds_write_b32 v29, v31 offset:108
    s_waitcnt vmcnt(0)
    v_mov_b32 v31, 16
    ds_write_b32 v29, v31 offset:108
    s_endpgm
LA_kv:
    s_mov_b32 s36, s18
    s_and_b32 s37, s19, 0xffff
    s_mov_b32 s38, 67108864
    s_mov_b32 s39, 0x20000
    s_mov_b32 s40, s20
    s_and_b32 s41, s21, 0xffff
    s_mov_b32 s42, 67108864
    s_mov_b32 s43, 0x20000
    s_lshl_b32 s11, s6, 5
    s_add_u32 s11, s11, s7
    s_lshl_b32 s11, s11, 17
    v_xor_b32 v3, v2, v1
    v_lshlrev_b32 v3, 4, v3
    v_lshl_add_u32 v4, v1, 8, v3
    v_xor_b32 v5, 64, v4
    v_xor_b32 v6, 0x80, v4
    v_xor_b32 v7, 0xc0, v4
    v_lshlrev_b32 v3, 2, v1
    v_xor_b32 v2, v2, v3
    v_lshlrev_b32 v2, 4, v2
    v_lshl_add_u32 v8, v1, 8, v2
    v_mov_b32 v29, 163584
    s_barrier
    s_cmp_eq_u32 s2, 0
    s_cbranch_scc0 LA_nononce
    s_memrealtime s[12:13]
    s_waitcnt lgkmcnt(0)
    s_or_b32 s12, s12, 1
    v_mov_b32 v12, s12
    s_mov_b64 exec, 1
    buffer_store_dword v12, off, s[88:91], 0 sc1
    s_mov_b64 exec, -1
LA_nononce:
    v_lshlrev_b32 v16, 7, v0
    s_nop 1
LP31:
    ds_read_b32 v12, v29 offset:8
    s_waitcnt lgkmcnt(0)
    v_readfirstlane_b32 s12, v12
    s_nop 0
    s_cmp_ge_u32 s12, 1
    s_nop 2
    s_cbranch_scc1 LP31_ok
    s_sleep 1
    s_branch LP31
LP31_ok:
    s_xor_b32 s10, s95, 0
    s_lshl_b32 s10, s10, 17
    s_add_u32 s10, s10, s11
    s_lshr_b32 s13, s6, 1
    s_and_b32 s13, s13, 1
    s_xor_b32 s13, s13, 0
    s_lshl_b32 s13, s13, 16
    s_add_u32 s10, s10, s13
    s_mov_b32 m0, 16384
    s_add_u32 s13, s10, 0
    buffer_load_dwordx4 v4, s[36:39], s13 offen offset:0 nt lds
    buffer_load_dwordx4 v5, s[36:39], s13 offen offset:1024 nt lds
    buffer_load_dwordx4 v6, s[36:39], s13 offen offset:2048 nt lds
    buffer_load_dwordx4 v7, s[36:39], s13 offen offset:3072 nt lds
    s_mov_b32 m0, 20480
    s_add_u32 s13, s10, 4096
    buffer_load_dwordx4 v4, s[36:39], s13 offen offset:0 nt lds
    buffer_load_dwordx4 v5, s[36:39], s13 offen offset:1024 nt lds
    buffer_load_dwordx4 v6, s[36:39], s13 offen offset:2048 nt lds
    buffer_load_dwordx4 v7, s[36:39], s13 offen offset:3072 nt lds
    s_mov_b32 m0, 24576
    s_add_u32 s13, s10, 8192
    buffer_load_dwordx4 v4, s[36:39], s13 offen offset:0 nt lds
    buffer_load_dwordx4 v5, s[36:39], s13 offen offset:1024 nt lds
    buffer_load_dwordx4 v6, s[36:39], s13 offen offset:2048 nt lds
    buffer_load_dwordx4 v7, s[36:39], s13 offen offset:3072 nt lds
    s_mov_b32 m0, 28672
    s_add_u32 s13, s10, 12288
    buffer_load_dwordx4 v4, s[36:39], s13 offen offset:0 nt lds
    buffer_load_dwordx4 v5, s[36:39], s13 offen offset:1024 nt lds
    buffer_load_dwordx4 v6, s[36:39], s13 offen offset:2048 nt lds
    buffer_load_dwordx4 v7, s[36:39], s13 offen offset:3072 nt lds
    buffer_load_dword v17, off, s[40:43], s11
    s_mov_b32 m0, 32768
    s_add_u32 s13, s10, 16384
    buffer_load_dwordx4 v4, s[36:39], s13 offen offset:0 nt lds
    buffer_load_dwordx4 v5, s[36:39], s13 offen offset:1024 nt lds
    buffer_load_dwordx4 v6, s[36:39], s13 offen offset:2048 nt lds
    buffer_load_dwordx4 v7, s[36:39], s13 offen offset:3072 nt lds
    s_mov_b32 m0, 36864
    s_add_u32 s13, s10, 20480
    buffer_load_dwordx4 v4, s[36:39], s13 offen offset:0 nt lds
    buffer_load_dwordx4 v5, s[36:39], s13 offen offset:1024 nt lds
    buffer_load_dwordx4 v6, s[36:39], s13 offen offset:2048 nt lds
    buffer_load_dwordx4 v7, s[36:39], s13 offen offset:3072 nt lds
    s_mov_b32 m0, 40960
    s_add_u32 s13, s10, 24576
    buffer_load_dwordx4 v4, s[36:39], s13 offen offset:0 nt lds
    buffer_load_dwordx4 v5, s[36:39], s13 offen offset:1024 nt lds
    buffer_load_dwordx4 v6, s[36:39], s13 offen offset:2048 nt lds
    buffer_load_dwordx4 v7, s[36:39], s13 offen offset:3072 nt lds
    s_mov_b32 m0, 45056
    s_add_u32 s13, s10, 28672
    buffer_load_dwordx4 v4, s[36:39], s13 offen offset:0 nt lds
    buffer_load_dwordx4 v5, s[36:39], s13 offen offset:1024 nt lds
    buffer_load_dwordx4 v6, s[36:39], s13 offen offset:2048 nt lds
    buffer_load_dwordx4 v7, s[36:39], s13 offen offset:3072 nt lds
    s_waitcnt vmcnt(17)
    v_mov_b32 v31, 1
    ds_write_b32 v29, v31 offset:0
    s_nop 0
LP32:
    ds_read_b96 v[12:14], v29 offset:96
    s_waitcnt lgkmcnt(0)
    v_min3_u32 v12, v12, v13, v14
    s_nop 0
    v_readfirstlane_b32 s12, v12
    s_nop 0
    s_cmp_ge_u32 s12, 5
    s_nop 2
    s_cbranch_scc1 LP32_ok
    s_sleep 1
    s_branch LP32
LP32_ok:
LP33:
    ds_read_b96 v[12:14], v29 offset:112
    s_waitcnt lgkmcnt(0)
    v_min3_u32 v12, v12, v13, v14
    s_nop 0
    v_readfirstlane_b32 s12, v12
    s_nop 0
    s_cmp_ge_u32 s12, 5
    s_nop 2
    s_cbranch_scc1 LP33_ok
    s_sleep 1
    s_branch LP33
LP33_ok:
    s_mov_b32 m0, 49152
    s_add_u32 s13, s10, 32768
    buffer_load_dwordx4 v4, s[36:39], s13 offen offset:0 nt lds
    buffer_load_dwordx4 v5, s[36:39], s13 offen offset:1024 nt lds
    buffer_load_dwordx4 v6, s[36:39], s13 offen offset:2048 nt lds
    buffer_load_dwordx4 v7, s[36:39], s13 offen offset:3072 nt lds
    s_mov_b32 m0, 53248
    s_add_u32 s13, s10, 36864
    buffer_load_dwordx4 v4, s[36:39], s13 offen offset:0 nt lds
    buffer_load_dwordx4 v5, s[36:39], s13 offen offset:1024 nt lds
    buffer_load_dwordx4 v6, s[36:39], s13 offen offset:2048 nt lds
    buffer_load_dwordx4 v7, s[36:39], s13 offen offset:3072 nt lds
    s_mov_b32 m0, 57344
    s_add_u32 s13, s10, 40960
    buffer_load_dwordx4 v4, s[36:39], s13 offen offset:0 nt lds
    buffer_load_dwordx4 v5, s[36:39], s13 offen offset:1024 nt lds
    buffer_load_dwordx4 v6, s[36:39], s13 offen offset:2048 nt lds
    buffer_load_dwordx4 v7, s[36:39], s13 offen offset:3072 nt lds
    s_mov_b32 m0, 61440
    s_add_u32 s13, s10, 45056
    buffer_load_dwordx4 v4, s[36:39], s13 offen offset:0 nt lds
    buffer_load_dwordx4 v5, s[36:39], s13 offen offset:1024 nt lds
    buffer_load_dwordx4 v6, s[36:39], s13 offen offset:2048 nt lds
    buffer_load_dwordx4 v7, s[36:39], s13 offen offset:3072 nt lds
    s_waitcnt vmcnt(16)
    v_mov_b32 v31, 2
    ds_write_b32 v29, v31 offset:0
    s_mov_b32 m0, 65536
    s_add_u32 s13, s10, 49152
    buffer_load_dwordx4 v4, s[36:39], s13 offen offset:0 nt lds
    buffer_load_dwordx4 v5, s[36:39], s13 offen offset:1024 nt lds
    buffer_load_dwordx4 v6, s[36:39], s13 offen offset:2048 nt lds
    buffer_load_dwordx4 v7, s[36:39], s13 offen offset:3072 nt lds
    s_mov_b32 m0, 69632
    s_add_u32 s13, s10, 53248
    buffer_load_dwordx4 v4, s[36:39], s13 offen offset:0 nt lds
    buffer_load_dwordx4 v5, s[36:39], s13 offen offset:1024 nt lds
    buffer_load_dwordx4 v6, s[36:39], s13 offen offset:2048 nt lds
    buffer_load_dwordx4 v7, s[36:39], s13 offen offset:3072 nt lds
    s_mov_b32 m0, 73728
    s_add_u32 s13, s10, 57344
    buffer_load_dwordx4 v4, s[36:39], s13 offen offset:0 nt lds
    buffer_load_dwordx4 v5, s[36:39], s13 offen offset:1024 nt lds
    buffer_load_dwordx4 v6, s[36:39], s13 offen offset:2048 nt lds
    buffer_load_dwordx4 v7, s[36:39], s13 offen offset:3072 nt lds
    s_mov_b32 m0, 77824
    s_add_u32 s13, s10, 61440
    buffer_load_dwordx4 v4, s[36:39], s13 offen offset:0 nt lds
    buffer_load_dwordx4 v5, s[36:39], s13 offen offset:1024 nt lds
    buffer_load_dwordx4 v6, s[36:39], s13 offen offset:2048 nt lds
    buffer_load_dwordx4 v7, s[36:39], s13 offen offset:3072 nt lds
    s_waitcnt vmcnt(16)
    v_mov_b32 v31, 3
    ds_write_b32 v29, v31 offset:0
    s_mov_b32 m0, 81920
    s_add_u32 s13, s10, 0
    buffer_load_dwordx4 v8, s[40:43], s13 offen offset:0 nt lds
    buffer_load_dwordx4 v8, s[40:43], s13 offen offset:1024 nt lds
    buffer_load_dwordx4 v8, s[40:43], s13 offen offset:2048 nt lds
    buffer_load_dwordx4 v8, s[40:43], s13 offen offset:3072 nt lds
    s_mov_b32 m0, 86016
    s_add_u32 s13, s10, 4096
    buffer_load_dwordx4 v8, s[40:43], s13 offen offset:0 nt lds
    buffer_load_dwordx4 v8, s[40:43], s13 offen offset:1024 nt lds
    buffer_load_dwordx4 v8, s[40:43], s13 offen offset:2048 nt lds
    buffer_load_dwordx4 v8, s[40:43], s13 offen offset:3072 nt lds
    s_mov_b32 m0, 90112
    s_add_u32 s13, s10, 8192
    buffer_load_dwordx4 v8, s[40:43], s13 offen offset:0 nt lds
    buffer_load_dwordx4 v8, s[40:43], s13 offen offset:1024 nt lds
    buffer_load_dwordx4 v8, s[40:43], s13 offen offset:2048 nt lds
    buffer_load_dwordx4 v8, s[40:43], s13 offen offset:3072 nt lds
    s_mov_b32 m0, 94208
    s_add_u32 s13, s10, 12288
    buffer_load_dwordx4 v8, s[40:43], s13 offen offset:0 nt lds
    buffer_load_dwordx4 v8, s[40:43], s13 offen offset:1024 nt lds
    buffer_load_dwordx4 v8, s[40:43], s13 offen offset:2048 nt lds
    buffer_load_dwordx4 v8, s[40:43], s13 offen offset:3072 nt lds
    s_waitcnt vmcnt(16)
    v_mov_b32 v31, 4
    ds_write_b32 v29, v31 offset:0
    s_nop 0
LP34:
    ds_read_b96 v[12:14], v29 offset:48
    s_waitcnt lgkmcnt(0)
    v_min3_u32 v12, v12, v13, v14
    s_nop 0
    v_readfirstlane_b32 s12, v12
    s_nop 0
    s_cmp_ge_u32 s12, 8
    s_nop 2
    s_cbranch_scc1 LP34_ok
    s_sleep 1
    s_branch LP34
LP34_ok:
    s_mov_b32 m0, 0
    s_add_u32 s13, s10, 16384
    buffer_load_dwordx4 v8, s[40:43], s13 offen offset:0 nt lds
    buffer_load_dwordx4 v8, s[40:43], s13 offen offset:1024 nt lds
    buffer_load_dwordx4 v8, s[40:43], s13 offen offset:2048 nt lds
    buffer_load_dwordx4 v8, s[40:43], s13 offen offset:3072 nt lds
    s_mov_b32 m0, 4096
    s_add_u32 s13, s10, 20480
    buffer_load_dwordx4 v8, s[40:43], s13 offen offset:0 nt lds
    buffer_load_dwordx4 v8, s[40:43], s13 offen offset:1024 nt lds
    buffer_load_dwordx4 v8, s[40:43], s13 offen offset:2048 nt lds
    buffer_load_dwordx4 v8, s[40:43], s13 offen offset:3072 nt lds
    s_mov_b32 m0, 8192
    s_add_u32 s13, s10, 24576
    buffer_load_dwordx4 v8, s[40:43], s13 offen offset:0 nt lds
    buffer_load_dwordx4 v8, s[40:43], s13 offen offset:1024 nt lds
    buffer_load_dwordx4 v8, s[40:43], s13 offen offset:2048 nt lds
    buffer_load_dwordx4 v8, s[40:43], s13 offen offset:3072 nt lds
    s_mov_b32 m0, 12288
    s_add_u32 s13, s10, 28672
    buffer_load_dwordx4 v8, s[40:43], s13 offen offset:0 nt lds
    buffer_load_dwordx4 v8, s[40:43], s13 offen offset:1024 nt lds
    buffer_load_dwordx4 v8, s[40:43], s13 offen offset:2048 nt lds
    buffer_load_dwordx4 v8, s[40:43], s13 offen offset:3072 nt lds
    s_waitcnt vmcnt(16)
    v_mov_b32 v31, 5
    ds_write_b32 v29, v31 offset:0
    s_nop 0
LP35:
    ds_read_b96 v[12:14], v29 offset:16
    s_waitcnt lgkmcnt(0)
    v_min3_u32 v12, v12, v13, v14
    s_nop 0
    v_readfirstlane_b32 s12, v12
    s_nop 0
    s_cmp_ge_u32 s12, 1
    s_nop 2
    s_cbranch_scc1 LP35_ok
    s_sleep 1
    s_branch LP35
LP35_ok:
    s_mov_b32 m0, 16384
    s_add_u32 s13, s10, 32768
    buffer_load_dwordx4 v8, s[40:43], s13 offen offset:0 nt lds
    buffer_load_dwordx4 v8, s[40:43], s13 offen offset:1024 nt lds
    buffer_load_dwordx4 v8, s[40:43], s13 offen offset:2048 nt lds
    buffer_load_dwordx4 v8, s[40:43], s13 offen offset:3072 nt lds
    s_mov_b32 m0, 20480
    s_add_u32 s13, s10, 36864
    buffer_load_dwordx4 v8, s[40:43], s13 offen offset:0 nt lds
    buffer_load_dwordx4 v8, s[40:43], s13 offen offset:1024 nt lds
    buffer_load_dwordx4 v8, s[40:43], s13 offen offset:2048 nt lds
    buffer_load_dwordx4 v8, s[40:43], s13 offen offset:3072 nt lds
    s_mov_b32 m0, 24576
    s_add_u32 s13, s10, 40960
    buffer_load_dwordx4 v8, s[40:43], s13 offen offset:0 nt lds
    buffer_load_dwordx4 v8, s[40:43], s13 offen offset:1024 nt lds
    buffer_load_dwordx4 v8, s[40:43], s13 offen offset:2048 nt lds
    buffer_load_dwordx4 v8, s[40:43], s13 offen offset:3072 nt lds
    s_mov_b32 m0, 28672
    s_add_u32 s13, s10, 45056
    buffer_load_dwordx4 v8, s[40:43], s13 offen offset:0 nt lds
    buffer_load_dwordx4 v8, s[40:43], s13 offen offset:1024 nt lds
    buffer_load_dwordx4 v8, s[40:43], s13 offen offset:2048 nt lds
    buffer_load_dwordx4 v8, s[40:43], s13 offen offset:3072 nt lds
    s_mov_b32 s44, s24
    s_and_b32 s45, s25, 0xffff
    s_mov_b32 s46, 5242880
    s_mov_b32 s47, 0x20000
    s_mov_b32 s32, s26
    s_and_b32 s33, s27, 0xffff
    s_mov_b32 s34, 1966080
    s_mov_b32 s35, 0x20000
    s_mul_i32 s12, s6, 3
    s_lshl_b32 s12, s12, 4
    s_lshr_b32 s13, s7, 1
    s_add_u32 s12, s12, s13
    s_lshl_b32 s12, s12, 13
    v_and_b32 v18, 1, v0
    v_mul_u32_u24 v18, 6144, v18
    v_bfe_u32 v19, v0, 1, 1
    v_lshl_add_u32 v18, v19, 8, v18
    v_lshlrev_b32 v18, 10, v18
    s_lshl_b32 s13, s6, 2
    s_add_u32 s13, s13, s93
    s_mul_i32 s13, s13, 147456
    s_mul_i32 s14, s92, 15360
    s_add_u32 s13, s13, s14
    s_add_u32 s13, s13, 16777216
    v_mul_u32_u24 v20, 98304, v19
    s_mul_i32 s14, s92, 1310720
    v_mul_u32_u24 v21, 1310656, v19
    s_mul_i32 s15, s6, 122880
    s_mul_i32 s53, s92, 10240
    s_add_u32 s15, s15, s53
    s_mul_i32 s53, s93, 320
    s_add_u32 s15, s15, s53
    s_add_u32 s15, s15, 127
    s_andn2_b32 s15, s15, 127
    s_mov_b32 s53, 41967616
    buffer_load_dword v17, v18, s[48:51], s12 offen
    buffer_load_dword v17, v20, s[48:51], s13 offen
    buffer_load_dword v17, off, s[48:51], s53
    buffer_load_dword v17, v21, s[44:47], s14 offen
    buffer_load_dword v17, off, s[32:35], s15
    s_waitcnt vmcnt(21)
    v_mov_b32 v31, 6
    ds_write_b32 v29, v31 offset:0
    s_nop 0
LP36:
    ds_read_b96 v[12:14], v29 offset:16
    s_waitcnt lgkmcnt(0)
    v_min3_u32 v12, v12, v13, v14
    s_nop 0
    v_readfirstlane_b32 s12, v12
    s_nop 0
    s_cmp_ge_u32 s12, 2
    s_nop 2
    s_cbranch_scc1 LP36_ok
    s_sleep 1
    s_branch LP36
LP36_ok:
    s_mov_b32 m0, 32768
    s_add_u32 s13, s10, 49152
    buffer_load_dwordx4 v8, s[40:43], s13 offen offset:0 nt lds
    buffer_load_dwordx4 v8, s[40:43], s13 offen offset:1024 nt lds
    buffer_load_dwordx4 v8, s[40:43], s13 offen offset:2048 nt lds
    buffer_load_dwordx4 v8, s[40:43], s13 offen offset:3072 nt lds
    s_mov_b32 m0, 36864
    s_add_u32 s13, s10, 53248
    buffer_load_dwordx4 v8, s[40:43], s13 offen offset:0 nt lds
    buffer_load_dwordx4 v8, s[40:43], s13 offen offset:1024 nt lds
    buffer_load_dwordx4 v8, s[40:43], s13 offen offset:2048 nt lds
    buffer_load_dwordx4 v8, s[40:43], s13 offen offset:3072 nt lds
    s_mov_b32 m0, 40960
    s_add_u32 s13, s10, 57344
    buffer_load_dwordx4 v8, s[40:43], s13 offen offset:0 nt lds
    buffer_load_dwordx4 v8, s[40:43], s13 offen offset:1024 nt lds
    buffer_load_dwordx4 v8, s[40:43], s13 offen offset:2048 nt lds
    buffer_load_dwordx4 v8, s[40:43], s13 offen offset:3072 nt lds
    s_mov_b32 m0, 45056
    s_add_u32 s13, s10, 61440
    buffer_load_dwordx4 v8, s[40:43], s13 offen offset:0 nt lds
    buffer_load_dwordx4 v8, s[40:43], s13 offen offset:1024 nt lds
    buffer_load_dwordx4 v8, s[40:43], s13 offen offset:2048 nt lds
    buffer_load_dwordx4 v8, s[40:43], s13 offen offset:3072 nt lds
    s_waitcnt vmcnt(21)
    v_mov_b32 v31, 7
    ds_write_b32 v29, v31 offset:0
    s_nop 0
LP37:
    ds_read_b96 v[12:14], v29 offset:16
    s_waitcnt lgkmcnt(0)
    v_min3_u32 v12, v12, v13, v14
    s_nop 0
    v_readfirstlane_b32 s12, v12
    s_nop 0
    s_cmp_ge_u32 s12, 3
    s_nop 2
    s_cbranch_scc1 LP37_ok
    s_sleep 1
    s_branch LP37
LP37_ok:
    s_xor_b32 s10, s95, 0
    s_lshl_b32 s10, s10, 17
    s_add_u32 s10, s10, s11
    s_lshr_b32 s13, s6, 1
    s_and_b32 s13, s13, 1
    s_xor_b32 s13, s13, 1
    s_lshl_b32 s13, s13, 16
    s_add_u32 s10, s10, s13
    s_mov_b32 m0, 49152
    s_add_u32 s13, s10, 0
    buffer_load_dwordx4 v4, s[36:39], s13 offen offset:0 nt lds
    buffer_load_dwordx4 v5, s[36:39], s13 offen offset:1024 nt lds
    buffer_load_dwordx4 v6, s[36:39], s13 offen offset:2048 nt lds
    buffer_load_dwordx4 v7, s[36:39], s13 offen offset:3072 nt lds
    s_mov_b32 m0, 53248
    s_add_u32 s13, s10, 4096
    buffer_load_dwordx4 v4, s[36:39], s13 offen offset:0 nt lds
    buffer_load_dwordx4 v5, s[36:39], s13 offen offset:1024 nt lds
    buffer_load_dwordx4 v6, s[36:39], s13 offen offset:2048 nt lds
    buffer_load_dwordx4 v7, s[36:39], s13 offen offset:3072 nt lds
    s_mov_b32 m0, 57344
    s_add_u32 s13, s10, 8192
    buffer_load_dwordx4 v4, s[36:39], s13 offen offset:0 nt lds
    buffer_load_dwordx4 v5, s[36:39], s13 offen offset:1024 nt lds
    buffer_load_dwordx4 v6, s[36:39], s13 offen offset:2048 nt lds
    buffer_load_dwordx4 v7, s[36:39], s13 offen offset:3072 nt lds
    s_mov_b32 m0, 61440
    s_add_u32 s13, s10, 12288
    buffer_load_dwordx4 v4, s[36:39], s13 offen offset:0 nt lds
    buffer_load_dwordx4 v5, s[36:39], s13 offen offset:1024 nt lds
    buffer_load_dwordx4 v6, s[36:39], s13 offen offset:2048 nt lds
    buffer_load_dwordx4 v7, s[36:39], s13 offen offset:3072 nt lds
    s_waitcnt vmcnt(16)
    v_mov_b32 v31, 8
    ds_write_b32 v29, v31 offset:0
    s_nop 0
LP38:
    ds_read_b96 v[12:14], v29 offset:16
    s_waitcnt lgkmcnt(0)
    v_min3_u32 v12, v12, v13, v14
    s_nop 0
    v_readfirstlane_b32 s12, v12
    s_nop 0
    s_cmp_ge_u32 s12, 4
    s_nop 2
    s_cbranch_scc1 LP38_ok
    s_sleep 1
    s_branch LP38
LP38_ok:
    s_mov_b32 m0, 65536
    s_add_u32 s13, s10, 16384
    buffer_load_dwordx4 v4, s[36:39], s13 offen offset:0 nt lds
    buffer_load_dwordx4 v5, s[36:39], s13 offen offset:1024 nt lds
    buffer_load_dwordx4 v6, s[36:39], s13 offen offset:2048 nt lds
    buffer_load_dwordx4 v7, s[36:39], s13 offen offset:3072 nt lds
    s_mov_b32 m0, 69632
    s_add_u32 s13, s10, 20480
    buffer_load_dwordx4 v4, s[36:39], s13 offen offset:0 nt lds
    buffer_load_dwordx4 v5, s[36:39], s13 offen offset:1024 nt lds
    buffer_load_dwordx4 v6, s[36:39], s13 offen offset:2048 nt lds
    buffer_load_dwordx4 v7, s[36:39], s13 offen offset:3072 nt lds
    s_mov_b32 m0, 73728
    s_add_u32 s13, s10, 24576
    buffer_load_dwordx4 v4, s[36:39], s13 offen offset:0 nt lds
    buffer_load_dwordx4 v5, s[36:39], s13 offen offset:1024 nt lds
    buffer_load_dwordx4 v6, s[36:39], s13 offen offset:2048 nt lds
    buffer_load_dwordx4 v7, s[36:39], s13 offen offset:3072 nt lds
    s_mov_b32 m0, 77824
    s_add_u32 s13, s10, 28672
    buffer_load_dwordx4 v4, s[36:39], s13 offen offset:0 nt lds
    buffer_load_dwordx4 v5, s[36:39], s13 offen offset:1024 nt lds
    buffer_load_dwordx4 v6, s[36:39], s13 offen offset:2048 nt lds
    buffer_load_dwordx4 v7, s[36:39], s13 offen offset:3072 nt lds
    s_waitcnt vmcnt(16)
    v_mov_b32 v31, 9
    ds_write_b32 v29, v31 offset:0
    s_nop 0
LP39:
    ds_read_b96 v[12:14], v29 offset:16
    s_waitcnt lgkmcnt(0)
    v_min3_u32 v12, v12, v13, v14
    s_nop 0
    v_readfirstlane_b32 s12, v12
    s_nop 0
    s_cmp_ge_u32 s12, 5
    s_nop 2
    s_cbranch_scc1 LP39_ok
    s_sleep 1
    s_branch LP39
LP39_ok:
    s_mov_b32 m0, 81920
    s_add_u32 s13, s10, 32768
    buffer_load_dwordx4 v4, s[36:39], s13 offen offset:0 nt lds
    buffer_load_dwordx4 v5, s[36:39], s13 offen offset:1024 nt lds
    buffer_load_dwordx4 v6, s[36:39], s13 offen offset:2048 nt lds
    buffer_load_dwordx4 v7, s[36:39], s13 offen offset:3072 nt lds
    s_mov_b32 m0, 86016
    s_add_u32 s13, s10, 36864
    buffer_load_dwordx4 v4, s[36:39], s13 offen offset:0 nt lds
    buffer_load_dwordx4 v5, s[36:39], s13 offen offset:1024 nt lds
    buffer_load_dwordx4 v6, s[36:39], s13 offen offset:2048 nt lds
    buffer_load_dwordx4 v7, s[36:39], s13 offen offset:3072 nt lds
    s_mov_b32 m0, 90112
    s_add_u32 s13, s10, 40960
    buffer_load_dwordx4 v4, s[36:39], s13 offen offset:0 nt lds
    buffer_load_dwordx4 v5, s[36:39], s13 offen offset:1024 nt lds
    buffer_load_dwordx4 v6, s[36:39], s13 offen offset:2048 nt lds
    buffer_load_dwordx4 v7, s[36:39], s13 offen offset:3072 nt lds
    s_mov_b32 m0, 94208
    s_add_u32 s13, s10, 45056
    buffer_load_dwordx4 v4, s[36:39], s13 offen offset:0 nt lds
    buffer_load_dwordx4 v5, s[36:39], s13 offen offset:1024 nt lds
    buffer_load_dwordx4 v6, s[36:39], s13 offen offset:2048 nt lds
    buffer_load_dwordx4 v7, s[36:39], s13 offen offset:3072 nt lds
    s_waitcnt vmcnt(16)
    v_mov_b32 v31, 10
    ds_write_b32 v29, v31 offset:0
    s_nop 0
LP40:
    ds_read_b96 v[12:14], v29 offset:16
    s_waitcnt lgkmcnt(0)
    v_min3_u32 v12, v12, v13, v14
    s_nop 0
    v_readfirstlane_b32 s12, v12
    s_nop 0
    s_cmp_ge_u32 s12, 6
    s_nop 2
    s_cbranch_scc1 LP40_ok
    s_sleep 1
    s_branch LP40
LP40_ok:
    s_mov_b32 m0, 0
    s_add_u32 s13, s10, 49152
    buffer_load_dwordx4 v4, s[36:39], s13 offen offset:0 nt lds
    buffer_load_dwordx4 v5, s[36:39], s13 offen offset:1024 nt lds
    buffer_load_dwordx4 v6, s[36:39], s13 offen offset:2048 nt lds
    buffer_load_dwordx4 v7, s[36:39], s13 offen offset:3072 nt lds
    s_mov_b32 m0, 4096
    s_add_u32 s13, s10, 53248
    buffer_load_dwordx4 v4, s[36:39], s13 offen offset:0 nt lds
    buffer_load_dwordx4 v5, s[36:39], s13 offen offset:1024 nt lds
    buffer_load_dwordx4 v6, s[36:39], s13 offen offset:2048 nt lds
    buffer_load_dwordx4 v7, s[36:39], s13 offen offset:3072 nt lds
    s_mov_b32 m0, 8192
    s_add_u32 s13, s10, 57344
    buffer_load_dwordx4 v4, s[36:39], s13 offen offset:0 nt lds
    buffer_load_dwordx4 v5, s[36:39], s13 offen offset:1024 nt lds
    buffer_load_dwordx4 v6, s[36:39], s13 offen offset:2048 nt lds
    buffer_load_dwordx4 v7, s[36:39], s13 offen offset:3072 nt lds
    s_mov_b32 m0, 12288
    s_add_u32 s13, s10, 61440
    buffer_load_dwordx4 v4, s[36:39], s13 offen offset:0 nt lds
    buffer_load_dwordx4 v5, s[36:39], s13 offen offset:1024 nt lds
    buffer_load_dwordx4 v6, s[36:39], s13 offen offset:2048 nt lds
    buffer_load_dwordx4 v7, s[36:39], s13 offen offset:3072 nt lds
    s_waitcnt vmcnt(16)
    v_mov_b32 v31, 11
    ds_write_b32 v29, v31 offset:0
    s_nop 0
LP41:
    ds_read_b96 v[12:14], v29 offset:16
    s_waitcnt lgkmcnt(0)
    v_min3_u32 v12, v12, v13, v14
    s_nop 0
    v_readfirstlane_b32 s12, v12
    s_nop 0
    s_cmp_ge_u32 s12, 7
    s_nop 2
    s_cbranch_scc1 LP41_ok
    s_sleep 1
    s_branch LP41
LP41_ok:
    s_mov_b32 m0, 16384
    s_add_u32 s13, s10, 0
    buffer_load_dwordx4 v8, s[40:43], s13 offen offset:0 nt lds
    buffer_load_dwordx4 v8, s[40:43], s13 offen offset:1024 nt lds
    buffer_load_dwordx4 v8, s[40:43], s13 offen offset:2048 nt lds
    buffer_load_dwordx4 v8, s[40:43], s13 offen offset:3072 nt lds
    s_mov_b32 m0, 20480
    s_add_u32 s13, s10, 4096
    buffer_load_dwordx4 v8, s[40:43], s13 offen offset:0 nt lds
    buffer_load_dwordx4 v8, s[40:43], s13 offen offset:1024 nt lds
    buffer_load_dwordx4 v8, s[40:43], s13 offen offset:2048 nt lds
    buffer_load_dwordx4 v8, s[40:43], s13 offen offset:3072 nt lds
    s_mov_b32 m0, 24576
    s_add_u32 s13, s10, 8192
    buffer_load_dwordx4 v8, s[40:43], s13 offen offset:0 nt lds
    buffer_load_dwordx4 v8, s[40:43], s13 offen offset:1024 nt lds
    buffer_load_dwordx4 v8, s[40:43], s13 offen offset:2048 nt lds
    buffer_load_dwordx4 v8, s[40:43], s13 offen offset:3072 nt lds
    s_mov_b32 m0, 28672
    s_add_u32 s13, s10, 12288
    buffer_load_dwordx4 v8, s[40:43], s13 offen offset:0 nt lds
    buffer_load_dwordx4 v8, s[40:43], s13 offen offset:1024 nt lds
    buffer_load_dwordx4 v8, s[40:43], s13 offen offset:2048 nt lds
    buffer_load_dwordx4 v8, s[40:43], s13 offen offset:3072 nt lds
    s_waitcnt vmcnt(16)
    v_mov_b32 v31, 12
    ds_write_b32 v29, v31 offset:0
    s_nop 0
LP42:
    ds_read_b96 v[12:14], v29 offset:16
    s_waitcnt lgkmcnt(0)
    v_min3_u32 v12, v12, v13, v14
    s_nop 0
    v_readfirstlane_b32 s12, v12
    s_nop 0
    s_cmp_ge_u32 s12, 8
    s_nop 2
    s_cbranch_scc1 LP42_ok
    s_sleep 1
    s_branch LP42
LP42_ok:
    s_mov_b32 m0, 32768
    s_add_u32 s13, s10, 16384
    buffer_load_dwordx4 v8, s[40:43], s13 offen offset:0 nt lds
    buffer_load_dwordx4 v8, s[40:43], s13 offen offset:1024 nt lds
    buffer_load_dwordx4 v8, s[40:43], s13 offen offset:2048 nt lds
    buffer_load_dwordx4 v8, s[40:43], s13 offen offset:3072 nt lds
    s_mov_b32 m0, 36864
    s_add_u32 s13, s10, 20480
    buffer_load_dwordx4 v8, s[40:43], s13 offen offset:0 nt lds
    buffer_load_dwordx4 v8, s[40:43], s13 offen offset:1024 nt lds
    buffer_load_dwordx4 v8, s[40:43], s13 offen offset:2048 nt lds
    buffer_load_dwordx4 v8, s[40:43], s13 offen offset:3072 nt lds
    s_mov_b32 m0, 40960
    s_add_u32 s13, s10, 24576
    buffer_load_dwordx4 v8, s[40:43], s13 offen offset:0 nt lds
    buffer_load_dwordx4 v8, s[40:43], s13 offen offset:1024 nt lds
    buffer_load_dwordx4 v8, s[40:43], s13 offen offset:2048 nt lds
    buffer_load_dwordx4 v8, s[40:43], s13 offen offset:3072 nt lds
    s_mov_b32 m0, 45056
    s_add_u32 s13, s10, 28672
    buffer_load_dwordx4 v8, s[40:43], s13 offen offset:0 nt lds
    buffer_load_dwordx4 v8, s[40:43], s13 offen offset:1024 nt lds
    buffer_load_dwordx4 v8, s[40:43], s13 offen offset:2048 nt lds
    buffer_load_dwordx4 v8, s[40:43], s13 offen offset:3072 nt lds
    s_waitcnt vmcnt(16)
    v_mov_b32 v31, 13
    ds_write_b32 v29, v31 offset:0
    s_nop 0
LP43:
    ds_read_b96 v[12:14], v29 offset:16
    s_waitcnt lgkmcnt(0)
    v_min3_u32 v12, v12, v13, v14
    s_nop 0
    v_readfirstlane_b32 s12, v12
    s_nop 0
    s_cmp_ge_u32 s12, 9
    s_nop 2
    s_cbranch_scc1 LP43_ok
    s_sleep 1
    s_branch LP43
LP43_ok:
    s_mov_b32 m0, 49152
    s_add_u32 s13, s10, 32768
    buffer_load_dwordx4 v8, s[40:43], s13 offen offset:0 nt lds
    buffer_load_dwordx4 v8, s[40:43], s13 offen offset:1024 nt lds
    buffer_load_dwordx4 v8, s[40:43], s13 offen offset:2048 nt lds
    buffer_load_dwordx4 v8, s[40:43], s13 offen offset:3072 nt lds
    s_mov_b32 m0, 53248
    s_add_u32 s13, s10, 36864
    buffer_load_dwordx4 v8, s[40:43], s13 offen offset:0 nt lds
    buffer_load_dwordx4 v8, s[40:43], s13 offen offset:1024 nt lds
    buffer_load_dwordx4 v8, s[40:43], s13 offen offset:2048 nt lds
    buffer_load_dwordx4 v8, s[40:43], s13 offen offset:3072 nt lds
    s_mov_b32 m0, 57344
    s_add_u32 s13, s10, 40960
    buffer_load_dwordx4 v8, s[40:43], s13 offen offset:0 nt lds
    buffer_load_dwordx4 v8, s[40:43], s13 offen offset:1024 nt lds
    buffer_load_dwordx4 v8, s[40:43], s13 offen offset:2048 nt lds
    buffer_load_dwordx4 v8, s[40:43], s13 offen offset:3072 nt lds
    s_mov_b32 m0, 61440
    s_add_u32 s13, s10, 45056
    buffer_load_dwordx4 v8, s[40:43], s13 offen offset:0 nt lds
    buffer_load_dwordx4 v8, s[40:43], s13 offen offset:1024 nt lds
    buffer_load_dwordx4 v8, s[40:43], s13 offen offset:2048 nt lds
    buffer_load_dwordx4 v8, s[40:43], s13 offen offset:3072 nt lds
    s_waitcnt vmcnt(16)
    v_mov_b32 v31, 14
    ds_write_b32 v29, v31 offset:0
    s_nop 0
LP44:
    ds_read_b96 v[12:14], v29 offset:16
    s_waitcnt lgkmcnt(0)
    v_min3_u32 v12, v12, v13, v14
    s_nop 0
    v_readfirstlane_b32 s12, v12
    s_nop 0
    s_cmp_ge_u32 s12, 10
    s_nop 2
    s_cbranch_scc1 LP44_ok
    s_sleep 1
    s_branch LP44
LP44_ok:
    s_mov_b32 m0, 65536
    s_add_u32 s13, s10, 49152
    buffer_load_dwordx4 v8, s[40:43], s13 offen offset:0 nt lds
    buffer_load_dwordx4 v8, s[40:43], s13 offen offset:1024 nt lds
    buffer_load_dwordx4 v8, s[40:43], s13 offen offset:2048 nt lds
    buffer_load_dwordx4 v8, s[40:43], s13 offen offset:3072 nt lds
    s_mov_b32 m0, 69632
    s_add_u32 s13, s10, 53248
    buffer_load_dwordx4 v8, s[40:43], s13 offen offset:0 nt lds
    buffer_load_dwordx4 v8, s[40:43], s13 offen offset:1024 nt lds
    buffer_load_dwordx4 v8, s[40:43], s13 offen offset:2048 nt lds
    buffer_load_dwordx4 v8, s[40:43], s13 offen offset:3072 nt lds
    s_mov_b32 m0, 73728
    s_add_u32 s13, s10, 57344
    buffer_load_dwordx4 v8, s[40:43], s13 offen offset:0 nt lds
    buffer_load_dwordx4 v8, s[40:43], s13 offen offset:1024 nt lds
    buffer_load_dwordx4 v8, s[40:43], s13 offen offset:2048 nt lds
    buffer_load_dwordx4 v8, s[40:43], s13 offen offset:3072 nt lds
    s_mov_b32 m0, 77824
    s_add_u32 s13, s10, 61440
    buffer_load_dwordx4 v8, s[40:43], s13 offen offset:0 nt lds
    buffer_load_dwordx4 v8, s[40:43], s13 offen offset:1024 nt lds
    buffer_load_dwordx4 v8, s[40:43], s13 offen offset:2048 nt lds
    buffer_load_dwordx4 v8, s[40:43], s13 offen offset:3072 nt lds
    s_waitcnt vmcnt(16)
    v_mov_b32 v31, 15
    ds_write_b32 v29, v31 offset:0
    s_nop 0
LP45:
    ds_read_b96 v[12:14], v29 offset:16
    s_waitcnt lgkmcnt(0)
    v_min3_u32 v12, v12, v13, v14
    s_nop 0
    v_readfirstlane_b32 s12, v12
    s_nop 0
    s_cmp_ge_u32 s12, 11
    s_nop 2
    s_cbranch_scc1 LP45_ok
    s_sleep 1
    s_branch LP45
LP45_ok:
    s_xor_b32 s10, s95, 1
    s_lshl_b32 s10, s10, 17
    s_add_u32 s10, s10, s11
    s_lshr_b32 s13, s6, 1
    s_and_b32 s13, s13, 1
    s_xor_b32 s13, s13, 0
    s_lshl_b32 s13, s13, 16
    s_add_u32 s10, s10, s13
    s_mov_b32 m0, 81920
    s_add_u32 s13, s10, 0
    buffer_load_dwordx4 v4, s[36:39], s13 offen offset:0 nt lds
    buffer_load_dwordx4 v5, s[36:39], s13 offen offset:1024 nt lds
    buffer_load_dwordx4 v6, s[36:39], s13 offen offset:2048 nt lds
    buffer_load_dwordx4 v7, s[36:39], s13 offen offset:3072 nt lds
    s_mov_b32 m0, 86016
    s_add_u32 s13, s10, 4096
    buffer_load_dwordx4 v4, s[36:39], s13 offen offset:0 nt lds
    buffer_load_dwordx4 v5, s[36:39], s13 offen offset:1024 nt lds
    buffer_load_dwordx4 v6, s[36:39], s13 offen offset:2048 nt lds
    buffer_load_dwordx4 v7, s[36:39], s13 offen offset:3072 nt lds
    s_mov_b32 m0, 90112
    s_add_u32 s13, s10, 8192
    buffer_load_dwordx4 v4, s[36:39], s13 offen offset:0 nt lds
    buffer_load_dwordx4 v5, s[36:39], s13 offen offset:1024 nt lds
    buffer_load_dwordx4 v6, s[36:39], s13 offen offset:2048 nt lds
    buffer_load_dwordx4 v7, s[36:39], s13 offen offset:3072 nt lds
    s_mov_b32 m0, 94208
    s_add_u32 s13, s10, 12288
    buffer_load_dwordx4 v4, s[36:39], s13 offen offset:0 nt lds
    buffer_load_dwordx4 v5, s[36:39], s13 offen offset:1024 nt lds
    buffer_load_dwordx4 v6, s[36:39], s13 offen offset:2048 nt lds
    buffer_load_dwordx4 v7, s[36:39], s13 offen offset:3072 nt lds
LP46:
    ds_read_b96 v[12:14], v29 offset:16
    s_waitcnt lgkmcnt(0)
    v_min3_u32 v12, v12, v13, v14
    s_nop 0
    v_readfirstlane_b32 s12, v12
    s_nop 0
    s_cmp_ge_u32 s12, 12
    s_nop 2
    s_cbranch_scc1 LP46_ok
    s_sleep 1
    s_branch LP46
LP46_ok:
    s_mov_b32 m0, 0
    s_add_u32 s13, s10, 16384
    buffer_load_dwordx4 v4, s[36:39], s13 offen offset:0 nt lds
    buffer_load_dwordx4 v5, s[36:39], s13 offen offset:1024 nt lds
    buffer_load_dwordx4 v6, s[36:39], s13 offen offset:2048 nt lds
    buffer_load_dwordx4 v7, s[36:39], s13 offen offset:3072 nt lds
    s_mov_b32 m0, 4096
    s_add_u32 s13, s10, 20480
    buffer_load_dwordx4 v4, s[36:39], s13 offen offset:0 nt lds
    buffer_load_dwordx4 v5, s[36:39], s13 offen offset:1024 nt lds
    buffer_load_dwordx4 v6, s[36:39], s13 offen offset:2048 nt lds
    buffer_load_dwordx4 v7, s[36:39], s13 offen offset:3072 nt lds
    s_mov_b32 m0, 8192
    s_add_u32 s13, s10, 24576
    buffer_load_dwordx4 v4, s[36:39], s13 offen offset:0 nt lds
    buffer_load_dwordx4 v5, s[36:39], s13 offen offset:1024 nt lds
    buffer_load_dwordx4 v6, s[36:39], s13 offen offset:2048 nt lds
    buffer_load_dwordx4 v7, s[36:39], s13 offen offset:3072 nt lds
    s_mov_b32 m0, 12288
    s_add_u32 s13, s10, 28672
    buffer_load_dwordx4 v4, s[36:39], s13 offen offset:0 nt lds
    buffer_load_dwordx4 v5, s[36:39], s13 offen offset:1024 nt lds
    buffer_load_dwordx4 v6, s[36:39], s13 offen offset:2048 nt lds
    buffer_load_dwordx4 v7, s[36:39], s13 offen offset:3072 nt lds
    s_waitcnt vmcnt(32)
    v_mov_b32 v31, 16
    ds_write_b32 v29, v31 offset:0
    s_nop 0
LP47:
    ds_read_b96 v[12:14], v29 offset:16
    s_waitcnt lgkmcnt(0)
    v_min3_u32 v12, v12, v13, v14
    s_nop 0
    v_readfirstlane_b32 s12, v12
    s_nop 0
    s_cmp_ge_u32 s12, 13
    s_nop 2
    s_cbranch_scc1 LP47_ok
    s_sleep 1
    s_branch LP47
LP47_ok:
    s_mov_b32 m0, 16384
    s_add_u32 s13, s10, 32768
    buffer_load_dwordx4 v4, s[36:39], s13 offen offset:0 nt lds
    buffer_load_dwordx4 v5, s[36:39], s13 offen offset:1024 nt lds
    buffer_load_dwordx4 v6, s[36:39], s13 offen offset:2048 nt lds
    buffer_load_dwordx4 v7, s[36:39], s13 offen offset:3072 nt lds
    s_mov_b32 m0, 20480
    s_add_u32 s13, s10, 36864
    buffer_load_dwordx4 v4, s[36:39], s13 offen offset:0 nt lds
    buffer_load_dwordx4 v5, s[36:39], s13 offen offset:1024 nt lds
    buffer_load_dwordx4 v6, s[36:39], s13 offen offset:2048 nt lds
    buffer_load_dwordx4 v7, s[36:39], s13 offen offset:3072 nt lds
    s_mov_b32 m0, 24576
    s_add_u32 s13, s10, 40960
    buffer_load_dwordx4 v4, s[36:39], s13 offen offset:0 nt lds
    buffer_load_dwordx4 v5, s[36:39], s13 offen offset:1024 nt lds
    buffer_load_dwordx4 v6, s[36:39], s13 offen offset:2048 nt lds
    buffer_load_dwordx4 v7, s[36:39], s13 offen offset:3072 nt lds
    s_mov_b32 m0, 28672
    s_add_u32 s13, s10, 45056
    buffer_load_dwordx4 v4, s[36:39], s13 offen offset:0 nt lds
    buffer_load_dwordx4 v5, s[36:39], s13 offen offset:1024 nt lds
    buffer_load_dwordx4 v6, s[36:39], s13 offen offset:2048 nt lds
    buffer_load_dwordx4 v7, s[36:39], s13 offen offset:3072 nt lds
    s_waitcnt vmcnt(32)
    v_mov_b32 v31, 17
    ds_write_b32 v29, v31 offset:0
    s_nop 0
LP48:
    ds_read_b96 v[12:14], v29 offset:16
    s_waitcnt lgkmcnt(0)
    v_min3_u32 v12, v12, v13, v14
    s_nop 0
    v_readfirstlane_b32 s12, v12
    s_nop 0
    s_cmp_ge_u32 s12, 14
    s_nop 2
    s_cbranch_scc1 LP48_ok
    s_sleep 1
    s_branch LP48
LP48_ok:
    s_mov_b32 m0, 32768
    s_add_u32 s13, s10, 49152
    buffer_load_dwordx4 v4, s[36:39], s13 offen offset:0 nt lds
    buffer_load_dwordx4 v5, s[36:39], s13 offen offset:1024 nt lds
    buffer_load_dwordx4 v6, s[36:39], s13 offen offset:2048 nt lds
    buffer_load_dwordx4 v7, s[36:39], s13 offen offset:3072 nt lds
    s_mov_b32 m0, 36864
    s_add_u32 s13, s10, 53248
    buffer_load_dwordx4 v4, s[36:39], s13 offen offset:0 nt lds
    buffer_load_dwordx4 v5, s[36:39], s13 offen offset:1024 nt lds
    buffer_load_dwordx4 v6, s[36:39], s13 offen offset:2048 nt lds
    buffer_load_dwordx4 v7, s[36:39], s13 offen offset:3072 nt lds
    s_mov_b32 m0, 40960
    s_add_u32 s13, s10, 57344
    buffer_load_dwordx4 v4, s[36:39], s13 offen offset:0 nt lds
    buffer_load_dwordx4 v5, s[36:39], s13 offen offset:1024 nt lds
    buffer_load_dwordx4 v6, s[36:39], s13 offen offset:2048 nt lds
    buffer_load_dwordx4 v7, s[36:39], s13 offen offset:3072 nt lds
    s_mov_b32 m0, 45056
    s_add_u32 s13, s10, 61440
    buffer_load_dwordx4 v4, s[36:39], s13 offen offset:0 nt lds
    buffer_load_dwordx4 v5, s[36:39], s13 offen offset:1024 nt lds
    buffer_load_dwordx4 v6, s[36:39], s13 offen offset:2048 nt lds
    buffer_load_dwordx4 v7, s[36:39], s13 offen offset:3072 nt lds
    s_waitcnt vmcnt(32)
    v_mov_b32 v31, 18
    ds_write_b32 v29, v31 offset:0
    s_nop 0
LP49:
    ds_read_b96 v[12:14], v29 offset:16
    s_waitcnt lgkmcnt(0)
    v_min3_u32 v12, v12, v13, v14
    s_nop 0
    v_readfirstlane_b32 s12, v12
    s_nop 0
    s_cmp_ge_u32 s12, 15
    s_nop 2
    s_cbranch_scc1 LP49_ok
    s_sleep 1
    s_branch LP49
LP49_ok:
    s_mov_b32 m0, 49152
    s_add_u32 s13, s10, 0
    buffer_load_dwordx4 v8, s[40:43], s13 offen offset:0 nt lds
    buffer_load_dwordx4 v8, s[40:43], s13 offen offset:1024 nt lds
    buffer_load_dwordx4 v8, s[40:43], s13 offen offset:2048 nt lds
    buffer_load_dwordx4 v8, s[40:43], s13 offen offset:3072 nt lds
    s_mov_b32 m0, 53248
    s_add_u32 s13, s10, 4096
    buffer_load_dwordx4 v8, s[40:43], s13 offen offset:0 nt lds
    buffer_load_dwordx4 v8, s[40:43], s13 offen offset:1024 nt lds
    buffer_load_dwordx4 v8, s[40:43], s13 offen offset:2048 nt lds
    buffer_load_dwordx4 v8, s[40:43], s13 offen offset:3072 nt lds
    s_mov_b32 m0, 57344
    s_add_u32 s13, s10, 8192
    buffer_load_dwordx4 v8, s[40:43], s13 offen offset:0 nt lds
    buffer_load_dwordx4 v8, s[40:43], s13 offen offset:1024 nt lds
    buffer_load_dwordx4 v8, s[40:43], s13 offen offset:2048 nt lds
    buffer_load_dwordx4 v8, s[40:43], s13 offen offset:3072 nt lds
    s_mov_b32 m0, 61440
    s_add_u32 s13, s10, 12288
    buffer_load_dwordx4 v8, s[40:43], s13 offen offset:0 nt lds
    buffer_load_dwordx4 v8, s[40:43], s13 offen offset:1024 nt lds
    buffer_load_dwordx4 v8, s[40:43], s13 offen offset:2048 nt lds
    buffer_load_dwordx4 v8, s[40:43], s13 offen offset:3072 nt lds
    s_waitcnt vmcnt(32)
    v_mov_b32 v31, 19
    ds_write_b32 v29, v31 offset:0
    s_nop 0
LP50:
    ds_read_b96 v[12:14], v29 offset:16
    s_waitcnt lgkmcnt(0)
    v_min3_u32 v12, v12, v13, v14
    s_nop 0
    v_readfirstlane_b32 s12, v12
    s_nop 0
    s_cmp_ge_u32 s12, 16
    s_nop 2
    s_cbranch_scc1 LP50_ok
    s_sleep 1
    s_branch LP50
LP50_ok:
    s_mov_b32 m0, 65536
    s_add_u32 s13, s10, 16384
    buffer_load_dwordx4 v8, s[40:43], s13 offen offset:0 nt lds
    buffer_load_dwordx4 v8, s[40:43], s13 offen offset:1024 nt lds
    buffer_load_dwordx4 v8, s[40:43], s13 offen offset:2048 nt lds
    buffer_load_dwordx4 v8, s[40:43], s13 offen offset:3072 nt lds
    s_mov_b32 m0, 69632
    s_add_u32 s13, s10, 20480
    buffer_load_dwordx4 v8, s[40:43], s13 offen offset:0 nt lds
    buffer_load_dwordx4 v8, s[40:43], s13 offen offset:1024 nt lds
    buffer_load_dwordx4 v8, s[40:43], s13 offen offset:2048 nt lds
    buffer_load_dwordx4 v8, s[40:43], s13 offen offset:3072 nt lds
    s_mov_b32 m0, 73728
    s_add_u32 s13, s10, 24576
    buffer_load_dwordx4 v8, s[40:43], s13 offen offset:0 nt lds
    buffer_load_dwordx4 v8, s[40:43], s13 offen offset:1024 nt lds
    buffer_load_dwordx4 v8, s[40:43], s13 offen offset:2048 nt lds
    buffer_load_dwordx4 v8, s[40:43], s13 offen offset:3072 nt lds
    s_mov_b32 m0, 77824
    s_add_u32 s13, s10, 28672
    buffer_load_dwordx4 v8, s[40:43], s13 offen offset:0 nt lds
    buffer_load_dwordx4 v8, s[40:43], s13 offen offset:1024 nt lds
    buffer_load_dwordx4 v8, s[40:43], s13 offen offset:2048 nt lds
    buffer_load_dwordx4 v8, s[40:43], s13 offen offset:3072 nt lds
    s_waitcnt vmcnt(32)
    v_mov_b32 v31, 20
    ds_write_b32 v29, v31 offset:0
    s_nop 0
LP51:
    ds_read_b96 v[12:14], v29 offset:32
    s_waitcnt lgkmcnt(0)
    v_min3_u32 v12, v12, v13, v14
    s_nop 0
    v_readfirstlane_b32 s12, v12
    s_nop 0
    s_cmp_ge_u32 s12, 17
    s_nop 2
    s_cbranch_scc1 LP51_ok
    s_sleep 1
    s_branch LP51
LP51_ok:
    s_mov_b32 m0, 81920
    s_add_u32 s13, s10, 32768
    buffer_load_dwordx4 v8, s[40:43], s13 offen offset:0 nt lds
    buffer_load_dwordx4 v8, s[40:43], s13 offen offset:1024 nt lds
    buffer_load_dwordx4 v8, s[40:43], s13 offen offset:2048 nt lds
    buffer_load_dwordx4 v8, s[40:43], s13 offen offset:3072 nt lds
    s_mov_b32 m0, 86016
    s_add_u32 s13, s10, 36864
    buffer_load_dwordx4 v8, s[40:43], s13 offen offset:0 nt lds
    buffer_load_dwordx4 v8, s[40:43], s13 offen offset:1024 nt lds
    buffer_load_dwordx4 v8, s[40:43], s13 offen offset:2048 nt lds
    buffer_load_dwordx4 v8, s[40:43], s13 offen offset:3072 nt lds
    s_mov_b32 m0, 90112
    s_add_u32 s13, s10, 40960
    buffer_load_dwordx4 v8, s[40:43], s13 offen offset:0 nt lds
    buffer_load_dwordx4 v8, s[40:43], s13 offen offset:1024 nt lds
    buffer_load_dwordx4 v8, s[40:43], s13 offen offset:2048 nt lds
    buffer_load_dwordx4 v8, s[40:43], s13 offen offset:3072 nt lds
    s_mov_b32 m0, 94208
    s_add_u32 s13, s10, 45056
    buffer_load_dwordx4 v8, s[40:43], s13 offen offset:0 nt lds
    buffer_load_dwordx4 v8, s[40:43], s13 offen offset:1024 nt lds
    buffer_load_dwordx4 v8, s[40:43], s13 offen offset:2048 nt lds
    buffer_load_dwordx4 v8, s[40:43], s13 offen offset:3072 nt lds
    s_waitcnt vmcnt(32)
    v_mov_b32 v31, 21
    ds_write_b32 v29, v31 offset:0
    s_nop 0
LP52:
    ds_read_b96 v[12:14], v29 offset:32
    s_waitcnt lgkmcnt(0)
    v_min3_u32 v12, v12, v13, v14
    s_nop 0
    v_readfirstlane_b32 s12, v12
    s_nop 0
    s_cmp_ge_u32 s12, 18
    s_nop 2
    s_cbranch_scc1 LP52_ok
    s_sleep 1
    s_branch LP52
LP52_ok:
    s_mov_b32 m0, 0
    s_add_u32 s13, s10, 49152
    buffer_load_dwordx4 v8, s[40:43], s13 offen offset:0 nt lds
    buffer_load_dwordx4 v8, s[40:43], s13 offen offset:1024 nt lds
    buffer_load_dwordx4 v8, s[40:43], s13 offen offset:2048 nt lds
    buffer_load_dwordx4 v8, s[40:43], s13 offen offset:3072 nt lds
    s_mov_b32 m0, 4096
    s_add_u32 s13, s10, 53248
    buffer_load_dwordx4 v8, s[40:43], s13 offen offset:0 nt lds
    buffer_load_dwordx4 v8, s[40:43], s13 offen offset:1024 nt lds
    buffer_load_dwordx4 v8, s[40:43], s13 offen offset:2048 nt lds
    buffer_load_dwordx4 v8, s[40:43], s13 offen offset:3072 nt lds
    s_mov_b32 m0, 8192
    s_add_u32 s13, s10, 57344
    buffer_load_dwordx4 v8, s[40:43], s13 offen offset:0 nt lds
    buffer_load_dwordx4 v8, s[40:43], s13 offen offset:1024 nt lds
    buffer_load_dwordx4 v8, s[40:43], s13 offen offset:2048 nt lds
    buffer_load_dwordx4 v8, s[40:43], s13 offen offset:3072 nt lds
    s_mov_b32 m0, 12288
    s_add_u32 s13, s10, 61440
    buffer_load_dwordx4 v8, s[40:43], s13 offen offset:0 nt lds
    buffer_load_dwordx4 v8, s[40:43], s13 offen offset:1024 nt lds
    buffer_load_dwordx4 v8, s[40:43], s13 offen offset:2048 nt lds
    buffer_load_dwordx4 v8, s[40:43], s13 offen offset:3072 nt lds
    s_waitcnt vmcnt(32)
    v_mov_b32 v31, 22
    ds_write_b32 v29, v31 offset:0
    s_nop 0
LP53:
    ds_read_b96 v[12:14], v29 offset:32
    s_waitcnt lgkmcnt(0)
    v_min3_u32 v12, v12, v13, v14
    s_nop 0
    v_readfirstlane_b32 s12, v12
    s_nop 0
    s_cmp_ge_u32 s12, 19
    s_nop 2
    s_cbranch_scc1 LP53_ok
    s_sleep 1
    s_branch LP53
LP53_ok:
    s_xor_b32 s10, s95, 1
    s_lshl_b32 s10, s10, 17
    s_add_u32 s10, s10, s11
    s_lshr_b32 s13, s6, 1
    s_and_b32 s13, s13, 1
    s_xor_b32 s13, s13, 1
    s_lshl_b32 s13, s13, 16
    s_add_u32 s10, s10, s13
    s_mov_b32 m0, 16384
    s_add_u32 s13, s10, 0
    buffer_load_dwordx4 v4, s[36:39], s13 offen offset:0 nt lds
    buffer_load_dwordx4 v5, s[36:39], s13 offen offset:1024 nt lds
    buffer_load_dwordx4 v6, s[36:39], s13 offen offset:2048 nt lds
    buffer_load_dwordx4 v7, s[36:39], s13 offen offset:3072 nt lds
    s_mov_b32 m0, 20480
    s_add_u32 s13, s10, 4096
    buffer_load_dwordx4 v4, s[36:39], s13 offen offset:0 nt lds
    buffer_load_dwordx4 v5, s[36:39], s13 offen offset:1024 nt lds
    buffer_load_dwordx4 v6, s[36:39], s13 offen offset:2048 nt lds
    buffer_load_dwordx4 v7, s[36:39], s13 offen offset:3072 nt lds
    s_mov_b32 m0, 24576
    s_add_u32 s13, s10, 8192
    buffer_load_dwordx4 v4, s[36:39], s13 offen offset:0 nt lds
    buffer_load_dwordx4 v5, s[36:39], s13 offen offset:1024 nt lds
    buffer_load_dwordx4 v6, s[36:39], s13 offen offset:2048 nt lds
    buffer_load_dwordx4 v7, s[36:39], s13 offen offset:3072 nt lds
    s_mov_b32 m0, 28672
    s_add_u32 s13, s10, 12288
    buffer_load_dwordx4 v4, s[36:39], s13 offen offset:0 nt lds
    buffer_load_dwordx4 v5, s[36:39], s13 offen offset:1024 nt lds
    buffer_load_dwordx4 v6, s[36:39], s13 offen offset:2048 nt lds
    buffer_load_dwordx4 v7, s[36:39], s13 offen offset:3072 nt lds
    s_waitcnt vmcnt(32)
    v_mov_b32 v31, 23
    ds_write_b32 v29, v31 offset:0
    s_nop 0
LP54:
    ds_read_b96 v[12:14], v29 offset:32
    s_waitcnt lgkmcnt(0)
    v_min3_u32 v12, v12, v13, v14
    s_nop 0
    v_readfirstlane_b32 s12, v12
    s_nop 0
    s_cmp_ge_u32 s12, 20
    s_nop 2
    s_cbranch_scc1 LP54_ok
    s_sleep 1
    s_branch LP54
LP54_ok:
    s_mov_b32 m0, 32768
    s_add_u32 s13, s10, 16384
    buffer_load_dwordx4 v4, s[36:39], s13 offen offset:0 nt lds
    buffer_load_dwordx4 v5, s[36:39], s13 offen offset:1024 nt lds
    buffer_load_dwordx4 v6, s[36:39], s13 offen offset:2048 nt lds
    buffer_load_dwordx4 v7, s[36:39], s13 offen offset:3072 nt lds
    s_mov_b32 m0, 36864
    s_add_u32 s13, s10, 20480
    buffer_load_dwordx4 v4, s[36:39], s13 offen offset:0 nt lds
    buffer_load_dwordx4 v5, s[36:39], s13 offen offset:1024 nt lds
    buffer_load_dwordx4 v6, s[36:39], s13 offen offset:2048 nt lds
    buffer_load_dwordx4 v7, s[36:39], s13 offen offset:3072 nt lds
    s_mov_b32 m0, 40960
    s_add_u32 s13, s10, 24576
    buffer_load_dwordx4 v4, s[36:39], s13 offen offset:0 nt lds
    buffer_load_dwordx4 v5, s[36:39], s13 offen offset:1024 nt lds
    buffer_load_dwordx4 v6, s[36:39], s13 offen offset:2048 nt lds
    buffer_load_dwordx4 v7, s[36:39], s13 offen offset:3072 nt lds
    s_mov_b32 m0, 45056
    s_add_u32 s13, s10, 28672
    buffer_load_dwordx4 v4, s[36:39], s13 offen offset:0 nt lds
    buffer_load_dwordx4 v5, s[36:39], s13 offen offset:1024 nt lds
    buffer_load_dwordx4 v6, s[36:39], s13 offen offset:2048 nt lds
    buffer_load_dwordx4 v7, s[36:39], s13 offen offset:3072 nt lds
    s_waitcnt vmcnt(32)
    v_mov_b32 v31, 24
    ds_write_b32 v29, v31 offset:0
    s_nop 0
LP55:
    ds_read_b96 v[12:14], v29 offset:32
    s_waitcnt lgkmcnt(0)
    v_min3_u32 v12, v12, v13, v14
    s_nop 0
    v_readfirstlane_b32 s12, v12
    s_nop 0
    s_cmp_ge_u32 s12, 21
    s_nop 2
    s_cbranch_scc1 LP55_ok
    s_sleep 1
    s_branch LP55
LP55_ok:
    s_mov_b32 m0, 49152
    s_add_u32 s13, s10, 32768
    buffer_load_dwordx4 v4, s[36:39], s13 offen offset:0 nt lds
    buffer_load_dwordx4 v5, s[36:39], s13 offen offset:1024 nt lds
    buffer_load_dwordx4 v6, s[36:39], s13 offen offset:2048 nt lds
    buffer_load_dwordx4 v7, s[36:39], s13 offen offset:3072 nt lds
    s_mov_b32 m0, 53248
    s_add_u32 s13, s10, 36864
    buffer_load_dwordx4 v4, s[36:39], s13 offen offset:0 nt lds
    buffer_load_dwordx4 v5, s[36:39], s13 offen offset:1024 nt lds
    buffer_load_dwordx4 v6, s[36:39], s13 offen offset:2048 nt lds
    buffer_load_dwordx4 v7, s[36:39], s13 offen offset:3072 nt lds
    s_mov_b32 m0, 57344
    s_add_u32 s13, s10, 40960
    buffer_load_dwordx4 v4, s[36:39], s13 offen offset:0 nt lds
    buffer_load_dwordx4 v5, s[36:39], s13 offen offset:1024 nt lds
    buffer_load_dwordx4 v6, s[36:39], s13 offen offset:2048 nt lds
    buffer_load_dwordx4 v7, s[36:39], s13 offen offset:3072 nt lds
    s_mov_b32 m0, 61440
    s_add_u32 s13, s10, 45056
    buffer_load_dwordx4 v4, s[36:39], s13 offen offset:0 nt lds
    buffer_load_dwordx4 v5, s[36:39], s13 offen offset:1024 nt lds
    buffer_load_dwordx4 v6, s[36:39], s13 offen offset:2048 nt lds
    buffer_load_dwordx4 v7, s[36:39], s13 offen offset:3072 nt lds
    s_waitcnt vmcnt(32)
    v_mov_b32 v31, 25
    ds_write_b32 v29, v31 offset:0
    s_nop 0
LP56:
    ds_read_b96 v[12:14], v29 offset:32
    s_waitcnt lgkmcnt(0)
    v_min3_u32 v12, v12, v13, v14
    s_nop 0
    v_readfirstlane_b32 s12, v12
    s_nop 0
    s_cmp_ge_u32 s12, 22
    s_nop 2
    s_cbranch_scc1 LP56_ok
    s_sleep 1
    s_branch LP56
LP56_ok:
    s_mov_b32 m0, 65536
    s_add_u32 s13, s10, 49152
    buffer_load_dwordx4 v4, s[36:39], s13 offen offset:0 nt lds
    buffer_load_dwordx4 v5, s[36:39], s13 offen offset:1024 nt lds
    buffer_load_dwordx4 v6, s[36:39], s13 offen offset:2048 nt lds
    buffer_load_dwordx4 v7, s[36:39], s13 offen offset:3072 nt lds
    s_mov_b32 m0, 69632
    s_add_u32 s13, s10, 53248
    buffer_load_dwordx4 v4, s[36:39], s13 offen offset:0 nt lds
    buffer_load_dwordx4 v5, s[36:39], s13 offen offset:1024 nt lds
    buffer_load_dwordx4 v6, s[36:39], s13 offen offset:2048 nt lds
    buffer_load_dwordx4 v7, s[36:39], s13 offen offset:3072 nt lds
    s_mov_b32 m0, 73728
    s_add_u32 s13, s10, 57344
    buffer_load_dwordx4 v4, s[36:39], s13 offen offset:0 nt lds
    buffer_load_dwordx4 v5, s[36:39], s13 offen offset:1024 nt lds
    buffer_load_dwordx4 v6, s[36:39], s13 offen offset:2048 nt lds
    buffer_load_dwordx4 v7, s[36:39], s13 offen offset:3072 nt lds
    s_mov_b32 m0, 77824
    s_add_u32 s13, s10, 61440
    buffer_load_dwordx4 v4, s[36:39], s13 offen offset:0 nt lds
    buffer_load_dwordx4 v5, s[36:39], s13 offen offset:1024 nt lds
    buffer_load_dwordx4 v6, s[36:39], s13 offen offset:2048 nt lds
    buffer_load_dwordx4 v7, s[36:39], s13 offen offset:3072 nt lds
    s_waitcnt vmcnt(32)
    v_mov_b32 v31, 26
    ds_write_b32 v29, v31 offset:0
    s_nop 0
LP57:
    ds_read_b96 v[12:14], v29 offset:32
    s_waitcnt lgkmcnt(0)
    v_min3_u32 v12, v12, v13, v14
    s_nop 0
    v_readfirstlane_b32 s12, v12
    s_nop 0
    s_cmp_ge_u32 s12, 23
    s_nop 2
    s_cbranch_scc1 LP57_ok
    s_sleep 1
    s_branch LP57
LP57_ok:
    s_mov_b32 m0, 81920
    s_add_u32 s13, s10, 0
    buffer_load_dwordx4 v8, s[40:43], s13 offen offset:0 nt lds
    buffer_load_dwordx4 v8, s[40:43], s13 offen offset:1024 nt lds
    buffer_load_dwordx4 v8, s[40:43], s13 offen offset:2048 nt lds
    buffer_load_dwordx4 v8, s[40:43], s13 offen offset:3072 nt lds
    s_mov_b32 m0, 86016
    s_add_u32 s13, s10, 4096
    buffer_load_dwordx4 v8, s[40:43], s13 offen offset:0 nt lds
    buffer_load_dwordx4 v8, s[40:43], s13 offen offset:1024 nt lds
    buffer_load_dwordx4 v8, s[40:43], s13 offen offset:2048 nt lds
    buffer_load_dwordx4 v8, s[40:43], s13 offen offset:3072 nt lds
    s_mov_b32 m0, 90112
    s_add_u32 s13, s10, 8192
    buffer_load_dwordx4 v8, s[40:43], s13 offen offset:0 nt lds
    buffer_load_dwordx4 v8, s[40:43], s13 offen offset:1024 nt lds
    buffer_load_dwordx4 v8, s[40:43], s13 offen offset:2048 nt lds
    buffer_load_dwordx4 v8, s[40:43], s13 offen offset:3072 nt lds
    s_mov_b32 m0, 94208
    s_add_u32 s13, s10, 12288
    buffer_load_dwordx4 v8, s[40:43], s13 offen offset:0 nt lds
    buffer_load_dwordx4 v8, s[40:43], s13 offen offset:1024 nt lds
    buffer_load_dwordx4 v8, s[40:43], s13 offen offset:2048 nt lds
    buffer_load_dwordx4 v8, s[40:43], s13 offen offset:3072 nt lds
    s_waitcnt vmcnt(32)
    v_mov_b32 v31, 27
    ds_write_b32 v29, v31 offset:0
    s_nop 0
LP58:
    ds_read_b96 v[12:14], v29 offset:32
    s_waitcnt lgkmcnt(0)
    v_min3_u32 v12, v12, v13, v14
    s_nop 0
    v_readfirstlane_b32 s12, v12
    s_nop 0
    s_cmp_ge_u32 s12, 24
    s_nop 2
    s_cbranch_scc1 LP58_ok
    s_sleep 1
    s_branch LP58
LP58_ok:
    s_mov_b32 m0, 0
    s_add_u32 s13, s10, 16384
    buffer_load_dwordx4 v8, s[40:43], s13 offen offset:0 nt lds
    buffer_load_dwordx4 v8, s[40:43], s13 offen offset:1024 nt lds
    buffer_load_dwordx4 v8, s[40:43], s13 offen offset:2048 nt lds
    buffer_load_dwordx4 v8, s[40:43], s13 offen offset:3072 nt lds
    s_mov_b32 m0, 4096
    s_add_u32 s13, s10, 20480
    buffer_load_dwordx4 v8, s[40:43], s13 offen offset:0 nt lds
    buffer_load_dwordx4 v8, s[40:43], s13 offen offset:1024 nt lds
    buffer_load_dwordx4 v8, s[40:43], s13 offen offset:2048 nt lds
    buffer_load_dwordx4 v8, s[40:43], s13 offen offset:3072 nt lds
    s_mov_b32 m0, 8192
    s_add_u32 s13, s10, 24576
    buffer_load_dwordx4 v8, s[40:43], s13 offen offset:0 nt lds
    buffer_load_dwordx4 v8, s[40:43], s13 offen offset:1024 nt lds
    buffer_load_dwordx4 v8, s[40:43], s13 offen offset:2048 nt lds
    buffer_load_dwordx4 v8, s[40:43], s13 offen offset:3072 nt lds
    s_mov_b32 m0, 12288
    s_add_u32 s13, s10, 28672
    buffer_load_dwordx4 v8, s[40:43], s13 offen offset:0 nt lds
    buffer_load_dwordx4 v8, s[40:43], s13 offen offset:1024 nt lds
    buffer_load_dwordx4 v8, s[40:43], s13 offen offset:2048 nt lds
    buffer_load_dwordx4 v8, s[40:43], s13 offen offset:3072 nt lds
    s_waitcnt vmcnt(32)
    v_mov_b32 v31, 28
    ds_write_b32 v29, v31 offset:0
    s_nop 0
LP59:
    ds_read_b96 v[12:14], v29 offset:32
    s_waitcnt lgkmcnt(0)
    v_min3_u32 v12, v12, v13, v14
    s_nop 0
    v_readfirstlane_b32 s12, v12
    s_nop 0
    s_cmp_ge_u32 s12, 25
    s_nop 2
    s_cbranch_scc1 LP59_ok
    s_sleep 1
    s_branch LP59
LP59_ok:
    s_mov_b32 m0, 16384
    s_add_u32 s13, s10, 32768
    buffer_load_dwordx4 v8, s[40:43], s13 offen offset:0 nt lds
    buffer_load_dwordx4 v8, s[40:43], s13 offen offset:1024 nt lds
    buffer_load_dwordx4 v8, s[40:43], s13 offen offset:2048 nt lds
    buffer_load_dwordx4 v8, s[40:43], s13 offen offset:3072 nt lds
    s_mov_b32 m0, 20480
    s_add_u32 s13, s10, 36864
    buffer_load_dwordx4 v8, s[40:43], s13 offen offset:0 nt lds
    buffer_load_dwordx4 v8, s[40:43], s13 offen offset:1024 nt lds
    buffer_load_dwordx4 v8, s[40:43], s13 offen offset:2048 nt lds
    buffer_load_dwordx4 v8, s[40:43], s13 offen offset:3072 nt lds
    s_mov_b32 m0, 24576
    s_add_u32 s13, s10, 40960
    buffer_load_dwordx4 v8, s[40:43], s13 offen offset:0 nt lds
    buffer_load_dwordx4 v8, s[40:43], s13 offen offset:1024 nt lds
    buffer_load_dwordx4 v8, s[40:43], s13 offen offset:2048 nt lds
    buffer_load_dwordx4 v8, s[40:43], s13 offen offset:3072 nt lds
    s_mov_b32 m0, 28672
    s_add_u32 s13, s10, 45056
    buffer_load_dwordx4 v8, s[40:43], s13 offen offset:0 nt lds
    buffer_load_dwordx4 v8, s[40:43], s13 offen offset:1024 nt lds
    buffer_load_dwordx4 v8, s[40:43], s13 offen offset:2048 nt lds
    buffer_load_dwordx4 v8, s[40:43], s13 offen offset:3072 nt lds
    s_waitcnt vmcnt(32)
    v_mov_b32 v31, 29
    ds_write_b32 v29, v31 offset:0
    s_nop 0
LP60:
    ds_read_b96 v[12:14], v29 offset:32
    s_waitcnt lgkmcnt(0)
    v_min3_u32 v12, v12, v13, v14
    s_nop 0
    v_readfirstlane_b32 s12, v12
    s_nop 0
    s_cmp_ge_u32 s12, 26
    s_nop 2
    s_cbranch_scc1 LP60_ok
    s_sleep 1
    s_branch LP60
LP60_ok:
    s_mov_b32 m0, 32768
    s_add_u32 s13, s10, 49152
    buffer_load_dwordx4 v8, s[40:43], s13 offen offset:0 nt lds
    buffer_load_dwordx4 v8, s[40:43], s13 offen offset:1024 nt lds
    buffer_load_dwordx4 v8, s[40:43], s13 offen offset:2048 nt lds
    buffer_load_dwordx4 v8, s[40:43], s13 offen offset:3072 nt lds
    s_mov_b32 m0, 36864
    s_add_u32 s13, s10, 53248
    buffer_load_dwordx4 v8, s[40:43], s13 offen offset:0 nt lds
    buffer_load_dwordx4 v8, s[40:43], s13 offen offset:1024 nt lds
    buffer_load_dwordx4 v8, s[40:43], s13 offen offset:2048 nt lds
    buffer_load_dwordx4 v8, s[40:43], s13 offen offset:3072 nt lds
    s_mov_b32 m0, 40960
    s_add_u32 s13, s10, 57344
    buffer_load_dwordx4 v8, s[40:43], s13 offen offset:0 nt lds
    buffer_load_dwordx4 v8, s[40:43], s13 offen offset:1024 nt lds
    buffer_load_dwordx4 v8, s[40:43], s13 offen offset:2048 nt lds
    buffer_load_dwordx4 v8, s[40:43], s13 offen offset:3072 nt lds
    s_mov_b32 m0, 45056
    s_add_u32 s13, s10, 61440
    buffer_load_dwordx4 v8, s[40:43], s13 offen offset:0 nt lds
    buffer_load_dwordx4 v8, s[40:43], s13 offen offset:1024 nt lds
    buffer_load_dwordx4 v8, s[40:43], s13 offen offset:2048 nt lds
    buffer_load_dwordx4 v8, s[40:43], s13 offen offset:3072 nt lds
    s_waitcnt vmcnt(32)
    v_mov_b32 v31, 30
    ds_write_b32 v29, v31 offset:0
    s_waitcnt vmcnt(16)
    v_mov_b32 v31, 31
    ds_write_b32 v29, v31 offset:0
    s_waitcnt vmcnt(0)
    v_mov_b32 v31, 32
    ds_write_b32 v29, v31 offset:0
    s_endpgm
LA_comp:
    v_mov_b32 v16, v0
    v_and_b32 v17, 31, v16
    v_lshrrev_b32 v18, 5, v16
    v_and_b32 v19, 15, v16
    v_bfe_u32 v20, v16, 4, 1
    v_lshrrev_b32 v21, 2, v19
    v_and_b32 v22, 3, v19
    v_xor_b32 v23, v18, v19
    v_lshlrev_b32 v23, 4, v23
    v_lshl_add_u32 v8, v17, 8, v23
    s_lshl_b32 s4, s8, 13
    s_add_u32 s12, s4, 49152
    v_add_u32 v11, s12, v8
    v_lshl_add_u32 v23, v18, 2, v21
    v_lshlrev_b32 v23, 8, v23
    v_lshl_add_u32 v23, v21, 6, v23
    v_lshl_add_u32 v24, v20, 5, v23
    v_lshl_add_u32 v9, v22, 3, v24
    v_lshl_add_u32 v23, v18, 3, v21
    v_lshlrev_b32 v23, 8, v23
    v_lshl_add_u32 v23, v21, 6, v23
    v_lshl_add_u32 v23, v20, 5, v23
    v_and_b32 v24, 1, v22
    v_lshl_add_u32 v23, v24, 4, v23
    v_lshrrev_b32 v24, 1, v22
    v_lshl_add_u32 v23, v24, 3, v23
    v_add_u32 v0, 98304, v23
    v_xor_b32 v1, 64, v0
    v_xor_b32 v2, 0x80, v0
    v_xor_b32 v3, 0xc0, v0
    s_mov_b32 s15, 0x3e0293ee
    s_mul_i32 s14, s6, 3
    s_add_u32 s14, s14, s8
    s_mul_i32 s12, s9, 48
    s_add_u32 s14, s14, s12
    s_lshl_b32 s14, s14, 4
    s_lshr_b32 s12, s7, 1
    s_add_u32 s14, s14, s12
    s_mul_i32 s12, s9, 0
    s_add_u32 s14, s14, s12
    s_lshl_b32 s14, s14, 13
    s_mul_i32 s10, s9, 65536
    s_add_u32 s10, s10, 16384
    v_mov_b32 v12, 0xf149f2ca
    v_mov_b32 v13, 0
    v_mov_b32 v10, 163584
    s_lshl_b32 s12, s8, 2
    s_lshl_b32 s13, s9, 4
    s_add_u32 s13, s13, s12
    v_add_u32 v4, s12, v10
    v_add_u32 v5, s13, v10
    s_cmp_eq_u32 s9, 0
    s_nop 0
    s_cbranch_scc0 LA_qb
    s_setprio 3
    s_barrier
    ds_read_b32 v6, v10 offset:4
    s_waitcnt lgkmcnt(0)
    v_readfirstlane_b32 s54, v6
    s_nop 0
    s_cmp_ge_u32 s54, 1
    s_cbranch_scc0 LC61
LC61_ret:
    ds_read_b32 v6, v4 offset:80
    s_waitcnt lgkmcnt(0)
    v_readfirstlane_b32 s54, v6
    s_nop 0
    s_cmp_ge_u32 s54, 1
    s_cbranch_scc0 LC62
LC62_ret:
    v_xor_b32 v14, 0, v11
    ds_read_b128 v[32:35], v14 offset:0
    v_xor_b32 v15, 32, v11
    ds_read_b128 v[36:39], v15 offset:0
    v_xor_b32 v14, 64, v11
    ds_read_b128 v[40:43], v14 offset:0
    v_xor_b32 v15, 96, v11
    ds_read_b128 v[44:47], v15 offset:0
    v_xor_b32 v14, 128, v11
    ds_read_b128 v[48:51], v14 offset:0
    v_xor_b32 v15, 160, v11
    ds_read_b128 v[52:55], v15 offset:0
    v_xor_b32 v14, 192, v11
    ds_read_b128 v[56:59], v14 offset:0
    v_xor_b32 v15, 224, v11
    ds_read_b128 v[60:63], v15 offset:0
    v_mov_b32 v7, 1
    ds_write_b32 v4, v7 offset:96
    ds_read_b64_tr_b16 v[16:17], v0 offset:0
    ds_read_b64_tr_b16 v[18:19], v0 offset:1024
    ds_read_b64_tr_b16 v[20:21], v1 offset:0
    ds_read_b64_tr_b16 v[22:23], v1 offset:1024
    ds_read_b64_tr_b16 v[24:25], v2 offset:0
    ds_read_b64_tr_b16 v[26:27], v2 offset:1024
    ds_read_b64_tr_b16 v[28:29], v3 offset:0
    ds_read_b64_tr_b16 v[30:31], v3 offset:1024
    s_waitcnt lgkmcnt(6)
    v_mfma_f32_32x32x16_bf16 v[64:79], v[16:19], v[32:35], 0
    ds_read_b64_tr_b16 v[16:17], v0 offset:4096
    ds_read_b64_tr_b16 v[18:19], v0 offset:5120
    s_waitcnt lgkmcnt(6)
    v_mfma_f32_32x32x16_bf16 v[80:95], v[20:23], v[32:35], 0
    ds_read_b64_tr_b16 v[20:21], v1 offset:4096
    ds_read_b64_tr_b16 v[22:23], v1 offset:5120
    s_waitcnt lgkmcnt(6)
    v_mfma_f32_32x32x16_bf16 v[96:111], v[24:27], v[32:35], 0
    ds_read_b64_tr_b16 v[24:25], v2 offset:4096
    ds_read_b64_tr_b16 v[26:27], v2 offset:5120
    s_waitcnt lgkmcnt(6)
    v_mfma_f32_32x32x16_bf16 v[112:127], v[28:31], v[32:35], 0
    ds_read_b64_tr_b16 v[28:29], v3 offset:4096
    ds_read_b64_tr_b16 v[30:31], v3 offset:5120
    s_waitcnt lgkmcnt(6)
    v_mfma_f32_32x32x16_bf16 v[64:79], v[16:19], v[36:39], v[64:79]
    ds_read_b64_tr_b16 v[16:17], v0 offset:8192
    ds_read_b64_tr_b16 v[18:19], v0 offset:9216
    s_waitcnt lgkmcnt(6)
    v_mfma_f32_32x32x16_bf16 v[80:95], v[20:23], v[36:39], v[80:95]
    ds_read_b64_tr_b16 v[20:21], v1 offset:8192
    ds_read_b64_tr_b16 v[22:23], v1 offset:9216
    s_waitcnt lgkmcnt(6)
    v_mfma_f32_32x32x16_bf16 v[96:111], v[24:27], v[36:39], v[96:111]
    ds_read_b64_tr_b16 v[24:25], v2 offset:8192
    ds_read_b64_tr_b16 v[26:27], v2 offset:9216
    s_waitcnt lgkmcnt(6)
    v_mfma_f32_32x32x16_bf16 v[112:127], v[28:31], v[36:39], v[112:127]
    ds_read_b64_tr_b16 v[28:29], v3 offset:8192
    ds_read_b64_tr_b16 v[30:31], v3 offset:9216
    ds_read_b32 v6, v10 offset:4
    s_waitcnt lgkmcnt(7)
    v_mfma_f32_32x32x16_bf16 v[64:79], v[16:19], v[40:43], v[64:79]
    ds_read_b64_tr_b16 v[16:17], v0 offset:12288
    ds_read_b64_tr_b16 v[18:19], v0 offset:13312
    s_waitcnt lgkmcnt(7)
    v_mfma_f32_32x32x16_bf16 v[80:95], v[20:23], v[40:43], v[80:95]
    ds_read_b64_tr_b16 v[20:21], v1 offset:12288
    ds_read_b64_tr_b16 v[22:23], v1 offset:13312
    s_waitcnt lgkmcnt(7)
    v_mfma_f32_32x32x16_bf16 v[96:111], v[24:27], v[40:43], v[96:111]
    ds_read_b64_tr_b16 v[24:25], v2 offset:12288
    ds_read_b64_tr_b16 v[26:27], v2 offset:13312
    s_waitcnt lgkmcnt(7)
    v_mfma_f32_32x32x16_bf16 v[112:127], v[28:31], v[40:43], v[112:127]
    ds_read_b64_tr_b16 v[28:29], v3 offset:12288
    ds_read_b64_tr_b16 v[30:31], v3 offset:13312
    v_mov_b32 v7, 1
    ds_write_b32 v5, v7 offset:48
    s_waitcnt lgkmcnt(7)
    v_mfma_f32_32x32x16_bf16 v[64:79], v[16:19], v[44:47], v[64:79]
    v_readfirstlane_b32 s54, v6
    s_nop 0
    s_cmp_ge_u32 s54, 2
    s_cbranch_scc0 LC63
LC63_ret:
    ds_read_b64_tr_b16 v[16:17], v0 offset:16384
    ds_read_b64_tr_b16 v[18:19], v0 offset:17408
    s_waitcnt lgkmcnt(7)
    v_mfma_f32_32x32x16_bf16 v[80:95], v[20:23], v[44:47], v[80:95]
    ds_read_b64_tr_b16 v[20:21], v1 offset:16384
    ds_read_b64_tr_b16 v[22:23], v1 offset:17408
    s_waitcnt lgkmcnt(7)
    v_mfma_f32_32x32x16_bf16 v[96:111], v[24:27], v[44:47], v[96:111]
    ds_read_b64_tr_b16 v[24:25], v2 offset:16384
    ds_read_b64_tr_b16 v[26:27], v2 offset:17408
    s_waitcnt lgkmcnt(7)
    v_mfma_f32_32x32x16_bf16 v[112:127], v[28:31], v[44:47], v[112:127]
    ds_read_b64_tr_b16 v[28:29], v3 offset:16384
    ds_read_b64_tr_b16 v[30:31], v3 offset:17408
    s_waitcnt lgkmcnt(6)
    v_mfma_f32_32x32x16_bf16 v[64:79], v[16:19], v[48:51], v[64:79]
    ds_read_b64_tr_b16 v[16:17], v0 offset:20480
    ds_read_b64_tr_b16 v[18:19], v0 offset:21504
    ds_read_b32 v15, v4 offset:80
    s_waitcnt lgkmcnt(7)
    v_mfma_f32_32x32x16_bf16 v[80:95], v[20:23], v[48:51], v[80:95]
    ds_read_b64_tr_b16 v[20:21], v1 offset:20480
    ds_read_b64_tr_b16 v[22:23], v1 offset:21504
    s_waitcnt lgkmcnt(7)
    v_mfma_f32_32x32x16_bf16 v[96:111], v[24:27], v[48:51], v[96:111]
    ds_read_b64_tr_b16 v[24:25], v2 offset:20480
    ds_read_b64_tr_b16 v[26:27], v2 offset:21504
    s_waitcnt lgkmcnt(7)
    v_mfma_f32_32x32x16_bf16 v[112:127], v[28:31], v[48:51], v[112:127]
    ds_read_b64_tr_b16 v[28:29], v3 offset:20480
    ds_read_b64_tr_b16 v[30:31], v3 offset:21504
    s_waitcnt lgkmcnt(6)
    v_readfirstlane_b32 s54, v15
    s_nop 0
    s_cmp_ge_u32 s54, 2
    s_cbranch_scc0 LC64
LC64_ret:
    v_xor_b32 v14, 0, v11
    ds_read_b128 v[128:131], v14 offset:24576
    v_mfma_f32_32x32x16_bf16 v[64:79], v[16:19], v[52:55], v[64:79]
    ds_read_b64_tr_b16 v[16:17], v0 offset:24576
    ds_read_b64_tr_b16 v[18:19], v0 offset:25600
    v_xor_b32 v14, 32, v11
    ds_read_b128 v[132:135], v14 offset:24576
    s_waitcnt lgkmcnt(8)
    v_mfma_f32_32x32x16_bf16 v[80:95], v[20:23], v[52:55], v[80:95]
    ds_read_b64_tr_b16 v[20:21], v1 offset:24576
    ds_read_b64_tr_b16 v[22:23], v1 offset:25600
    v_xor_b32 v14, 64, v11
    ds_read_b128 v[136:139], v14 offset:24576
    s_waitcnt lgkmcnt(9)
    v_mfma_f32_32x32x16_bf16 v[96:111], v[24:27], v[52:55], v[96:111]
    ds_read_b64_tr_b16 v[24:25], v2 offset:24576
    ds_read_b64_tr_b16 v[26:27], v2 offset:25600
    v_xor_b32 v14, 96, v11
    ds_read_b128 v[140:143], v14 offset:24576
    s_waitcnt lgkmcnt(10)
    v_mfma_f32_32x32x16_bf16 v[112:127], v[28:31], v[52:55], v[112:127]
    ds_read_b64_tr_b16 v[28:29], v3 offset:24576
    ds_read_b64_tr_b16 v[30:31], v3 offset:25600
    ds_read_b32 v6, v10 offset:4
    v_xor_b32 v14, 128, v11
    ds_read_b128 v[144:147], v14 offset:24576
    s_waitcnt lgkmcnt(11)
    v_mfma_f32_32x32x16_bf16 v[64:79], v[16:19], v[56:59], v[64:79]
    ds_read_b64_tr_b16 v[16:17], v0 offset:28672
    ds_read_b64_tr_b16 v[18:19], v0 offset:29696
    v_xor_b32 v14, 160, v11
    ds_read_b128 v[148:151], v14 offset:24576
    s_waitcnt lgkmcnt(11)
    v_mfma_f32_32x32x16_bf16 v[80:95], v[20:23], v[56:59], v[80:95]
    ds_read_b64_tr_b16 v[20:21], v1 offset:28672
    ds_read_b64_tr_b16 v[22:23], v1 offset:29696
    v_xor_b32 v14, 192, v11
    ds_read_b128 v[152:155], v14 offset:24576
    s_waitcnt lgkmcnt(11)
    v_mfma_f32_32x32x16_bf16 v[96:111], v[24:27], v[56:59], v[96:111]
    ds_read_b64_tr_b16 v[24:25], v2 offset:28672
    ds_read_b64_tr_b16 v[26:27], v2 offset:29696
    v_xor_b32 v14, 224, v11
    ds_read_b128 v[156:159], v14 offset:24576
    v_mov_b32 v15, 2
    ds_write_b32 v4, v15 offset:96
    s_waitcnt lgkmcnt(12)
    v_mfma_f32_32x32x16_bf16 v[112:127], v[28:31], v[56:59], v[112:127]
    ds_read_b64_tr_b16 v[28:29], v3 offset:28672
    ds_read_b64_tr_b16 v[30:31], v3 offset:29696
    v_mov_b32 v7, 2
    ds_write_b32 v5, v7 offset:48
    s_waitcnt lgkmcnt(11)
    v_mfma_f32_32x32x16_bf16 v[64:79], v[16:19], v[60:63], v[64:79]
    v_readfirstlane_b32 s54, v6
    s_nop 0
    s_cmp_ge_u32 s54, 3
    s_cbranch_scc0 LC65
LC65_ret:
    ds_read_b64_tr_b16 v[16:17], v0 offset:32768
    ds_read_b64_tr_b16 v[18:19], v0 offset:33792
    s_waitcnt lgkmcnt(10)
    v_mfma_f32_32x32x16_bf16 v[80:95], v[20:23], v[60:63], v[80:95]
    ds_read_b64_tr_b16 v[20:21], v1 offset:32768
    ds_read_b64_tr_b16 v[22:23], v1 offset:33792
    s_waitcnt lgkmcnt(9)
    v_mfma_f32_32x32x16_bf16 v[96:111], v[24:27], v[60:63], v[96:111]
    ds_read_b64_tr_b16 v[24:25], v2 offset:32768
    ds_read_b64_tr_b16 v[26:27], v2 offset:33792
    s_waitcnt lgkmcnt(7)
    v_mfma_f32_32x32x16_bf16 v[112:127], v[28:31], v[60:63], v[112:127]
    ds_read_b64_tr_b16 v[28:29], v3 offset:32768
    ds_read_b64_tr_b16 v[30:31], v3 offset:33792
    s_waitcnt lgkmcnt(6)
    v_mfma_f32_32x32x16_bf16 v[64:79], v[16:19], v[128:131], v[64:79]
    ds_read_b64_tr_b16 v[16:17], v0 offset:36864
    ds_read_b64_tr_b16 v[18:19], v0 offset:37888
    ds_read_b32 v15, v4 offset:80
    s_waitcnt lgkmcnt(7)
    v_mfma_f32_32x32x16_bf16 v[80:95], v[20:23], v[128:131], v[80:95]
    ds_read_b64_tr_b16 v[20:21], v1 offset:36864
    ds_read_b64_tr_b16 v[22:23], v1 offset:37888
    s_waitcnt lgkmcnt(7)
    v_mfma_f32_32x32x16_bf16 v[96:111], v[24:27], v[128:131], v[96:111]
    ds_read_b64_tr_b16 v[24:25], v2 offset:36864
    ds_read_b64_tr_b16 v[26:27], v2 offset:37888
    s_waitcnt lgkmcnt(7)
    v_mfma_f32_32x32x16_bf16 v[112:127], v[28:31], v[128:131], v[112:127]
    ds_read_b64_tr_b16 v[28:29], v3 offset:36864
    ds_read_b64_tr_b16 v[30:31], v3 offset:37888
    s_waitcnt lgkmcnt(6)
    v_readfirstlane_b32 s54, v15
    s_nop 0
    s_cmp_ge_u32 s54, 3
    s_cbranch_scc0 LC66
LC66_ret:
    v_xor_b32 v14, 0, v11
    ds_read_b128 v[160:163], v14 offset:0
    v_mfma_f32_32x32x16_bf16 v[64:79], v[16:19], v[132:135], v[64:79]
    ds_read_b64_tr_b16 v[16:17], v0 offset:40960
    ds_read_b64_tr_b16 v[18:19], v0 offset:41984
    v_xor_b32 v14, 32, v11
    ds_read_b128 v[164:167], v14 offset:0
    s_waitcnt lgkmcnt(8)
    v_mfma_f32_32x32x16_bf16 v[80:95], v[20:23], v[132:135], v[80:95]
    ds_read_b64_tr_b16 v[20:21], v1 offset:40960
    ds_read_b64_tr_b16 v[22:23], v1 offset:41984
    v_xor_b32 v14, 64, v11
    ds_read_b128 v[168:171], v14 offset:0
    s_waitcnt lgkmcnt(9)
    v_mfma_f32_32x32x16_bf16 v[96:111], v[24:27], v[132:135], v[96:111]
    ds_read_b64_tr_b16 v[24:25], v2 offset:40960
    ds_read_b64_tr_b16 v[26:27], v2 offset:41984
    v_xor_b32 v14, 96, v11
    ds_read_b128 v[172:175], v14 offset:0
    s_waitcnt lgkmcnt(10)
    v_mfma_f32_32x32x16_bf16 v[112:127], v[28:31], v[132:135], v[112:127]
    ds_read_b64_tr_b16 v[28:29], v3 offset:40960
    ds_read_b64_tr_b16 v[30:31], v3 offset:41984
    ds_read_b32 v6, v10 offset:4
    v_xor_b32 v14, 128, v11
    ds_read_b128 v[176:179], v14 offset:0
    s_waitcnt lgkmcnt(11)
    v_mfma_f32_32x32x16_bf16 v[64:79], v[16:19], v[136:139], v[64:79]
    ds_read_b64_tr_b16 v[16:17], v0 offset:45056
    ds_read_b64_tr_b16 v[18:19], v0 offset:46080
    v_xor_b32 v14, 160, v11
    ds_read_b128 v[180:183], v14 offset:0
    s_waitcnt lgkmcnt(11)
    v_mfma_f32_32x32x16_bf16 v[80:95], v[20:23], v[136:139], v[80:95]
    ds_read_b64_tr_b16 v[20:21], v1 offset:45056
    ds_read_b64_tr_b16 v[22:23], v1 offset:46080
    v_xor_b32 v14, 192, v11
    ds_read_b128 v[184:187], v14 offset:0
    s_waitcnt lgkmcnt(11)
    v_mfma_f32_32x32x16_bf16 v[96:111], v[24:27], v[136:139], v[96:111]
    ds_read_b64_tr_b16 v[24:25], v2 offset:45056
    ds_read_b64_tr_b16 v[26:27], v2 offset:46080
    v_xor_b32 v14, 224, v11
    ds_read_b128 v[188:191], v14 offset:0
    v_mov_b32 v15, 3
    ds_write_b32 v4, v15 offset:96
    s_waitcnt lgkmcnt(12)
    v_mfma_f32_32x32x16_bf16 v[112:127], v[28:31], v[136:139], v[112:127]
    ds_read_b64_tr_b16 v[28:29], v3 offset:45056
    ds_read_b64_tr_b16 v[30:31], v3 offset:46080
    v_mov_b32 v7, 3
    ds_write_b32 v5, v7 offset:48
    s_waitcnt lgkmcnt(11)
    v_mfma_f32_32x32x16_bf16 v[64:79], v[16:19], v[140:143], v[64:79]
    v_subrev_u32 v0, 98304, v0
    v_subrev_u32 v1, 98304, v1
    v_subrev_u32 v2, 98304, v2
    v_subrev_u32 v3, 98304, v3
    v_readfirstlane_b32 s54, v6
    s_nop 0
    s_cmp_ge_u32 s54, 4
    s_cbranch_scc0 LC67
LC67_ret:
    ds_read_b64_tr_b16 v[16:17], v0 offset:0
    ds_read_b64_tr_b16 v[18:19], v0 offset:1024
    s_waitcnt lgkmcnt(10)
    v_mfma_f32_32x32x16_bf16 v[80:95], v[20:23], v[140:143], v[80:95]
    ds_read_b64_tr_b16 v[20:21], v1 offset:0
    ds_read_b64_tr_b16 v[22:23], v1 offset:1024
    s_waitcnt lgkmcnt(9)
    v_mfma_f32_32x32x16_bf16 v[96:111], v[24:27], v[140:143], v[96:111]
    ds_read_b64_tr_b16 v[24:25], v2 offset:0
    ds_read_b64_tr_b16 v[26:27], v2 offset:1024
    s_waitcnt lgkmcnt(7)
    v_mfma_f32_32x32x16_bf16 v[112:127], v[28:31], v[140:143], v[112:127]
    ds_read_b64_tr_b16 v[28:29], v3 offset:0
    ds_read_b64_tr_b16 v[30:31], v3 offset:1024
    s_waitcnt lgkmcnt(6)
    v_mfma_f32_32x32x16_bf16 v[64:79], v[16:19], v[144:147], v[64:79]
    ds_read_b64_tr_b16 v[16:17], v0 offset:4096
    ds_read_b64_tr_b16 v[18:19], v0 offset:5120
    s_waitcnt lgkmcnt(6)
    v_mfma_f32_32x32x16_bf16 v[80:95], v[20:23], v[144:147], v[80:95]
    ds_read_b64_tr_b16 v[20:21], v1 offset:4096
    ds_read_b64_tr_b16 v[22:23], v1 offset:5120
    s_waitcnt lgkmcnt(6)
    v_mfma_f32_32x32x16_bf16 v[96:111], v[24:27], v[144:147], v[96:111]
    ds_read_b64_tr_b16 v[24:25], v2 offset:4096
    ds_read_b64_tr_b16 v[26:27], v2 offset:5120
    s_waitcnt lgkmcnt(6)
    v_mfma_f32_32x32x16_bf16 v[112:127], v[28:31], v[144:147], v[112:127]
    ds_read_b64_tr_b16 v[28:29], v3 offset:4096
    ds_read_b64_tr_b16 v[30:31], v3 offset:5120
    s_waitcnt lgkmcnt(6)
    v_mfma_f32_32x32x16_bf16 v[64:79], v[16:19], v[148:151], v[64:79]
    ds_read_b64_tr_b16 v[16:17], v0 offset:8192
    ds_read_b64_tr_b16 v[18:19], v0 offset:9216
    s_waitcnt lgkmcnt(6)
    v_mfma_f32_32x32x16_bf16 v[80:95], v[20:23], v[148:151], v[80:95]
    ds_read_b64_tr_b16 v[20:21], v1 offset:8192
    ds_read_b64_tr_b16 v[22:23], v1 offset:9216
    s_waitcnt lgkmcnt(6)
    v_mfma_f32_32x32x16_bf16 v[96:111], v[24:27], v[148:151], v[96:111]
    ds_read_b64_tr_b16 v[24:25], v2 offset:8192
    ds_read_b64_tr_b16 v[26:27], v2 offset:9216
    s_waitcnt lgkmcnt(6)
    v_mfma_f32_32x32x16_bf16 v[112:127], v[28:31], v[148:151], v[112:127]
    ds_read_b64_tr_b16 v[28:29], v3 offset:8192
    ds_read_b64_tr_b16 v[30:31], v3 offset:9216
    ds_read_b32 v6, v10 offset:4
    s_waitcnt lgkmcnt(7)
    v_mfma_f32_32x32x16_bf16 v[64:79], v[16:19], v[152:155], v[64:79]
    ds_read_b64_tr_b16 v[16:17], v0 offset:12288
    ds_read_b64_tr_b16 v[18:19], v0 offset:13312
    s_waitcnt lgkmcnt(7)
    v_mfma_f32_32x32x16_bf16 v[80:95], v[20:23], v[152:155], v[80:95]
    ds_read_b64_tr_b16 v[20:21], v1 offset:12288
    ds_read_b64_tr_b16 v[22:23], v1 offset:13312
    s_waitcnt lgkmcnt(7)
    v_mfma_f32_32x32x16_bf16 v[96:111], v[24:27], v[152:155], v[96:111]
    ds_read_b64_tr_b16 v[24:25], v2 offset:12288
    ds_read_b64_tr_b16 v[26:27], v2 offset:13312
    s_waitcnt lgkmcnt(7)
    v_mfma_f32_32x32x16_bf16 v[112:127], v[28:31], v[152:155], v[112:127]
    ds_read_b64_tr_b16 v[28:29], v3 offset:12288
    ds_read_b64_tr_b16 v[30:31], v3 offset:13312
    v_mov_b32 v7, 4
    ds_write_b32 v5, v7 offset:48
    s_waitcnt lgkmcnt(7)
    v_mfma_f32_32x32x16_bf16 v[64:79], v[16:19], v[156:159], v[64:79]
    v_add_u32 v0, 98304, v0
    v_add_u32 v1, 98304, v1
    v_add_u32 v2, 98304, v2
    v_add_u32 v3, 98304, v3
    v_readfirstlane_b32 s54, v6
    s_nop 0
    s_cmp_ge_u32 s54, 5
    s_cbranch_scc0 LC68
LC68_ret:
    ds_read_b64_tr_b16 v[16:17], v0 offset:0
    ds_read_b64_tr_b16 v[18:19], v0 offset:1024
    s_waitcnt lgkmcnt(7)
    v_mfma_f32_32x32x16_bf16 v[80:95], v[20:23], v[156:159], v[80:95]
    ds_read_b64_tr_b16 v[20:21], v1 offset:0
    ds_read_b64_tr_b16 v[22:23], v1 offset:1024
    s_waitcnt lgkmcnt(7)
    v_mfma_f32_32x32x16_bf16 v[96:111], v[24:27], v[156:159], v[96:111]
    ds_read_b64_tr_b16 v[24:25], v2 offset:0
    ds_read_b64_tr_b16 v[26:27], v2 offset:1024
    s_waitcnt lgkmcnt(7)
    v_mfma_f32_32x32x16_bf16 v[112:127], v[28:31], v[156:159], v[112:127]
    ds_read_b64_tr_b16 v[28:29], v3 offset:0
    ds_read_b64_tr_b16 v[30:31], v3 offset:1024
    s_waitcnt lgkmcnt(6)
    v_mfma_f32_32x32x16_bf16 v[64:79], v[16:19], v[160:163], v[64:79]
    ds_read_b64_tr_b16 v[16:17], v0 offset:4096
    ds_read_b64_tr_b16 v[18:19], v0 offset:5120
    ds_read_b32 v15, v4 offset:80
    s_waitcnt lgkmcnt(7)
    v_mfma_f32_32x32x16_bf16 v[80:95], v[20:23], v[160:163], v[80:95]
    ds_read_b64_tr_b16 v[20:21], v1 offset:4096
    ds_read_b64_tr_b16 v[22:23], v1 offset:5120
    s_waitcnt lgkmcnt(7)
    v_mfma_f32_32x32x16_bf16 v[96:111], v[24:27], v[160:163], v[96:111]
    ds_read_b64_tr_b16 v[24:25], v2 offset:4096
    ds_read_b64_tr_b16 v[26:27], v2 offset:5120
    s_waitcnt lgkmcnt(7)
    v_mfma_f32_32x32x16_bf16 v[112:127], v[28:31], v[160:163], v[112:127]
    ds_read_b64_tr_b16 v[28:29], v3 offset:4096
    ds_read_b64_tr_b16 v[30:31], v3 offset:5120
    s_waitcnt lgkmcnt(6)
    v_readfirstlane_b32 s54, v15
    s_nop 0
    s_cmp_ge_u32 s54, 4
    s_cbranch_scc0 LC69
LC69_ret:
    v_xor_b32 v14, 0, v11
    ds_read_b128 v[192:195], v14 offset:24576
    v_mfma_f32_32x32x16_bf16 v[64:79], v[16:19], v[164:167], v[64:79]
    ds_read_b64_tr_b16 v[16:17], v0 offset:8192
    ds_read_b64_tr_b16 v[18:19], v0 offset:9216
    v_xor_b32 v14, 32, v11
    ds_read_b128 v[196:199], v14 offset:24576
    s_waitcnt lgkmcnt(8)
    v_mfma_f32_32x32x16_bf16 v[80:95], v[20:23], v[164:167], v[80:95]
    ds_read_b64_tr_b16 v[20:21], v1 offset:8192
    ds_read_b64_tr_b16 v[22:23], v1 offset:9216
    v_xor_b32 v14, 64, v11
    ds_read_b128 v[200:203], v14 offset:24576
    s_waitcnt lgkmcnt(9)
    v_mfma_f32_32x32x16_bf16 v[96:111], v[24:27], v[164:167], v[96:111]
    ds_read_b64_tr_b16 v[24:25], v2 offset:8192
    ds_read_b64_tr_b16 v[26:27], v2 offset:9216
    v_xor_b32 v14, 96, v11
    ds_read_b128 v[204:207], v14 offset:24576
    s_waitcnt lgkmcnt(10)
    v_mfma_f32_32x32x16_bf16 v[112:127], v[28:31], v[164:167], v[112:127]
    ds_read_b64_tr_b16 v[28:29], v3 offset:8192
    ds_read_b64_tr_b16 v[30:31], v3 offset:9216
    ds_read_b32 v6, v10 offset:4
    v_xor_b32 v14, 128, v11
    ds_read_b128 v[208:211], v14 offset:24576
    s_waitcnt lgkmcnt(11)
    v_mfma_f32_32x32x16_bf16 v[64:79], v[16:19], v[168:171], v[64:79]
    ds_read_b64_tr_b16 v[16:17], v0 offset:12288
    ds_read_b64_tr_b16 v[18:19], v0 offset:13312
    v_xor_b32 v14, 160, v11
    ds_read_b128 v[212:215], v14 offset:24576
    s_waitcnt lgkmcnt(11)
    v_mfma_f32_32x32x16_bf16 v[80:95], v[20:23], v[168:171], v[80:95]
    ds_read_b64_tr_b16 v[20:21], v1 offset:12288
    ds_read_b64_tr_b16 v[22:23], v1 offset:13312
    v_xor_b32 v14, 192, v11
    ds_read_b128 v[216:219], v14 offset:24576
    s_waitcnt lgkmcnt(11)
    v_mfma_f32_32x32x16_bf16 v[96:111], v[24:27], v[168:171], v[96:111]
    ds_read_b64_tr_b16 v[24:25], v2 offset:12288
    ds_read_b64_tr_b16 v[26:27], v2 offset:13312
    v_xor_b32 v14, 224, v11
    ds_read_b128 v[220:223], v14 offset:24576
    v_mov_b32 v15, 4
    ds_write_b32 v4, v15 offset:96
    s_waitcnt lgkmcnt(12)
    v_mfma_f32_32x32x16_bf16 v[112:127], v[28:31], v[168:171], v[112:127]
    ds_read_b64_tr_b16 v[28:29], v3 offset:12288
    ds_read_b64_tr_b16 v[30:31], v3 offset:13312
    v_mov_b32 v7, 5
    ds_write_b32 v5, v7 offset:48
    s_waitcnt lgkmcnt(11)
    v_mfma_f32_32x32x16_bf16 v[64:79], v[16:19], v[172:175], v[64:79]
    v_readfirstlane_b32 s54, v6
    s_nop 0
    s_cmp_ge_u32 s54, 6
    s_cbranch_scc0 LC70
LC70_ret:
    ds_read_b64_tr_b16 v[16:17], v0 offset:16384
    ds_read_b64_tr_b16 v[18:19], v0 offset:17408
    s_waitcnt lgkmcnt(10)
    v_mfma_f32_32x32x16_bf16 v[80:95], v[20:23], v[172:175], v[80:95]
    ds_read_b64_tr_b16 v[20:21], v1 offset:16384
    ds_read_b64_tr_b16 v[22:23], v1 offset:17408
    s_waitcnt lgkmcnt(9)
    v_mfma_f32_32x32x16_bf16 v[96:111], v[24:27], v[172:175], v[96:111]
    ds_read_b64_tr_b16 v[24:25], v2 offset:16384
    ds_read_b64_tr_b16 v[26:27], v2 offset:17408
    s_waitcnt lgkmcnt(7)
    v_mfma_f32_32x32x16_bf16 v[112:127], v[28:31], v[172:175], v[112:127]
    ds_read_b64_tr_b16 v[28:29], v3 offset:16384
    ds_read_b64_tr_b16 v[30:31], v3 offset:17408
    s_waitcnt lgkmcnt(6)
    v_mfma_f32_32x32x16_bf16 v[64:79], v[16:19], v[176:179], v[64:79]
    ds_read_b64_tr_b16 v[16:17], v0 offset:20480
    ds_read_b64_tr_b16 v[18:19], v0 offset:21504
    s_waitcnt lgkmcnt(6)
    v_mfma_f32_32x32x16_bf16 v[80:95], v[20:23], v[176:179], v[80:95]
    ds_read_b64_tr_b16 v[20:21], v1 offset:20480
    ds_read_b64_tr_b16 v[22:23], v1 offset:21504
    s_waitcnt lgkmcnt(6)
    v_mfma_f32_32x32x16_bf16 v[96:111], v[24:27], v[176:179], v[96:111]
    ds_read_b64_tr_b16 v[24:25], v2 offset:20480
    ds_read_b64_tr_b16 v[26:27], v2 offset:21504
    s_waitcnt lgkmcnt(6)
    v_mfma_f32_32x32x16_bf16 v[112:127], v[28:31], v[176:179], v[112:127]
    ds_read_b64_tr_b16 v[28:29], v3 offset:20480
    ds_read_b64_tr_b16 v[30:31], v3 offset:21504
    s_waitcnt lgkmcnt(6)
    v_mfma_f32_32x32x16_bf16 v[64:79], v[16:19], v[180:183], v[64:79]
    ds_read_b64_tr_b16 v[16:17], v0 offset:24576
    ds_read_b64_tr_b16 v[18:19], v0 offset:25600
    s_waitcnt lgkmcnt(6)
    v_mfma_f32_32x32x16_bf16 v[80:95], v[20:23], v[180:183], v[80:95]
    ds_read_b64_tr_b16 v[20:21], v1 offset:24576
    ds_read_b64_tr_b16 v[22:23], v1 offset:25600
    s_waitcnt lgkmcnt(6)
    v_mfma_f32_32x32x16_bf16 v[96:111], v[24:27], v[180:183], v[96:111]
    ds_read_b64_tr_b16 v[24:25], v2 offset:24576
    ds_read_b64_tr_b16 v[26:27], v2 offset:25600
    s_waitcnt lgkmcnt(6)
    v_mfma_f32_32x32x16_bf16 v[112:127], v[28:31], v[180:183], v[112:127]
    ds_read_b64_tr_b16 v[28:29], v3 offset:24576
    ds_read_b64_tr_b16 v[30:31], v3 offset:25600
    ds_read_b32 v6, v10 offset:4
    s_waitcnt lgkmcnt(7)
    v_mfma_f32_32x32x16_bf16 v[64:79], v[16:19], v[184:187], v[64:79]
    ds_read_b64_tr_b16 v[16:17], v0 offset:28672
    ds_read_b64_tr_b16 v[18:19], v0 offset:29696
    s_waitcnt lgkmcnt(7)
    v_mfma_f32_32x32x16_bf16 v[80:95], v[20:23], v[184:187], v[80:95]
    ds_read_b64_tr_b16 v[20:21], v1 offset:28672
    ds_read_b64_tr_b16 v[22:23], v1 offset:29696
    s_waitcnt lgkmcnt(7)
    v_mfma_f32_32x32x16_bf16 v[96:111], v[24:27], v[184:187], v[96:111]
    ds_read_b64_tr_b16 v[24:25], v2 offset:28672
    ds_read_b64_tr_b16 v[26:27], v2 offset:29696
    s_waitcnt lgkmcnt(7)
    v_mfma_f32_32x32x16_bf16 v[112:127], v[28:31], v[184:187], v[112:127]
    ds_read_b64_tr_b16 v[28:29], v3 offset:28672
    ds_read_b64_tr_b16 v[30:31], v3 offset:29696
    v_mov_b32 v7, 6
    ds_write_b32 v5, v7 offset:48
    s_waitcnt lgkmcnt(7)
    v_mfma_f32_32x32x16_bf16 v[64:79], v[16:19], v[188:191], v[64:79]
    v_readfirstlane_b32 s54, v6
    s_nop 0
    s_cmp_ge_u32 s54, 7
    s_cbranch_scc0 LC71
LC71_ret:
    ds_read_b64_tr_b16 v[16:17], v0 offset:32768
    ds_read_b64_tr_b16 v[18:19], v0 offset:33792
    s_waitcnt lgkmcnt(7)
    v_mfma_f32_32x32x16_bf16 v[80:95], v[20:23], v[188:191], v[80:95]
    ds_read_b64_tr_b16 v[20:21], v1 offset:32768
    ds_read_b64_tr_b16 v[22:23], v1 offset:33792
    s_waitcnt lgkmcnt(7)
    v_mfma_f32_32x32x16_bf16 v[96:111], v[24:27], v[188:191], v[96:111]
    ds_read_b64_tr_b16 v[24:25], v2 offset:32768
    ds_read_b64_tr_b16 v[26:27], v2 offset:33792
    s_waitcnt lgkmcnt(7)
    v_mfma_f32_32x32x16_bf16 v[112:127], v[28:31], v[188:191], v[112:127]
    ds_read_b64_tr_b16 v[28:29], v3 offset:32768
    ds_read_b64_tr_b16 v[30:31], v3 offset:33792
    s_waitcnt lgkmcnt(6)
    v_mfma_f32_32x32x16_bf16 v[64:79], v[16:19], v[192:195], v[64:79]
    ds_read_b64_tr_b16 v[16:17], v0 offset:36864
    ds_read_b64_tr_b16 v[18:19], v0 offset:37888
    ds_read_b32 v15, v4 offset:80
    s_waitcnt lgkmcnt(7)
    v_mfma_f32_32x32x16_bf16 v[80:95], v[20:23], v[192:195], v[80:95]
    ds_read_b64_tr_b16 v[20:21], v1 offset:36864
    ds_read_b64_tr_b16 v[22:23], v1 offset:37888
    s_waitcnt lgkmcnt(7)
    v_mfma_f32_32x32x16_bf16 v[96:111], v[24:27], v[192:195], v[96:111]
    ds_read_b64_tr_b16 v[24:25], v2 offset:36864
    ds_read_b64_tr_b16 v[26:27], v2 offset:37888
    s_waitcnt lgkmcnt(7)
    v_mfma_f32_32x32x16_bf16 v[112:127], v[28:31], v[192:195], v[112:127]
    ds_read_b64_tr_b16 v[28:29], v3 offset:36864
    ds_read_b64_tr_b16 v[30:31], v3 offset:37888
    s_waitcnt lgkmcnt(6)
    v_readfirstlane_b32 s54, v15
    s_nop 0
    s_cmp_ge_u32 s54, 5
    s_cbranch_scc0 LC72
LC72_ret:
    v_xor_b32 v14, 0, v11
    ds_read_b128 v[224:227], v14 offset:0
    v_mfma_f32_32x32x16_bf16 v[64:79], v[16:19], v[196:199], v[64:79]
    ds_read_b64_tr_b16 v[16:17], v0 offset:40960
    ds_read_b64_tr_b16 v[18:19], v0 offset:41984
    v_xor_b32 v14, 32, v11
    ds_read_b128 v[228:231], v14 offset:0
    s_waitcnt lgkmcnt(8)
    v_mfma_f32_32x32x16_bf16 v[80:95], v[20:23], v[196:199], v[80:95]
    ds_read_b64_tr_b16 v[20:21], v1 offset:40960
    ds_read_b64_tr_b16 v[22:23], v1 offset:41984
    v_xor_b32 v14, 64, v11
    ds_read_b128 v[232:235], v14 offset:0
    s_waitcnt lgkmcnt(9)
    v_mfma_f32_32x32x16_bf16 v[96:111], v[24:27], v[196:199], v[96:111]
    ds_read_b64_tr_b16 v[24:25], v2 offset:40960
    ds_read_b64_tr_b16 v[26:27], v2 offset:41984
    v_xor_b32 v14, 96, v11
    ds_read_b128 v[236:239], v14 offset:0
    s_waitcnt lgkmcnt(10)
    v_mfma_f32_32x32x16_bf16 v[112:127], v[28:31], v[196:199], v[112:127]
    ds_read_b64_tr_b16 v[28:29], v3 offset:40960
    ds_read_b64_tr_b16 v[30:31], v3 offset:41984
    ds_read_b32 v6, v10 offset:4
    v_xor_b32 v14, 128, v11
    ds_read_b128 v[240:243], v14 offset:0
    s_waitcnt lgkmcnt(11)
    v_mfma_f32_32x32x16_bf16 v[64:79], v[16:19], v[200:203], v[64:79]
    ds_read_b64_tr_b16 v[16:17], v0 offset:45056
    ds_read_b64_tr_b16 v[18:19], v0 offset:46080
    v_xor_b32 v14, 160, v11
    ds_read_b128 v[244:247], v14 offset:0
    s_waitcnt lgkmcnt(11)
    v_mfma_f32_32x32x16_bf16 v[80:95], v[20:23], v[200:203], v[80:95]
    ds_read_b64_tr_b16 v[20:21], v1 offset:45056
    ds_read_b64_tr_b16 v[22:23], v1 offset:46080
    v_xor_b32 v14, 192, v11
    ds_read_b128 v[248:251], v14 offset:0
    s_waitcnt lgkmcnt(11)
    v_mfma_f32_32x32x16_bf16 v[96:111], v[24:27], v[200:203], v[96:111]
    ds_read_b64_tr_b16 v[24:25], v2 offset:45056
    ds_read_b64_tr_b16 v[26:27], v2 offset:46080
    v_xor_b32 v14, 224, v11
    ds_read_b128 v[252:255], v14 offset:0
    v_mov_b32 v15, 5
    ds_write_b32 v4, v15 offset:96
    s_waitcnt lgkmcnt(12)
    v_mfma_f32_32x32x16_bf16 v[112:127], v[28:31], v[200:203], v[112:127]
    ds_read_b64_tr_b16 v[28:29], v3 offset:45056
    ds_read_b64_tr_b16 v[30:31], v3 offset:46080
    v_mov_b32 v7, 7
    ds_write_b32 v5, v7 offset:48
    s_waitcnt lgkmcnt(11)
    v_mfma_f32_32x32x16_bf16 v[64:79], v[16:19], v[204:207], v[64:79]
    v_subrev_u32 v0, 98304, v0
    v_subrev_u32 v1, 98304, v1
    v_subrev_u32 v2, 98304, v2
    v_subrev_u32 v3, 98304, v3
    v_readfirstlane_b32 s54, v6
    s_nop 0
    s_cmp_ge_u32 s54, 8
    s_cbranch_scc0 LC73
LC73_ret:
    ds_read_b64_tr_b16 v[16:17], v0 offset:0
    ds_read_b64_tr_b16 v[18:19], v0 offset:1024
    s_waitcnt lgkmcnt(10)
    v_mfma_f32_32x32x16_bf16 v[80:95], v[20:23], v[204:207], v[80:95]
    ds_read_b64_tr_b16 v[20:21], v1 offset:0
    ds_read_b64_tr_b16 v[22:23], v1 offset:1024
    s_waitcnt lgkmcnt(9)
    v_mfma_f32_32x32x16_bf16 v[96:111], v[24:27], v[204:207], v[96:111]
    ds_read_b64_tr_b16 v[24:25], v2 offset:0
    ds_read_b64_tr_b16 v[26:27], v2 offset:1024
    s_waitcnt lgkmcnt(7)
    v_mfma_f32_32x32x16_bf16 v[112:127], v[28:31], v[204:207], v[112:127]
    ds_read_b64_tr_b16 v[28:29], v3 offset:0
    ds_read_b64_tr_b16 v[30:31], v3 offset:1024
    s_waitcnt lgkmcnt(6)
    v_mfma_f32_32x32x16_bf16 v[64:79], v[16:19], v[208:211], v[64:79]
    ds_read_b64_tr_b16 v[16:17], v0 offset:4096
    ds_read_b64_tr_b16 v[18:19], v0 offset:5120
    s_waitcnt lgkmcnt(6)
    v_mfma_f32_32x32x16_bf16 v[80:95], v[20:23], v[208:211], v[80:95]
    ds_read_b64_tr_b16 v[20:21], v1 offset:4096
    ds_read_b64_tr_b16 v[22:23], v1 offset:5120
    s_waitcnt lgkmcnt(6)
    v_mfma_f32_32x32x16_bf16 v[96:111], v[24:27], v[208:211], v[96:111]
    ds_read_b64_tr_b16 v[24:25], v2 offset:4096
    ds_read_b64_tr_b16 v[26:27], v2 offset:5120
    s_waitcnt lgkmcnt(6)
    v_mfma_f32_32x32x16_bf16 v[112:127], v[28:31], v[208:211], v[112:127]
    ds_read_b64_tr_b16 v[28:29], v3 offset:4096
    ds_read_b64_tr_b16 v[30:31], v3 offset:5120
    s_waitcnt lgkmcnt(6)
    v_mfma_f32_32x32x16_bf16 v[64:79], v[16:19], v[212:215], v[64:79]
    ds_read_b64_tr_b16 v[16:17], v0 offset:8192
    ds_read_b64_tr_b16 v[18:19], v0 offset:9216
    s_waitcnt lgkmcnt(6)
    v_mfma_f32_32x32x16_bf16 v[80:95], v[20:23], v[212:215], v[80:95]
    ds_read_b64_tr_b16 v[20:21], v1 offset:8192
    ds_read_b64_tr_b16 v[22:23], v1 offset:9216
    s_waitcnt lgkmcnt(6)
    v_mfma_f32_32x32x16_bf16 v[96:111], v[24:27], v[212:215], v[96:111]
    ds_read_b64_tr_b16 v[24:25], v2 offset:8192
    ds_read_b64_tr_b16 v[26:27], v2 offset:9216
    s_waitcnt lgkmcnt(6)
    v_mfma_f32_32x32x16_bf16 v[112:127], v[28:31], v[212:215], v[112:127]
    ds_read_b64_tr_b16 v[28:29], v3 offset:8192
    ds_read_b64_tr_b16 v[30:31], v3 offset:9216
    ds_read_b32 v6, v10 offset:4
    s_waitcnt lgkmcnt(7)
    v_mfma_f32_32x32x16_bf16 v[64:79], v[16:19], v[216:219], v[64:79]
    ds_read_b64_tr_b16 v[16:17], v0 offset:12288
    ds_read_b64_tr_b16 v[18:19], v0 offset:13312
    s_waitcnt lgkmcnt(7)
    v_mfma_f32_32x32x16_bf16 v[80:95], v[20:23], v[216:219], v[80:95]
    ds_read_b64_tr_b16 v[20:21], v1 offset:12288
    ds_read_b64_tr_b16 v[22:23], v1 offset:13312
    s_waitcnt lgkmcnt(7)
    v_mfma_f32_32x32x16_bf16 v[96:111], v[24:27], v[216:219], v[96:111]
    ds_read_b64_tr_b16 v[24:25], v2 offset:12288
    ds_read_b64_tr_b16 v[26:27], v2 offset:13312
    s_waitcnt lgkmcnt(7)
    v_mfma_f32_32x32x16_bf16 v[112:127], v[28:31], v[216:219], v[112:127]
    ds_read_b64_tr_b16 v[28:29], v3 offset:12288
    ds_read_b64_tr_b16 v[30:31], v3 offset:13312
    v_mov_b32 v7, 8
    ds_write_b32 v5, v7 offset:48
    s_waitcnt lgkmcnt(7)
    v_mfma_f32_32x32x16_bf16 v[64:79], v[16:19], v[220:223], v[64:79]
    v_add_u32 v0, 98304, v0
    v_add_u32 v1, 98304, v1
    v_add_u32 v2, 98304, v2
    v_add_u32 v3, 98304, v3
    v_readfirstlane_b32 s54, v6
    s_nop 0
    s_cmp_ge_u32 s54, 9
    s_cbranch_scc0 LC74
LC74_ret:
    ds_read_b64_tr_b16 v[16:17], v0 offset:0
    ds_read_b64_tr_b16 v[18:19], v0 offset:1024
    s_waitcnt lgkmcnt(7)
    v_mfma_f32_32x32x16_bf16 v[80:95], v[20:23], v[220:223], v[80:95]
    ds_read_b64_tr_b16 v[20:21], v1 offset:0
    ds_read_b64_tr_b16 v[22:23], v1 offset:1024
    s_waitcnt lgkmcnt(7)
    v_mfma_f32_32x32x16_bf16 v[96:111], v[24:27], v[220:223], v[96:111]
    ds_read_b64_tr_b16 v[24:25], v2 offset:0
    ds_read_b64_tr_b16 v[26:27], v2 offset:1024
    s_waitcnt lgkmcnt(7)
    v_mfma_f32_32x32x16_bf16 v[112:127], v[28:31], v[220:223], v[112:127]
    ds_read_b64_tr_b16 v[28:29], v3 offset:0
    ds_read_b64_tr_b16 v[30:31], v3 offset:1024
    s_waitcnt lgkmcnt(6)
    v_mfma_f32_32x32x16_bf16 v[64:79], v[16:19], v[224:227], v[64:79]
    ds_read_b64_tr_b16 v[16:17], v0 offset:4096
    ds_read_b64_tr_b16 v[18:19], v0 offset:5120
    s_waitcnt lgkmcnt(6)
    v_mfma_f32_32x32x16_bf16 v[80:95], v[20:23], v[224:227], v[80:95]
    ds_read_b64_tr_b16 v[20:21], v1 offset:4096
    ds_read_b64_tr_b16 v[22:23], v1 offset:5120
    s_waitcnt lgkmcnt(6)
    v_mfma_f32_32x32x16_bf16 v[96:111], v[24:27], v[224:227], v[96:111]
    ds_read_b64_tr_b16 v[24:25], v2 offset:4096
    ds_read_b64_tr_b16 v[26:27], v2 offset:5120
    s_waitcnt lgkmcnt(6)
    v_mfma_f32_32x32x16_bf16 v[112:127], v[28:31], v[224:227], v[112:127]
    ds_read_b64_tr_b16 v[28:29], v3 offset:4096
    ds_read_b64_tr_b16 v[30:31], v3 offset:5120
    s_waitcnt lgkmcnt(6)
    v_mfma_f32_32x32x16_bf16 v[64:79], v[16:19], v[228:231], v[64:79]
    ds_read_b64_tr_b16 v[16:17], v0 offset:8192
    ds_read_b64_tr_b16 v[18:19], v0 offset:9216
    s_waitcnt lgkmcnt(6)
    v_mfma_f32_32x32x16_bf16 v[80:95], v[20:23], v[228:231], v[80:95]
    ds_read_b64_tr_b16 v[20:21], v1 offset:8192
    ds_read_b64_tr_b16 v[22:23], v1 offset:9216
    s_waitcnt lgkmcnt(6)
    v_mfma_f32_32x32x16_bf16 v[96:111], v[24:27], v[228:231], v[96:111]
    ds_read_b64_tr_b16 v[24:25], v2 offset:8192
    ds_read_b64_tr_b16 v[26:27], v2 offset:9216
    s_waitcnt lgkmcnt(6)
    v_mfma_f32_32x32x16_bf16 v[112:127], v[28:31], v[228:231], v[112:127]
    ds_read_b64_tr_b16 v[28:29], v3 offset:8192
    ds_read_b64_tr_b16 v[30:31], v3 offset:9216
    ds_read_b32 v6, v10 offset:4
    s_waitcnt lgkmcnt(7)
    v_mfma_f32_32x32x16_bf16 v[64:79], v[16:19], v[232:235], v[64:79]
    ds_read_b64_tr_b16 v[16:17], v0 offset:12288
    ds_read_b64_tr_b16 v[18:19], v0 offset:13312
    s_waitcnt lgkmcnt(7)
    v_mfma_f32_32x32x16_bf16 v[80:95], v[20:23], v[232:235], v[80:95]
    ds_read_b64_tr_b16 v[20:21], v1 offset:12288
    ds_read_b64_tr_b16 v[22:23], v1 offset:13312
    s_waitcnt lgkmcnt(7)
    v_mfma_f32_32x32x16_bf16 v[96:111], v[24:27], v[232:235], v[96:111]
    ds_read_b64_tr_b16 v[24:25], v2 offset:12288
    ds_read_b64_tr_b16 v[26:27], v2 offset:13312
    s_waitcnt lgkmcnt(7)
    v_mfma_f32_32x32x16_bf16 v[112:127], v[28:31], v[232:235], v[112:127]
    ds_read_b64_tr_b16 v[28:29], v3 offset:12288
    ds_read_b64_tr_b16 v[30:31], v3 offset:13312
    v_mov_b32 v7, 9
    ds_write_b32 v5, v7 offset:48
    s_waitcnt lgkmcnt(7)
    v_mfma_f32_32x32x16_bf16 v[64:79], v[16:19], v[236:239], v[64:79]
    v_readfirstlane_b32 s54, v6
    s_nop 0
    s_cmp_ge_u32 s54, 10
    s_cbranch_scc0 LC75
LC75_ret:
    ds_read_b64_tr_b16 v[16:17], v0 offset:16384
    ds_read_b64_tr_b16 v[18:19], v0 offset:17408
    s_waitcnt lgkmcnt(7)
    v_mfma_f32_32x32x16_bf16 v[80:95], v[20:23], v[236:239], v[80:95]
    ds_read_b64_tr_b16 v[20:21], v1 offset:16384
    ds_read_b64_tr_b16 v[22:23], v1 offset:17408
    s_waitcnt lgkmcnt(7)
    v_mfma_f32_32x32x16_bf16 v[96:111], v[24:27], v[236:239], v[96:111]
    ds_read_b64_tr_b16 v[24:25], v2 offset:16384
    ds_read_b64_tr_b16 v[26:27], v2 offset:17408
    s_waitcnt lgkmcnt(7)
    v_mfma_f32_32x32x16_bf16 v[112:127], v[28:31], v[236:239], v[112:127]
    ds_read_b64_tr_b16 v[28:29], v3 offset:16384
    ds_read_b64_tr_b16 v[30:31], v3 offset:17408
    s_waitcnt lgkmcnt(6)
    v_mfma_f32_32x32x16_bf16 v[64:79], v[16:19], v[240:243], v[64:79]
    ds_read_b64_tr_b16 v[16:17], v0 offset:20480
    ds_read_b64_tr_b16 v[18:19], v0 offset:21504
    s_waitcnt lgkmcnt(6)
    v_mfma_f32_32x32x16_bf16 v[80:95], v[20:23], v[240:243], v[80:95]
    ds_read_b64_tr_b16 v[20:21], v1 offset:20480
    ds_read_b64_tr_b16 v[22:23], v1 offset:21504
    s_waitcnt lgkmcnt(6)
    v_mfma_f32_32x32x16_bf16 v[96:111], v[24:27], v[240:243], v[96:111]
    ds_read_b64_tr_b16 v[24:25], v2 offset:20480
    ds_read_b64_tr_b16 v[26:27], v2 offset:21504
    s_waitcnt lgkmcnt(6)
    v_mfma_f32_32x32x16_bf16 v[112:127], v[28:31], v[240:243], v[112:127]
    ds_read_b64_tr_b16 v[28:29], v3 offset:20480
    ds_read_b64_tr_b16 v[30:31], v3 offset:21504
    s_waitcnt lgkmcnt(6)
    v_mfma_f32_32x32x16_bf16 v[64:79], v[16:19], v[244:247], v[64:79]
    ds_read_b64_tr_b16 v[16:17], v0 offset:24576
    ds_read_b64_tr_b16 v[18:19], v0 offset:25600
    s_waitcnt lgkmcnt(6)
    v_mfma_f32_32x32x16_bf16 v[80:95], v[20:23], v[244:247], v[80:95]
    ds_read_b64_tr_b16 v[20:21], v1 offset:24576
    ds_read_b64_tr_b16 v[22:23], v1 offset:25600
    s_waitcnt lgkmcnt(6)
    v_mfma_f32_32x32x16_bf16 v[96:111], v[24:27], v[244:247], v[96:111]
    ds_read_b64_tr_b16 v[24:25], v2 offset:24576
    ds_read_b64_tr_b16 v[26:27], v2 offset:25600
    s_waitcnt lgkmcnt(6)
    v_mfma_f32_32x32x16_bf16 v[112:127], v[28:31], v[244:247], v[112:127]
    ds_read_b64_tr_b16 v[28:29], v3 offset:24576
    ds_read_b64_tr_b16 v[30:31], v3 offset:25600
    s_waitcnt lgkmcnt(6)
    v_mfma_f32_32x32x16_bf16 v[64:79], v[16:19], v[248:251], v[64:79]
    ds_read_b64_tr_b16 v[16:17], v0 offset:28672
    ds_read_b64_tr_b16 v[18:19], v0 offset:29696
    s_waitcnt lgkmcnt(6)
    v_mfma_f32_32x32x16_bf16 v[80:95], v[20:23], v[248:251], v[80:95]
    ds_read_b64_tr_b16 v[20:21], v1 offset:28672
    ds_read_b64_tr_b16 v[22:23], v1 offset:29696
    s_waitcnt lgkmcnt(6)
    v_mfma_f32_32x32x16_bf16 v[96:111], v[24:27], v[248:251], v[96:111]
    ds_read_b64_tr_b16 v[24:25], v2 offset:28672
    ds_read_b64_tr_b16 v[26:27], v2 offset:29696
    s_waitcnt lgkmcnt(6)
    v_mfma_f32_32x32x16_bf16 v[112:127], v[28:31], v[248:251], v[112:127]
    ds_read_b64_tr_b16 v[28:29], v3 offset:28672
    ds_read_b64_tr_b16 v[30:31], v3 offset:29696
    v_mov_b32 v7, 10
    ds_write_b32 v5, v7 offset:48
    s_waitcnt lgkmcnt(7)
    v_mfma_f32_32x32x16_bf16 v[64:79], v[16:19], v[252:255], v[64:79]
    s_waitcnt lgkmcnt(5)
    v_mfma_f32_32x32x16_bf16 v[80:95], v[20:23], v[252:255], v[80:95]
    s_waitcnt lgkmcnt(3)
    v_mfma_f32_32x32x16_bf16 v[96:111], v[24:27], v[252:255], v[96:111]
    s_waitcnt lgkmcnt(1)
    v_mfma_f32_32x32x16_bf16 v[112:127], v[28:31], v[252:255], v[112:127]
    s_nop 5
    v_cvt_pk_bf16_f32 v32, v64, v65
    v_cvt_pk_bf16_f32 v33, v66, v67
    v_cvt_pk_bf16_f32 v34, v68, v69
    v_cvt_pk_bf16_f32 v35, v70, v71
    v_cvt_pk_bf16_f32 v36, v72, v73
    v_cvt_pk_bf16_f32 v37, v74, v75
    v_cvt_pk_bf16_f32 v38, v76, v77
    v_cvt_pk_bf16_f32 v39, v78, v79
    v_cvt_pk_bf16_f32 v40, v80, v81
    v_cvt_pk_bf16_f32 v41, v82, v83
    v_cvt_pk_bf16_f32 v42, v84, v85
    v_cvt_pk_bf16_f32 v43, v86, v87
    v_cvt_pk_bf16_f32 v44, v88, v89
    v_cvt_pk_bf16_f32 v45, v90, v91
    v_cvt_pk_bf16_f32 v46, v92, v93
    v_cvt_pk_bf16_f32 v47, v94, v95
    v_cvt_pk_bf16_f32 v48, v96, v97
    v_cvt_pk_bf16_f32 v49, v98, v99
    v_cvt_pk_bf16_f32 v50, v100, v101
    v_cvt_pk_bf16_f32 v51, v102, v103
    v_cvt_pk_bf16_f32 v52, v104, v105
    v_cvt_pk_bf16_f32 v53, v106, v107
    v_cvt_pk_bf16_f32 v54, v108, v109
    v_cvt_pk_bf16_f32 v55, v110, v111
    v_cvt_pk_bf16_f32 v56, v112, v113
    v_cvt_pk_bf16_f32 v57, v114, v115
    v_cvt_pk_bf16_f32 v58, v116, v117
    v_cvt_pk_bf16_f32 v59, v118, v119
    v_cvt_pk_bf16_f32 v60, v120, v121
    v_cvt_pk_bf16_f32 v61, v122, v123
    v_cvt_pk_bf16_f32 v62, v124, v125
    v_cvt_pk_bf16_f32 v63, v126, v127
    s_nop 1
    s_branch LA_attn
LA_qb:
    s_mov_b32 s32, s16
    s_and_b32 s33, s17, 0xffff
    s_mov_b32 s34, 1966080
    s_mov_b32 s35, 0x20000
    v_lshrrev_b32 v68, 4, v16
    v_xor_b32 v69, v19, v68
    v_lshlrev_b32 v69, 4, v69
    v_mul_u32_u24 v68, 1280, v68
    v_add_u32 v64, v68, v69
    v_xor_b32 v65, 64, v69
    v_xor_b32 v66, 0x80, v69
    v_xor_b32 v67, 0xc0, v69
    v_add_u32 v65, v68, v65
    v_add_u32 v66, v68, v66
    v_add_u32 v67, v68, v67
    v_add_u32 v65, 4096, v65
    v_add_u32 v66, 8192, v66
    v_add_u32 v67, 12288, v67
    s_mul_i32 s5, s6, 122880
    s_mul_i32 s12, s8, 40960
    s_add_u32 s5, s5, s12
    s_add_u32 s12, s4, 49152
    s_mov_b32 m0, s12
    s_lshl_b32 s13, s97, 8
    s_add_u32 s13, s13, s5
    s_add_u32 s13, s13, 0
    buffer_load_dwordx4 v64, s[32:35], s13 offen offset:0 lds
    buffer_load_dwordx4 v65, s[32:35], s13 offen offset:1024 lds
    buffer_load_dwordx4 v66, s[32:35], s13 offen offset:2048 lds
    buffer_load_dwordx4 v67, s[32:35], s13 offen offset:3072 lds
    s_add_u32 s12, s4, 53248
    s_mov_b32 m0, s12
    s_lshl_b32 s13, s97, 8
    s_add_u32 s13, s13, s5
    s_add_u32 s13, s13, 20480
    buffer_load_dwordx4 v64, s[32:35], s13 offen offset:0 lds
    buffer_load_dwordx4 v65, s[32:35], s13 offen offset:1024 lds
    buffer_load_dwordx4 v66, s[32:35], s13 offen offset:2048 lds
    buffer_load_dwordx4 v67, s[32:35], s13 offen offset:3072 lds
    s_barrier
    s_waitcnt vmcnt(0)
    v_mov_b32 v7, 1
    ds_write_b32 v4, v7 offset:80
    s_add_u32 s12, s4, 73728
    s_mov_b32 m0, s12
    s_lshl_b32 s13, s98, 8
    s_add_u32 s13, s13, s5
    s_add_u32 s13, s13, 0
    buffer_load_dwordx4 v64, s[32:35], s13 offen offset:0 lds
    buffer_load_dwordx4 v65, s[32:35], s13 offen offset:1024 lds
    buffer_load_dwordx4 v66, s[32:35], s13 offen offset:2048 lds
    buffer_load_dwordx4 v67, s[32:35], s13 offen offset:3072 lds
    s_add_u32 s12, s4, 77824
    s_mov_b32 m0, s12
    s_lshl_b32 s13, s98, 8
    s_add_u32 s13, s13, s5
    s_add_u32 s13, s13, 20480
    buffer_load_dwordx4 v64, s[32:35], s13 offen offset:0 lds
    buffer_load_dwordx4 v65, s[32:35], s13 offen offset:1024 lds
    buffer_load_dwordx4 v66, s[32:35], s13 offen offset:2048 lds
    buffer_load_dwordx4 v67, s[32:35], s13 offen offset:3072 lds
    v_xor_b32 v14, 0, v11
    ds_read_b128 v[32:35], v14 offset:0
    v_xor_b32 v15, 32, v11
    ds_read_b128 v[36:39], v15 offset:0
    v_xor_b32 v14, 64, v11
    ds_read_b128 v[40:43], v14 offset:0
    v_xor_b32 v15, 96, v11
    ds_read_b128 v[44:47], v15 offset:0
    v_xor_b32 v14, 128, v11
    ds_read_b128 v[48:51], v14 offset:0
    v_xor_b32 v15, 160, v11
    ds_read_b128 v[52:55], v15 offset:0
    v_xor_b32 v14, 192, v11
    ds_read_b128 v[56:59], v14 offset:0
    v_xor_b32 v15, 224, v11
    ds_read_b128 v[60:63], v15 offset:0
    s_waitcnt lgkmcnt(0)
LP76:
    ds_read_b32 v6, v4 offset:96
    s_waitcnt lgkmcnt(0)
    v_readfirstlane_b32 s54, v6
    s_nop 0
    s_cmp_ge_u32 s54, 1
    s_nop 2
    s_cbranch_scc1 LP76_ok
    s_sleep 1
    s_branch LP76
LP76_ok:
    s_add_u32 s12, s4, 49152
    s_mov_b32 m0, s12
    s_lshl_b32 s13, s99, 8
    s_add_u32 s13, s13, s5
    s_add_u32 s13, s13, 0
    buffer_load_dwordx4 v64, s[32:35], s13 offen offset:0 lds
    buffer_load_dwordx4 v65, s[32:35], s13 offen offset:1024 lds
    buffer_load_dwordx4 v66, s[32:35], s13 offen offset:2048 lds
    buffer_load_dwordx4 v67, s[32:35], s13 offen offset:3072 lds
    s_add_u32 s12, s4, 53248
    s_mov_b32 m0, s12
    s_lshl_b32 s13, s99, 8
    s_add_u32 s13, s13, s5
    s_add_u32 s13, s13, 20480
    buffer_load_dwordx4 v64, s[32:35], s13 offen offset:0 lds
    buffer_load_dwordx4 v65, s[32:35], s13 offen offset:1024 lds
    buffer_load_dwordx4 v66, s[32:35], s13 offen offset:2048 lds
    buffer_load_dwordx4 v67, s[32:35], s13 offen offset:3072 lds
    s_waitcnt vmcnt(8)
    v_mov_b32 v7, 2
    ds_write_b32 v4, v7 offset:80
    v_xor_b32 v14, 0, v11
    ds_read_b128 v[128:131], v14 offset:24576
    v_xor_b32 v15, 32, v11
    ds_read_b128 v[132:135], v15 offset:24576
    v_xor_b32 v14, 64, v11
    ds_read_b128 v[136:139], v14 offset:24576
    v_xor_b32 v15, 96, v11
    ds_read_b128 v[140:143], v15 offset:24576
    v_xor_b32 v14, 128, v11
    ds_read_b128 v[144:147], v14 offset:24576
    v_xor_b32 v15, 160, v11
    ds_read_b128 v[148:151], v15 offset:24576
    v_xor_b32 v14, 192, v11
    ds_read_b128 v[152:155], v14 offset:24576
    v_xor_b32 v15, 224, v11
    ds_read_b128 v[156:159], v15 offset:24576
    s_waitcnt lgkmcnt(0)
LP77:
    ds_read_b32 v6, v4 offset:96
    s_waitcnt lgkmcnt(0)
    v_readfirstlane_b32 s54, v6
    s_nop 0
    s_cmp_ge_u32 s54, 2
    s_nop 2
    s_cbranch_scc1 LP77_ok
    s_sleep 1
    s_branch LP77
LP77_ok:
    s_add_u32 s12, s4, 73728
    s_mov_b32 m0, s12
    s_lshl_b32 s13, s100, 8
    s_add_u32 s13, s13, s5
    s_add_u32 s13, s13, 0
    buffer_load_dwordx4 v64, s[32:35], s13 offen offset:0 lds
    buffer_load_dwordx4 v65, s[32:35], s13 offen offset:1024 lds
    buffer_load_dwordx4 v66, s[32:35], s13 offen offset:2048 lds
    buffer_load_dwordx4 v67, s[32:35], s13 offen offset:3072 lds
    s_add_u32 s12, s4, 77824
    s_mov_b32 m0, s12
    s_lshl_b32 s13, s100, 8
    s_add_u32 s13, s13, s5
    s_add_u32 s13, s13, 20480
    buffer_load_dwordx4 v64, s[32:35], s13 offen offset:0 lds
    buffer_load_dwordx4 v65, s[32:35], s13 offen offset:1024 lds
    buffer_load_dwordx4 v66, s[32:35], s13 offen offset:2048 lds
    buffer_load_dwordx4 v67, s[32:35], s13 offen offset:3072 lds
    s_waitcnt vmcnt(8)
    v_mov_b32 v7, 3
    ds_write_b32 v4, v7 offset:80
    v_xor_b32 v14, 0, v11
    ds_read_b128 v[160:163], v14 offset:0
    v_xor_b32 v15, 32, v11
    ds_read_b128 v[164:167], v15 offset:0
    v_xor_b32 v14, 64, v11
    ds_read_b128 v[168:171], v14 offset:0
    v_xor_b32 v15, 96, v11
    ds_read_b128 v[172:175], v15 offset:0
    v_xor_b32 v14, 128, v11
    ds_read_b128 v[176:179], v14 offset:0
    v_xor_b32 v15, 160, v11
    ds_read_b128 v[180:183], v15 offset:0
    v_xor_b32 v14, 192, v11
    ds_read_b128 v[184:187], v14 offset:0
    v_xor_b32 v15, 224, v11
    ds_read_b128 v[188:191], v15 offset:0
    s_waitcnt lgkmcnt(0)
LP78:
    ds_read_b32 v6, v4 offset:96
    s_waitcnt lgkmcnt(0)
    v_readfirstlane_b32 s54, v6
    s_nop 0
    s_cmp_ge_u32 s54, 3
    s_nop 2
    s_cbranch_scc1 LP78_ok
    s_sleep 1
    s_branch LP78
LP78_ok:
    s_add_u32 s12, s4, 49152
    s_mov_b32 m0, s12
    s_lshl_b32 s13, s101, 8
    s_add_u32 s13, s13, s5
    s_add_u32 s13, s13, 0
    buffer_load_dwordx4 v64, s[32:35], s13 offen offset:0 lds
    buffer_load_dwordx4 v65, s[32:35], s13 offen offset:1024 lds
    buffer_load_dwordx4 v66, s[32:35], s13 offen offset:2048 lds
    buffer_load_dwordx4 v67, s[32:35], s13 offen offset:3072 lds
    s_add_u32 s12, s4, 53248
    s_mov_b32 m0, s12
    s_lshl_b32 s13, s101, 8
    s_add_u32 s13, s13, s5
    s_add_u32 s13, s13, 20480
    buffer_load_dwordx4 v64, s[32:35], s13 offen offset:0 lds
    buffer_load_dwordx4 v65, s[32:35], s13 offen offset:1024 lds
    buffer_load_dwordx4 v66, s[32:35], s13 offen offset:2048 lds
    buffer_load_dwordx4 v67, s[32:35], s13 offen offset:3072 lds
    s_waitcnt vmcnt(8)
    v_mov_b32 v7, 4
    ds_write_b32 v4, v7 offset:80
    v_xor_b32 v14, 0, v11
    ds_read_b128 v[192:195], v14 offset:24576
    v_xor_b32 v15, 32, v11
    ds_read_b128 v[196:199], v15 offset:24576
    v_xor_b32 v14, 64, v11
    ds_read_b128 v[200:203], v14 offset:24576
    v_xor_b32 v15, 96, v11
    ds_read_b128 v[204:207], v15 offset:24576
    v_xor_b32 v14, 128, v11
    ds_read_b128 v[208:211], v14 offset:24576
    v_xor_b32 v15, 160, v11
    ds_read_b128 v[212:215], v15 offset:24576
    v_xor_b32 v14, 192, v11
    ds_read_b128 v[216:219], v14 offset:24576
    v_xor_b32 v15, 224, v11
    ds_read_b128 v[220:223], v15 offset:24576
    s_waitcnt lgkmcnt(0)
    s_waitcnt vmcnt(0)
    v_mov_b32 v7, 5
    ds_write_b32 v4, v7 offset:80
    v_xor_b32 v14, 0, v11
    ds_read_b128 v[224:227], v14 offset:0
    v_xor_b32 v15, 32, v11
    ds_read_b128 v[228:231], v15 offset:0
    v_xor_b32 v14, 64, v11
    ds_read_b128 v[232:235], v14 offset:0
    v_xor_b32 v15, 96, v11
    ds_read_b128 v[236:239], v15 offset:0
    v_xor_b32 v14, 128, v11
    ds_read_b128 v[240:243], v14 offset:0
    v_xor_b32 v15, 160, v11
    ds_read_b128 v[244:247], v15 offset:0
    v_xor_b32 v14, 192, v11
    ds_read_b128 v[248:251], v14 offset:0
    v_xor_b32 v15, 224, v11
    ds_read_b128 v[252:255], v15 offset:0
    s_waitcnt lgkmcnt(0)
    ds_write_b32 v4, v7 offset:112
    s_cmp_eq_u32 s8, 0
    s_cbranch_scc0 LA_tagdone
    s_mov_b32 s53, 0
    s_mov_b32 s88, s28
    s_and_b32 s89, s29, 0xffff
    s_mov_b32 s90, 256
    s_mov_b32 s91, 0x20000
LA_tagwait:
    buffer_load_dword v7, off, s[88:91], 0 sc1
    s_add_u32 s53, s53, 1
    s_waitcnt vmcnt(0)
    v_readfirstlane_b32 s12, v7
    s_cmp_ge_u32 s53, 131072
    s_nop 3
    s_cbranch_scc1 LA_taggo
    s_cmp_lg_u32 s12, 0
    s_cbranch_scc1 LA_taggo
    s_sleep 4
    s_branch LA_tagwait
LA_taggo:
    ds_write_b32 v10, v7 offset:92
LA_tagdone:
    ds_read_b32 v6, v10 offset:4
    s_waitcnt lgkmcnt(0)
    v_readfirstlane_b32 s54, v6
    s_nop 0
    s_cmp_ge_u32 s54, 11
    s_cbranch_scc0 LC79
LC79_ret:
    ds_read_b64_tr_b16 v[16:17], v0 offset:32768
    ds_read_b64_tr_b16 v[18:19], v0 offset:33792
    ds_read_b64_tr_b16 v[20:21], v1 offset:32768
    ds_read_b64_tr_b16 v[22:23], v1 offset:33792
    ds_read_b64_tr_b16 v[24:25], v2 offset:32768
    ds_read_b64_tr_b16 v[26:27], v2 offset:33792
    ds_read_b64_tr_b16 v[28:29], v3 offset:32768
    ds_read_b64_tr_b16 v[30:31], v3 offset:33792
    s_waitcnt lgkmcnt(6)
    v_mfma_f32_32x32x16_bf16 v[64:79], v[16:19], v[32:35], 0
    ds_read_b64_tr_b16 v[16:17], v0 offset:36864
    ds_read_b64_tr_b16 v[18:19], v0 offset:37888
    s_waitcnt lgkmcnt(6)
    v_mfma_f32_32x32x16_bf16 v[80:95], v[20:23], v[32:35], 0
    ds_read_b64_tr_b16 v[20:21], v1 offset:36864
    ds_read_b64_tr_b16 v[22:23], v1 offset:37888
    s_waitcnt lgkmcnt(6)
    v_mfma_f32_32x32x16_bf16 v[96:111], v[24:27], v[32:35], 0
    ds_read_b64_tr_b16 v[24:25], v2 offset:36864
    ds_read_b64_tr_b16 v[26:27], v2 offset:37888
    s_waitcnt lgkmcnt(6)
    v_mfma_f32_32x32x16_bf16 v[112:127], v[28:31], v[32:35], 0
    ds_read_b64_tr_b16 v[28:29], v3 offset:36864
    ds_read_b64_tr_b16 v[30:31], v3 offset:37888
    s_waitcnt lgkmcnt(6)
    v_mfma_f32_32x32x16_bf16 v[64:79], v[16:19], v[36:39], v[64:79]
    ds_read_b64_tr_b16 v[16:17], v0 offset:40960
    ds_read_b64_tr_b16 v[18:19], v0 offset:41984
    s_waitcnt lgkmcnt(6)
    v_mfma_f32_32x32x16_bf16 v[80:95], v[20:23], v[36:39], v[80:95]
    ds_read_b64_tr_b16 v[20:21], v1 offset:40960
    ds_read_b64_tr_b16 v[22:23], v1 offset:41984
    s_waitcnt lgkmcnt(6)
    v_mfma_f32_32x32x16_bf16 v[96:111], v[24:27], v[36:39], v[96:111]
    ds_read_b64_tr_b16 v[24:25], v2 offset:40960
    ds_read_b64_tr_b16 v[26:27], v2 offset:41984
    s_waitcnt lgkmcnt(6)
    v_mfma_f32_32x32x16_bf16 v[112:127], v[28:31], v[36:39], v[112:127]
    ds_read_b64_tr_b16 v[28:29], v3 offset:40960
    ds_read_b64_tr_b16 v[30:31], v3 offset:41984
    ds_read_b32 v6, v10 offset:4
    s_waitcnt lgkmcnt(7)
    v_mfma_f32_32x32x16_bf16 v[64:79], v[16:19], v[40:43], v[64:79]
    ds_read_b64_tr_b16 v[16:17], v0 offset:45056
    ds_read_b64_tr_b16 v[18:19], v0 offset:46080
    s_waitcnt lgkmcnt(7)
    v_mfma_f32_32x32x16_bf16 v[80:95], v[20:23], v[40:43], v[80:95]
    ds_read_b64_tr_b16 v[20:21], v1 offset:45056
    ds_read_b64_tr_b16 v[22:23], v1 offset:46080
    s_waitcnt lgkmcnt(7)
    v_mfma_f32_32x32x16_bf16 v[96:111], v[24:27], v[40:43], v[96:111]
    ds_read_b64_tr_b16 v[24:25], v2 offset:45056
    ds_read_b64_tr_b16 v[26:27], v2 offset:46080
    s_waitcnt lgkmcnt(7)
    v_mfma_f32_32x32x16_bf16 v[112:127], v[28:31], v[40:43], v[112:127]
    ds_read_b64_tr_b16 v[28:29], v3 offset:45056
    ds_read_b64_tr_b16 v[30:31], v3 offset:46080
    v_mov_b32 v7, 11
    ds_write_b32 v5, v7 offset:48
    s_waitcnt lgkmcnt(7)
    v_mfma_f32_32x32x16_bf16 v[64:79], v[16:19], v[44:47], v[64:79]
    v_readfirstlane_b32 s54, v6
    s_nop 0
    s_cmp_ge_u32 s54, 12
    s_cbranch_scc0 LC80
LC80_ret:
    ds_read_b64_tr_b16 v[16:17], v0 offset:0
    ds_read_b64_tr_b16 v[18:19], v0 offset:1024
    s_waitcnt lgkmcnt(7)
    v_mfma_f32_32x32x16_bf16 v[80:95], v[20:23], v[44:47], v[80:95]
    ds_read_b64_tr_b16 v[20:21], v1 offset:0
    ds_read_b64_tr_b16 v[22:23], v1 offset:1024
    s_waitcnt lgkmcnt(7)
    v_mfma_f32_32x32x16_bf16 v[96:111], v[24:27], v[44:47], v[96:111]
    ds_read_b64_tr_b16 v[24:25], v2 offset:0
    ds_read_b64_tr_b16 v[26:27], v2 offset:1024
    s_waitcnt lgkmcnt(7)
    v_mfma_f32_32x32x16_bf16 v[112:127], v[28:31], v[44:47], v[112:127]
    ds_read_b64_tr_b16 v[28:29], v3 offset:0
    ds_read_b64_tr_b16 v[30:31], v3 offset:1024
    s_waitcnt lgkmcnt(6)
    v_mfma_f32_32x32x16_bf16 v[64:79], v[16:19], v[48:51], v[64:79]
    ds_read_b64_tr_b16 v[16:17], v0 offset:4096
    ds_read_b64_tr_b16 v[18:19], v0 offset:5120
    s_waitcnt lgkmcnt(6)
    v_mfma_f32_32x32x16_bf16 v[80:95], v[20:23], v[48:51], v[80:95]
    ds_read_b64_tr_b16 v[20:21], v1 offset:4096
    ds_read_b64_tr_b16 v[22:23], v1 offset:5120
    s_waitcnt lgkmcnt(6)
    v_mfma_f32_32x32x16_bf16 v[96:111], v[24:27], v[48:51], v[96:111]
    ds_read_b64_tr_b16 v[24:25], v2 offset:4096
    ds_read_b64_tr_b16 v[26:27], v2 offset:5120
    s_waitcnt lgkmcnt(6)
    v_mfma_f32_32x32x16_bf16 v[112:127], v[28:31], v[48:51], v[112:127]
    ds_read_b64_tr_b16 v[28:29], v3 offset:4096
    ds_read_b64_tr_b16 v[30:31], v3 offset:5120
    s_waitcnt lgkmcnt(6)
    v_mfma_f32_32x32x16_bf16 v[64:79], v[16:19], v[52:55], v[64:79]
    ds_read_b64_tr_b16 v[16:17], v0 offset:8192
    ds_read_b64_tr_b16 v[18:19], v0 offset:9216
    s_waitcnt lgkmcnt(6)
    v_mfma_f32_32x32x16_bf16 v[80:95], v[20:23], v[52:55], v[80:95]
    ds_read_b64_tr_b16 v[20:21], v1 offset:8192
    ds_read_b64_tr_b16 v[22:23], v1 offset:9216
    s_waitcnt lgkmcnt(6)
    v_mfma_f32_32x32x16_bf16 v[96:111], v[24:27], v[52:55], v[96:111]
    ds_read_b64_tr_b16 v[24:25], v2 offset:8192
    ds_read_b64_tr_b16 v[26:27], v2 offset:9216
    s_waitcnt lgkmcnt(6)
    v_mfma_f32_32x32x16_bf16 v[112:127], v[28:31], v[52:55], v[112:127]
    ds_read_b64_tr_b16 v[28:29], v3 offset:8192
    ds_read_b64_tr_b16 v[30:31], v3 offset:9216
    ds_read_b32 v6, v10 offset:4
    s_waitcnt lgkmcnt(7)
    v_mfma_f32_32x32x16_bf16 v[64:79], v[16:19], v[56:59], v[64:79]
    ds_read_b64_tr_b16 v[16:17], v0 offset:12288
    ds_read_b64_tr_b16 v[18:19], v0 offset:13312
    s_waitcnt lgkmcnt(7)
    v_mfma_f32_32x32x16_bf16 v[80:95], v[20:23], v[56:59], v[80:95]
    ds_read_b64_tr_b16 v[20:21], v1 offset:12288
    ds_read_b64_tr_b16 v[22:23], v1 offset:13312
    s_waitcnt lgkmcnt(7)
    v_mfma_f32_32x32x16_bf16 v[96:111], v[24:27], v[56:59], v[96:111]
    ds_read_b64_tr_b16 v[24:25], v2 offset:12288
    ds_read_b64_tr_b16 v[26:27], v2 offset:13312
    s_waitcnt lgkmcnt(7)
    v_mfma_f32_32x32x16_bf16 v[112:127], v[28:31], v[56:59], v[112:127]
    ds_read_b64_tr_b16 v[28:29], v3 offset:12288
    ds_read_b64_tr_b16 v[30:31], v3 offset:13312
    v_mov_b32 v7, 12
    ds_write_b32 v5, v7 offset:48
    s_waitcnt lgkmcnt(7)
    v_mfma_f32_32x32x16_bf16 v[64:79], v[16:19], v[60:63], v[64:79]
    v_readfirstlane_b32 s54, v6
    s_nop 0
    s_cmp_ge_u32 s54, 13
    s_cbranch_scc0 LC81
LC81_ret:
    ds_read_b64_tr_b16 v[16:17], v0 offset:16384
    ds_read_b64_tr_b16 v[18:19], v0 offset:17408
    s_waitcnt lgkmcnt(7)
    v_mfma_f32_32x32x16_bf16 v[80:95], v[20:23], v[60:63], v[80:95]
    ds_read_b64_tr_b16 v[20:21], v1 offset:16384
    ds_read_b64_tr_b16 v[22:23], v1 offset:17408
    s_waitcnt lgkmcnt(7)
    v_mfma_f32_32x32x16_bf16 v[96:111], v[24:27], v[60:63], v[96:111]
    ds_read_b64_tr_b16 v[24:25], v2 offset:16384
    ds_read_b64_tr_b16 v[26:27], v2 offset:17408
    s_waitcnt lgkmcnt(7)
    v_mfma_f32_32x32x16_bf16 v[112:127], v[28:31], v[60:63], v[112:127]
    ds_read_b64_tr_b16 v[28:29], v3 offset:16384
    ds_read_b64_tr_b16 v[30:31], v3 offset:17408
    s_waitcnt lgkmcnt(6)
    v_mfma_f32_32x32x16_bf16 v[64:79], v[16:19], v[128:131], v[64:79]
    ds_read_b64_tr_b16 v[16:17], v0 offset:20480
    ds_read_b64_tr_b16 v[18:19], v0 offset:21504
    s_waitcnt lgkmcnt(6)
    v_mfma_f32_32x32x16_bf16 v[80:95], v[20:23], v[128:131], v[80:95]
    ds_read_b64_tr_b16 v[20:21], v1 offset:20480
    ds_read_b64_tr_b16 v[22:23], v1 offset:21504
    s_waitcnt lgkmcnt(6)
    v_mfma_f32_32x32x16_bf16 v[96:111], v[24:27], v[128:131], v[96:111]
    ds_read_b64_tr_b16 v[24:25], v2 offset:20480
    ds_read_b64_tr_b16 v[26:27], v2 offset:21504
    s_waitcnt lgkmcnt(6)
    v_mfma_f32_32x32x16_bf16 v[112:127], v[28:31], v[128:131], v[112:127]
    ds_read_b64_tr_b16 v[28:29], v3 offset:20480
    ds_read_b64_tr_b16 v[30:31], v3 offset:21504
    s_waitcnt lgkmcnt(6)
    v_mfma_f32_32x32x16_bf16 v[64:79], v[16:19], v[132:135], v[64:79]
    ds_read_b64_tr_b16 v[16:17], v0 offset:24576
    ds_read_b64_tr_b16 v[18:19], v0 offset:25600
    s_waitcnt lgkmcnt(6)
    v_mfma_f32_32x32x16_bf16 v[80:95], v[20:23], v[132:135], v[80:95]
    ds_read_b64_tr_b16 v[20:21], v1 offset:24576
    ds_read_b64_tr_b16 v[22:23], v1 offset:25600
    s_waitcnt lgkmcnt(6)
    v_mfma_f32_32x32x16_bf16 v[96:111], v[24:27], v[132:135], v[96:111]
    ds_read_b64_tr_b16 v[24:25], v2 offset:24576
    ds_read_b64_tr_b16 v[26:27], v2 offset:25600
    s_waitcnt lgkmcnt(6)
    v_mfma_f32_32x32x16_bf16 v[112:127], v[28:31], v[132:135], v[112:127]
    ds_read_b64_tr_b16 v[28:29], v3 offset:24576
    ds_read_b64_tr_b16 v[30:31], v3 offset:25600
    ds_read_b32 v6, v10 offset:4
    s_waitcnt lgkmcnt(7)
    v_mfma_f32_32x32x16_bf16 v[64:79], v[16:19], v[136:139], v[64:79]
    ds_read_b64_tr_b16 v[16:17], v0 offset:28672
    ds_read_b64_tr_b16 v[18:19], v0 offset:29696
    s_waitcnt lgkmcnt(7)
    v_mfma_f32_32x32x16_bf16 v[80:95], v[20:23], v[136:139], v[80:95]
    ds_read_b64_tr_b16 v[20:21], v1 offset:28672
    ds_read_b64_tr_b16 v[22:23], v1 offset:29696
    s_waitcnt lgkmcnt(7)
    v_mfma_f32_32x32x16_bf16 v[96:111], v[24:27], v[136:139], v[96:111]
    ds_read_b64_tr_b16 v[24:25], v2 offset:28672
    ds_read_b64_tr_b16 v[26:27], v2 offset:29696
    s_waitcnt lgkmcnt(7)
    v_mfma_f32_32x32x16_bf16 v[112:127], v[28:31], v[136:139], v[112:127]
    ds_read_b64_tr_b16 v[28:29], v3 offset:28672
    ds_read_b64_tr_b16 v[30:31], v3 offset:29696
    v_mov_b32 v7, 13
    ds_write_b32 v5, v7 offset:48
    s_waitcnt lgkmcnt(7)
    v_mfma_f32_32x32x16_bf16 v[64:79], v[16:19], v[140:143], v[64:79]
    v_readfirstlane_b32 s54, v6
    s_nop 0
    s_cmp_ge_u32 s54, 14
    s_cbranch_scc0 LC82
LC82_ret:
    ds_read_b64_tr_b16 v[16:17], v0 offset:32768
    ds_read_b64_tr_b16 v[18:19], v0 offset:33792
    s_waitcnt lgkmcnt(7)
    v_mfma_f32_32x32x16_bf16 v[80:95], v[20:23], v[140:143], v[80:95]
    ds_read_b64_tr_b16 v[20:21], v1 offset:32768
    ds_read_b64_tr_b16 v[22:23], v1 offset:33792
    s_waitcnt lgkmcnt(7)
    v_mfma_f32_32x32x16_bf16 v[96:111], v[24:27], v[140:143], v[96:111]
    ds_read_b64_tr_b16 v[24:25], v2 offset:32768
    ds_read_b64_tr_b16 v[26:27], v2 offset:33792
    s_waitcnt lgkmcnt(7)
    v_mfma_f32_32x32x16_bf16 v[112:127], v[28:31], v[140:143], v[112:127]
    ds_read_b64_tr_b16 v[28:29], v3 offset:32768
    ds_read_b64_tr_b16 v[30:31], v3 offset:33792
    s_waitcnt lgkmcnt(6)
    v_mfma_f32_32x32x16_bf16 v[64:79], v[16:19], v[144:147], v[64:79]
    ds_read_b64_tr_b16 v[16:17], v0 offset:36864
    ds_read_b64_tr_b16 v[18:19], v0 offset:37888
    s_waitcnt lgkmcnt(6)
    v_mfma_f32_32x32x16_bf16 v[80:95], v[20:23], v[144:147], v[80:95]
    ds_read_b64_tr_b16 v[20:21], v1 offset:36864
    ds_read_b64_tr_b16 v[22:23], v1 offset:37888
    s_waitcnt lgkmcnt(6)
    v_mfma_f32_32x32x16_bf16 v[96:111], v[24:27], v[144:147], v[96:111]
    ds_read_b64_tr_b16 v[24:25], v2 offset:36864
    ds_read_b64_tr_b16 v[26:27], v2 offset:37888
    s_waitcnt lgkmcnt(6)
    v_mfma_f32_32x32x16_bf16 v[112:127], v[28:31], v[144:147], v[112:127]
    ds_read_b64_tr_b16 v[28:29], v3 offset:36864
    ds_read_b64_tr_b16 v[30:31], v3 offset:37888
    s_waitcnt lgkmcnt(6)
    v_mfma_f32_32x32x16_bf16 v[64:79], v[16:19], v[148:151], v[64:79]
    ds_read_b64_tr_b16 v[16:17], v0 offset:40960
    ds_read_b64_tr_b16 v[18:19], v0 offset:41984
    s_waitcnt lgkmcnt(6)
    v_mfma_f32_32x32x16_bf16 v[80:95], v[20:23], v[148:151], v[80:95]
    ds_read_b64_tr_b16 v[20:21], v1 offset:40960
    ds_read_b64_tr_b16 v[22:23], v1 offset:41984
    s_waitcnt lgkmcnt(6)
    v_mfma_f32_32x32x16_bf16 v[96:111], v[24:27], v[148:151], v[96:111]
    ds_read_b64_tr_b16 v[24:25], v2 offset:40960
    ds_read_b64_tr_b16 v[26:27], v2 offset:41984
    s_waitcnt lgkmcnt(6)
    v_mfma_f32_32x32x16_bf16 v[112:127], v[28:31], v[148:151], v[112:127]
    ds_read_b64_tr_b16 v[28:29], v3 offset:40960
    ds_read_b64_tr_b16 v[30:31], v3 offset:41984
    ds_read_b32 v6, v10 offset:4
    s_waitcnt lgkmcnt(7)
    v_mfma_f32_32x32x16_bf16 v[64:79], v[16:19], v[152:155], v[64:79]
    ds_read_b64_tr_b16 v[16:17], v0 offset:45056
    ds_read_b64_tr_b16 v[18:19], v0 offset:46080
    s_waitcnt lgkmcnt(7)
    v_mfma_f32_32x32x16_bf16 v[80:95], v[20:23], v[152:155], v[80:95]
    ds_read_b64_tr_b16 v[20:21], v1 offset:45056
    ds_read_b64_tr_b16 v[22:23], v1 offset:46080
    s_waitcnt lgkmcnt(7)
    v_mfma_f32_32x32x16_bf16 v[96:111], v[24:27], v[152:155], v[96:111]
    ds_read_b64_tr_b16 v[24:25], v2 offset:45056
    ds_read_b64_tr_b16 v[26:27], v2 offset:46080
    s_waitcnt lgkmcnt(7)
    v_mfma_f32_32x32x16_bf16 v[112:127], v[28:31], v[152:155], v[112:127]
    ds_read_b64_tr_b16 v[28:29], v3 offset:45056
    ds_read_b64_tr_b16 v[30:31], v3 offset:46080
    v_mov_b32 v7, 14
    ds_write_b32 v5, v7 offset:48
    s_waitcnt lgkmcnt(7)
    v_mfma_f32_32x32x16_bf16 v[64:79], v[16:19], v[156:159], v[64:79]
    v_readfirstlane_b32 s54, v6
    s_nop 0
    s_cmp_ge_u32 s54, 15
    s_cbranch_scc0 LC83
LC83_ret:
    ds_read_b64_tr_b16 v[16:17], v0 offset:0
    ds_read_b64_tr_b16 v[18:19], v0 offset:1024
    s_waitcnt lgkmcnt(7)
    v_mfma_f32_32x32x16_bf16 v[80:95], v[20:23], v[156:159], v[80:95]
    ds_read_b64_tr_b16 v[20:21], v1 offset:0
    ds_read_b64_tr_b16 v[22:23], v1 offset:1024
    s_waitcnt lgkmcnt(7)
    v_mfma_f32_32x32x16_bf16 v[96:111], v[24:27], v[156:159], v[96:111]
    ds_read_b64_tr_b16 v[24:25], v2 offset:0
    ds_read_b64_tr_b16 v[26:27], v2 offset:1024
    s_waitcnt lgkmcnt(7)
    v_mfma_f32_32x32x16_bf16 v[112:127], v[28:31], v[156:159], v[112:127]
    ds_read_b64_tr_b16 v[28:29], v3 offset:0
    ds_read_b64_tr_b16 v[30:31], v3 offset:1024
    s_waitcnt lgkmcnt(6)
    v_mfma_f32_32x32x16_bf16 v[64:79], v[16:19], v[160:163], v[64:79]
    ds_read_b64_tr_b16 v[16:17], v0 offset:4096
    ds_read_b64_tr_b16 v[18:19], v0 offset:5120
    s_waitcnt lgkmcnt(6)
    v_mfma_f32_32x32x16_bf16 v[80:95], v[20:23], v[160:163], v[80:95]
    ds_read_b64_tr_b16 v[20:21], v1 offset:4096
    ds_read_b64_tr_b16 v[22:23], v1 offset:5120
    s_waitcnt lgkmcnt(6)
    v_mfma_f32_32x32x16_bf16 v[96:111], v[24:27], v[160:163], v[96:111]
    ds_read_b64_tr_b16 v[24:25], v2 offset:4096
    ds_read_b64_tr_b16 v[26:27], v2 offset:5120
    s_waitcnt lgkmcnt(6)
    v_mfma_f32_32x32x16_bf16 v[112:127], v[28:31], v[160:163], v[112:127]
    ds_read_b64_tr_b16 v[28:29], v3 offset:4096
    ds_read_b64_tr_b16 v[30:31], v3 offset:5120
    s_waitcnt lgkmcnt(6)
    v_mfma_f32_32x32x16_bf16 v[64:79], v[16:19], v[164:167], v[64:79]
    ds_read_b64_tr_b16 v[16:17], v0 offset:8192
    ds_read_b64_tr_b16 v[18:19], v0 offset:9216
    s_waitcnt lgkmcnt(6)
    v_mfma_f32_32x32x16_bf16 v[80:95], v[20:23], v[164:167], v[80:95]
    ds_read_b64_tr_b16 v[20:21], v1 offset:8192
    ds_read_b64_tr_b16 v[22:23], v1 offset:9216
    s_waitcnt lgkmcnt(6)
    v_mfma_f32_32x32x16_bf16 v[96:111], v[24:27], v[164:167], v[96:111]
    ds_read_b64_tr_b16 v[24:25], v2 offset:8192
    ds_read_b64_tr_b16 v[26:27], v2 offset:9216
    s_waitcnt lgkmcnt(6)
    v_mfma_f32_32x32x16_bf16 v[112:127], v[28:31], v[164:167], v[112:127]
    ds_read_b64_tr_b16 v[28:29], v3 offset:8192
    ds_read_b64_tr_b16 v[30:31], v3 offset:9216
    ds_read_b32 v6, v10 offset:4
    s_waitcnt lgkmcnt(7)
    v_mfma_f32_32x32x16_bf16 v[64:79], v[16:19], v[168:171], v[64:79]
    ds_read_b64_tr_b16 v[16:17], v0 offset:12288
    ds_read_b64_tr_b16 v[18:19], v0 offset:13312
    s_waitcnt lgkmcnt(7)
    v_mfma_f32_32x32x16_bf16 v[80:95], v[20:23], v[168:171], v[80:95]
    ds_read_b64_tr_b16 v[20:21], v1 offset:12288
    ds_read_b64_tr_b16 v[22:23], v1 offset:13312
    s_waitcnt lgkmcnt(7)
    v_mfma_f32_32x32x16_bf16 v[96:111], v[24:27], v[168:171], v[96:111]
    ds_read_b64_tr_b16 v[24:25], v2 offset:12288
    ds_read_b64_tr_b16 v[26:27], v2 offset:13312
    s_waitcnt lgkmcnt(7)
    v_mfma_f32_32x32x16_bf16 v[112:127], v[28:31], v[168:171], v[112:127]
    ds_read_b64_tr_b16 v[28:29], v3 offset:12288
    ds_read_b64_tr_b16 v[30:31], v3 offset:13312
    v_mov_b32 v7, 15
    ds_write_b32 v5, v7 offset:48
    s_waitcnt lgkmcnt(7)
    v_mfma_f32_32x32x16_bf16 v[64:79], v[16:19], v[172:175], v[64:79]
    v_readfirstlane_b32 s54, v6
    s_nop 0
    s_cmp_ge_u32 s54, 16
    s_cbranch_scc0 LC84
LC84_ret:
    ds_read_b64_tr_b16 v[16:17], v0 offset:16384
    ds_read_b64_tr_b16 v[18:19], v0 offset:17408
    s_waitcnt lgkmcnt(7)
    v_mfma_f32_32x32x16_bf16 v[80:95], v[20:23], v[172:175], v[80:95]
    ds_read_b64_tr_b16 v[20:21], v1 offset:16384
    ds_read_b64_tr_b16 v[22:23], v1 offset:17408
    s_waitcnt lgkmcnt(7)
    v_mfma_f32_32x32x16_bf16 v[96:111], v[24:27], v[172:175], v[96:111]
    ds_read_b64_tr_b16 v[24:25], v2 offset:16384
    ds_read_b64_tr_b16 v[26:27], v2 offset:17408
    s_waitcnt lgkmcnt(7)
    v_mfma_f32_32x32x16_bf16 v[112:127], v[28:31], v[172:175], v[112:127]
    ds_read_b64_tr_b16 v[28:29], v3 offset:16384
    ds_read_b64_tr_b16 v[30:31], v3 offset:17408
    s_waitcnt lgkmcnt(6)
    v_mfma_f32_32x32x16_bf16 v[64:79], v[16:19], v[176:179], v[64:79]
    ds_read_b64_tr_b16 v[16:17], v0 offset:20480
    ds_read_b64_tr_b16 v[18:19], v0 offset:21504
    s_waitcnt lgkmcnt(6)
    v_mfma_f32_32x32x16_bf16 v[80:95], v[20:23], v[176:179], v[80:95]
    ds_read_b64_tr_b16 v[20:21], v1 offset:20480
    ds_read_b64_tr_b16 v[22:23], v1 offset:21504
    s_waitcnt lgkmcnt(6)
    v_mfma_f32_32x32x16_bf16 v[96:111], v[24:27], v[176:179], v[96:111]
    ds_read_b64_tr_b16 v[24:25], v2 offset:20480
    ds_read_b64_tr_b16 v[26:27], v2 offset:21504
    s_waitcnt lgkmcnt(6)
    v_mfma_f32_32x32x16_bf16 v[112:127], v[28:31], v[176:179], v[112:127]
    ds_read_b64_tr_b16 v[28:29], v3 offset:20480
    ds_read_b64_tr_b16 v[30:31], v3 offset:21504
    s_waitcnt lgkmcnt(6)
    v_mfma_f32_32x32x16_bf16 v[64:79], v[16:19], v[180:183], v[64:79]
    ds_read_b64_tr_b16 v[16:17], v0 offset:24576
    ds_read_b64_tr_b16 v[18:19], v0 offset:25600
    s_waitcnt lgkmcnt(6)
    v_mfma_f32_32x32x16_bf16 v[80:95], v[20:23], v[180:183], v[80:95]
    ds_read_b64_tr_b16 v[20:21], v1 offset:24576
    ds_read_b64_tr_b16 v[22:23], v1 offset:25600
    s_waitcnt lgkmcnt(6)
    v_mfma_f32_32x32x16_bf16 v[96:111], v[24:27], v[180:183], v[96:111]
    ds_read_b64_tr_b16 v[24:25], v2 offset:24576
    ds_read_b64_tr_b16 v[26:27], v2 offset:25600
    s_waitcnt lgkmcnt(6)
    v_mfma_f32_32x32x16_bf16 v[112:127], v[28:31], v[180:183], v[112:127]
    ds_read_b64_tr_b16 v[28:29], v3 offset:24576
    ds_read_b64_tr_b16 v[30:31], v3 offset:25600
    ds_read_b32 v6, v10 offset:4
    s_waitcnt lgkmcnt(7)
    v_mfma_f32_32x32x16_bf16 v[64:79], v[16:19], v[184:187], v[64:79]
    ds_read_b64_tr_b16 v[16:17], v0 offset:28672
    ds_read_b64_tr_b16 v[18:19], v0 offset:29696
    s_waitcnt lgkmcnt(7)
    v_mfma_f32_32x32x16_bf16 v[80:95], v[20:23], v[184:187], v[80:95]
    ds_read_b64_tr_b16 v[20:21], v1 offset:28672
    ds_read_b64_tr_b16 v[22:23], v1 offset:29696
    s_waitcnt lgkmcnt(7)
    v_mfma_f32_32x32x16_bf16 v[96:111], v[24:27], v[184:187], v[96:111]
    ds_read_b64_tr_b16 v[24:25], v2 offset:28672
    ds_read_b64_tr_b16 v[26:27], v2 offset:29696
    s_waitcnt lgkmcnt(7)
    v_mfma_f32_32x32x16_bf16 v[112:127], v[28:31], v[184:187], v[112:127]
    ds_read_b64_tr_b16 v[28:29], v3 offset:28672
    ds_read_b64_tr_b16 v[30:31], v3 offset:29696
    v_mov_b32 v7, 16
    ds_write_b32 v5, v7 offset:48
    s_waitcnt lgkmcnt(7)
    v_mfma_f32_32x32x16_bf16 v[64:79], v[16:19], v[188:191], v[64:79]
    v_readfirstlane_b32 s54, v6
    s_nop 0
    s_cmp_ge_u32 s54, 17
    s_cbranch_scc0 LC85
LC85_ret:
    ds_read_b64_tr_b16 v[16:17], v0 offset:32768
    ds_read_b64_tr_b16 v[18:19], v0 offset:33792
    s_waitcnt lgkmcnt(7)
    v_mfma_f32_32x32x16_bf16 v[80:95], v[20:23], v[188:191], v[80:95]
    ds_read_b64_tr_b16 v[20:21], v1 offset:32768
    ds_read_b64_tr_b16 v[22:23], v1 offset:33792
    s_waitcnt lgkmcnt(7)
    v_mfma_f32_32x32x16_bf16 v[96:111], v[24:27], v[188:191], v[96:111]
    ds_read_b64_tr_b16 v[24:25], v2 offset:32768
    ds_read_b64_tr_b16 v[26:27], v2 offset:33792
    s_waitcnt lgkmcnt(7)
    v_mfma_f32_32x32x16_bf16 v[112:127], v[28:31], v[188:191], v[112:127]
    ds_read_b64_tr_b16 v[28:29], v3 offset:32768
    ds_read_b64_tr_b16 v[30:31], v3 offset:33792
    s_waitcnt lgkmcnt(6)
    v_mfma_f32_32x32x16_bf16 v[64:79], v[16:19], v[192:195], v[64:79]
    ds_read_b64_tr_b16 v[16:17], v0 offset:36864
    ds_read_b64_tr_b16 v[18:19], v0 offset:37888
    s_waitcnt lgkmcnt(6)
    v_mfma_f32_32x32x16_bf16 v[80:95], v[20:23], v[192:195], v[80:95]
    ds_read_b64_tr_b16 v[20:21], v1 offset:36864
    ds_read_b64_tr_b16 v[22:23], v1 offset:37888
    s_waitcnt lgkmcnt(6)
    v_mfma_f32_32x32x16_bf16 v[96:111], v[24:27], v[192:195], v[96:111]
    ds_read_b64_tr_b16 v[24:25], v2 offset:36864
    ds_read_b64_tr_b16 v[26:27], v2 offset:37888
    s_waitcnt lgkmcnt(6)
    v_mfma_f32_32x32x16_bf16 v[112:127], v[28:31], v[192:195], v[112:127]
    ds_read_b64_tr_b16 v[28:29], v3 offset:36864
    ds_read_b64_tr_b16 v[30:31], v3 offset:37888
    s_waitcnt lgkmcnt(6)
    v_mfma_f32_32x32x16_bf16 v[64:79], v[16:19], v[196:199], v[64:79]
    ds_read_b64_tr_b16 v[16:17], v0 offset:40960
    ds_read_b64_tr_b16 v[18:19], v0 offset:41984
    s_waitcnt lgkmcnt(6)
    v_mfma_f32_32x32x16_bf16 v[80:95], v[20:23], v[196:199], v[80:95]
    ds_read_b64_tr_b16 v[20:21], v1 offset:40960
    ds_read_b64_tr_b16 v[22:23], v1 offset:41984
    s_waitcnt lgkmcnt(6)
    v_mfma_f32_32x32x16_bf16 v[96:111], v[24:27], v[196:199], v[96:111]
    ds_read_b64_tr_b16 v[24:25], v2 offset:40960
    ds_read_b64_tr_b16 v[26:27], v2 offset:41984
    s_waitcnt lgkmcnt(6)
    v_mfma_f32_32x32x16_bf16 v[112:127], v[28:31], v[196:199], v[112:127]
    ds_read_b64_tr_b16 v[28:29], v3 offset:40960
    ds_read_b64_tr_b16 v[30:31], v3 offset:41984
    ds_read_b32 v6, v10 offset:4
    s_waitcnt lgkmcnt(7)
    v_mfma_f32_32x32x16_bf16 v[64:79], v[16:19], v[200:203], v[64:79]
    ds_read_b64_tr_b16 v[16:17], v0 offset:45056
    ds_read_b64_tr_b16 v[18:19], v0 offset:46080
    s_waitcnt lgkmcnt(7)
    v_mfma_f32_32x32x16_bf16 v[80:95], v[20:23], v[200:203], v[80:95]
    ds_read_b64_tr_b16 v[20:21], v1 offset:45056
    ds_read_b64_tr_b16 v[22:23], v1 offset:46080
    s_waitcnt lgkmcnt(7)
    v_mfma_f32_32x32x16_bf16 v[96:111], v[24:27], v[200:203], v[96:111]
    ds_read_b64_tr_b16 v[24:25], v2 offset:45056
    ds_read_b64_tr_b16 v[26:27], v2 offset:46080
    s_waitcnt lgkmcnt(7)
    v_mfma_f32_32x32x16_bf16 v[112:127], v[28:31], v[200:203], v[112:127]
    ds_read_b64_tr_b16 v[28:29], v3 offset:45056
    ds_read_b64_tr_b16 v[30:31], v3 offset:46080
    v_mov_b32 v7, 17
    ds_write_b32 v5, v7 offset:48
    s_waitcnt lgkmcnt(7)
    v_mfma_f32_32x32x16_bf16 v[64:79], v[16:19], v[204:207], v[64:79]
    v_readfirstlane_b32 s54, v6
    s_nop 0
    s_cmp_ge_u32 s54, 18
    s_cbranch_scc0 LC86
LC86_ret:
    ds_read_b64_tr_b16 v[16:17], v0 offset:0
    ds_read_b64_tr_b16 v[18:19], v0 offset:1024
    s_waitcnt lgkmcnt(7)
    v_mfma_f32_32x32x16_bf16 v[80:95], v[20:23], v[204:207], v[80:95]
    ds_read_b64_tr_b16 v[20:21], v1 offset:0
    ds_read_b64_tr_b16 v[22:23], v1 offset:1024
    s_waitcnt lgkmcnt(7)
    v_mfma_f32_32x32x16_bf16 v[96:111], v[24:27], v[204:207], v[96:111]
    ds_read_b64_tr_b16 v[24:25], v2 offset:0
    ds_read_b64_tr_b16 v[26:27], v2 offset:1024
    s_waitcnt lgkmcnt(7)
    v_mfma_f32_32x32x16_bf16 v[112:127], v[28:31], v[204:207], v[112:127]
    ds_read_b64_tr_b16 v[28:29], v3 offset:0
    ds_read_b64_tr_b16 v[30:31], v3 offset:1024
    s_waitcnt lgkmcnt(6)
    v_mfma_f32_32x32x16_bf16 v[64:79], v[16:19], v[208:211], v[64:79]
    ds_read_b64_tr_b16 v[16:17], v0 offset:4096
    ds_read_b64_tr_b16 v[18:19], v0 offset:5120
    s_waitcnt lgkmcnt(6)
    v_mfma_f32_32x32x16_bf16 v[80:95], v[20:23], v[208:211], v[80:95]
    ds_read_b64_tr_b16 v[20:21], v1 offset:4096
    ds_read_b64_tr_b16 v[22:23], v1 offset:5120
    s_waitcnt lgkmcnt(6)
    v_mfma_f32_32x32x16_bf16 v[96:111], v[24:27], v[208:211], v[96:111]
    ds_read_b64_tr_b16 v[24:25], v2 offset:4096
    ds_read_b64_tr_b16 v[26:27], v2 offset:5120
    s_waitcnt lgkmcnt(6)
    v_mfma_f32_32x32x16_bf16 v[112:127], v[28:31], v[208:211], v[112:127]
    ds_read_b64_tr_b16 v[28:29], v3 offset:4096
    ds_read_b64_tr_b16 v[30:31], v3 offset:5120
    s_waitcnt lgkmcnt(6)
    v_mfma_f32_32x32x16_bf16 v[64:79], v[16:19], v[212:215], v[64:79]
    ds_read_b64_tr_b16 v[16:17], v0 offset:8192
    ds_read_b64_tr_b16 v[18:19], v0 offset:9216
    s_waitcnt lgkmcnt(6)
    v_mfma_f32_32x32x16_bf16 v[80:95], v[20:23], v[212:215], v[80:95]
    ds_read_b64_tr_b16 v[20:21], v1 offset:8192
    ds_read_b64_tr_b16 v[22:23], v1 offset:9216
    s_waitcnt lgkmcnt(6)
    v_mfma_f32_32x32x16_bf16 v[96:111], v[24:27], v[212:215], v[96:111]
    ds_read_b64_tr_b16 v[24:25], v2 offset:8192
    ds_read_b64_tr_b16 v[26:27], v2 offset:9216
    s_waitcnt lgkmcnt(6)
    v_mfma_f32_32x32x16_bf16 v[112:127], v[28:31], v[212:215], v[112:127]
    ds_read_b64_tr_b16 v[28:29], v3 offset:8192
    ds_read_b64_tr_b16 v[30:31], v3 offset:9216
    ds_read_b32 v6, v10 offset:4
    s_waitcnt lgkmcnt(7)
    v_mfma_f32_32x32x16_bf16 v[64:79], v[16:19], v[216:219], v[64:79]
    ds_read_b64_tr_b16 v[16:17], v0 offset:12288
    ds_read_b64_tr_b16 v[18:19], v0 offset:13312
    s_waitcnt lgkmcnt(7)
    v_mfma_f32_32x32x16_bf16 v[80:95], v[20:23], v[216:219], v[80:95]
    ds_read_b64_tr_b16 v[20:21], v1 offset:12288
    ds_read_b64_tr_b16 v[22:23], v1 offset:13312
    s_waitcnt lgkmcnt(7)
    v_mfma_f32_32x32x16_bf16 v[96:111], v[24:27], v[216:219], v[96:111]
    ds_read_b64_tr_b16 v[24:25], v2 offset:12288
    ds_read_b64_tr_b16 v[26:27], v2 offset:13312
    s_waitcnt lgkmcnt(7)
    v_mfma_f32_32x32x16_bf16 v[112:127], v[28:31], v[216:219], v[112:127]
    ds_read_b64_tr_b16 v[28:29], v3 offset:12288
    ds_read_b64_tr_b16 v[30:31], v3 offset:13312
    v_mov_b32 v7, 18
    ds_write_b32 v5, v7 offset:48
    s_waitcnt lgkmcnt(7)
    v_mfma_f32_32x32x16_bf16 v[64:79], v[16:19], v[220:223], v[64:79]
    v_readfirstlane_b32 s54, v6
    s_nop 0
    s_cmp_ge_u32 s54, 19
    s_cbranch_scc0 LC87
LC87_ret:
    ds_read_b64_tr_b16 v[16:17], v0 offset:16384
    ds_read_b64_tr_b16 v[18:19], v0 offset:17408
    s_waitcnt lgkmcnt(7)
    v_mfma_f32_32x32x16_bf16 v[80:95], v[20:23], v[220:223], v[80:95]
    ds_read_b64_tr_b16 v[20:21], v1 offset:16384
    ds_read_b64_tr_b16 v[22:23], v1 offset:17408
    s_waitcnt lgkmcnt(7)
    v_mfma_f32_32x32x16_bf16 v[96:111], v[24:27], v[220:223], v[96:111]
    ds_read_b64_tr_b16 v[24:25], v2 offset:16384
    ds_read_b64_tr_b16 v[26:27], v2 offset:17408
    s_waitcnt lgkmcnt(7)
    v_mfma_f32_32x32x16_bf16 v[112:127], v[28:31], v[220:223], v[112:127]
    ds_read_b64_tr_b16 v[28:29], v3 offset:16384
    ds_read_b64_tr_b16 v[30:31], v3 offset:17408
    s_waitcnt lgkmcnt(6)
    v_mfma_f32_32x32x16_bf16 v[64:79], v[16:19], v[224:227], v[64:79]
    ds_read_b64_tr_b16 v[16:17], v0 offset:20480
    ds_read_b64_tr_b16 v[18:19], v0 offset:21504
    s_waitcnt lgkmcnt(6)
    v_mfma_f32_32x32x16_bf16 v[80:95], v[20:23], v[224:227], v[80:95]
    ds_read_b64_tr_b16 v[20:21], v1 offset:20480
    ds_read_b64_tr_b16 v[22:23], v1 offset:21504
    s_waitcnt lgkmcnt(6)
    v_mfma_f32_32x32x16_bf16 v[96:111], v[24:27], v[224:227], v[96:111]
    ds_read_b64_tr_b16 v[24:25], v2 offset:20480
    ds_read_b64_tr_b16 v[26:27], v2 offset:21504
    s_waitcnt lgkmcnt(6)
    v_mfma_f32_32x32x16_bf16 v[112:127], v[28:31], v[224:227], v[112:127]
    ds_read_b64_tr_b16 v[28:29], v3 offset:20480
    ds_read_b64_tr_b16 v[30:31], v3 offset:21504
    s_waitcnt lgkmcnt(6)
    v_mfma_f32_32x32x16_bf16 v[64:79], v[16:19], v[228:231], v[64:79]
    ds_read_b64_tr_b16 v[16:17], v0 offset:24576
    ds_read_b64_tr_b16 v[18:19], v0 offset:25600
    s_waitcnt lgkmcnt(6)
    v_mfma_f32_32x32x16_bf16 v[80:95], v[20:23], v[228:231], v[80:95]
    ds_read_b64_tr_b16 v[20:21], v1 offset:24576
    ds_read_b64_tr_b16 v[22:23], v1 offset:25600
    s_waitcnt lgkmcnt(6)
    v_mfma_f32_32x32x16_bf16 v[96:111], v[24:27], v[228:231], v[96:111]
    ds_read_b64_tr_b16 v[24:25], v2 offset:24576
    ds_read_b64_tr_b16 v[26:27], v2 offset:25600
    s_waitcnt lgkmcnt(6)
    v_mfma_f32_32x32x16_bf16 v[112:127], v[28:31], v[228:231], v[112:127]
    ds_read_b64_tr_b16 v[28:29], v3 offset:24576
    ds_read_b64_tr_b16 v[30:31], v3 offset:25600
    ds_read_b32 v6, v10 offset:4
    s_waitcnt lgkmcnt(7)
    v_mfma_f32_32x32x16_bf16 v[64:79], v[16:19], v[232:235], v[64:79]
    ds_read_b64_tr_b16 v[16:17], v0 offset:28672
    ds_read_b64_tr_b16 v[18:19], v0 offset:29696
    s_waitcnt lgkmcnt(7)
    v_mfma_f32_32x32x16_bf16 v[80:95], v[20:23], v[232:235], v[80:95]
    ds_read_b64_tr_b16 v[20:21], v1 offset:28672
    ds_read_b64_tr_b16 v[22:23], v1 offset:29696
    s_waitcnt lgkmcnt(7)
    v_mfma_f32_32x32x16_bf16 v[96:111], v[24:27], v[232:235], v[96:111]
    ds_read_b64_tr_b16 v[24:25], v2 offset:28672
    ds_read_b64_tr_b16 v[26:27], v2 offset:29696
    s_waitcnt lgkmcnt(7)
    v_mfma_f32_32x32x16_bf16 v[112:127], v[28:31], v[232:235], v[112:127]
    ds_read_b64_tr_b16 v[28:29], v3 offset:28672
    ds_read_b64_tr_b16 v[30:31], v3 offset:29696
    v_mov_b32 v7, 19
    ds_write_b32 v5, v7 offset:48
    s_waitcnt lgkmcnt(7)
    v_mfma_f32_32x32x16_bf16 v[64:79], v[16:19], v[236:239], v[64:79]
    v_readfirstlane_b32 s54, v6
    s_nop 0
    s_cmp_ge_u32 s54, 20
    s_cbranch_scc0 LC88
LC88_ret:
    ds_read_b64_tr_b16 v[16:17], v0 offset:32768
    ds_read_b64_tr_b16 v[18:19], v0 offset:33792
    s_waitcnt lgkmcnt(7)
    v_mfma_f32_32x32x16_bf16 v[80:95], v[20:23], v[236:239], v[80:95]
    ds_read_b64_tr_b16 v[20:21], v1 offset:32768
    ds_read_b64_tr_b16 v[22:23], v1 offset:33792
    s_waitcnt lgkmcnt(7)
    v_mfma_f32_32x32x16_bf16 v[96:111], v[24:27], v[236:239], v[96:111]
    ds_read_b64_tr_b16 v[24:25], v2 offset:32768
    ds_read_b64_tr_b16 v[26:27], v2 offset:33792
    s_waitcnt lgkmcnt(7)
    v_mfma_f32_32x32x16_bf16 v[112:127], v[28:31], v[236:239], v[112:127]
    ds_read_b64_tr_b16 v[28:29], v3 offset:32768
    ds_read_b64_tr_b16 v[30:31], v3 offset:33792
    s_waitcnt lgkmcnt(6)
    v_mfma_f32_32x32x16_bf16 v[64:79], v[16:19], v[240:243], v[64:79]
    ds_read_b64_tr_b16 v[16:17], v0 offset:36864
    ds_read_b64_tr_b16 v[18:19], v0 offset:37888
    s_waitcnt lgkmcnt(6)
    v_mfma_f32_32x32x16_bf16 v[80:95], v[20:23], v[240:243], v[80:95]
    ds_read_b64_tr_b16 v[20:21], v1 offset:36864
    ds_read_b64_tr_b16 v[22:23], v1 offset:37888
    s_waitcnt lgkmcnt(6)
    v_mfma_f32_32x32x16_bf16 v[96:111], v[24:27], v[240:243], v[96:111]
    ds_read_b64_tr_b16 v[24:25], v2 offset:36864
    ds_read_b64_tr_b16 v[26:27], v2 offset:37888
    s_waitcnt lgkmcnt(6)
    v_mfma_f32_32x32x16_bf16 v[112:127], v[28:31], v[240:243], v[112:127]
    ds_read_b64_tr_b16 v[28:29], v3 offset:36864
    ds_read_b64_tr_b16 v[30:31], v3 offset:37888
    s_waitcnt lgkmcnt(6)
    v_mfma_f32_32x32x16_bf16 v[64:79], v[16:19], v[244:247], v[64:79]
    ds_read_b64_tr_b16 v[16:17], v0 offset:40960
    ds_read_b64_tr_b16 v[18:19], v0 offset:41984
    s_waitcnt lgkmcnt(6)
    v_mfma_f32_32x32x16_bf16 v[80:95], v[20:23], v[244:247], v[80:95]
    ds_read_b64_tr_b16 v[20:21], v1 offset:40960
    ds_read_b64_tr_b16 v[22:23], v1 offset:41984
    s_waitcnt lgkmcnt(6)
    v_mfma_f32_32x32x16_bf16 v[96:111], v[24:27], v[244:247], v[96:111]
    ds_read_b64_tr_b16 v[24:25], v2 offset:40960
    ds_read_b64_tr_b16 v[26:27], v2 offset:41984
    s_waitcnt lgkmcnt(6)
    v_mfma_f32_32x32x16_bf16 v[112:127], v[28:31], v[244:247], v[112:127]
    ds_read_b64_tr_b16 v[28:29], v3 offset:40960
    ds_read_b64_tr_b16 v[30:31], v3 offset:41984
    s_waitcnt lgkmcnt(6)
    v_mfma_f32_32x32x16_bf16 v[64:79], v[16:19], v[248:251], v[64:79]
    ds_read_b64_tr_b16 v[16:17], v0 offset:45056
    ds_read_b64_tr_b16 v[18:19], v0 offset:46080
    s_waitcnt lgkmcnt(6)
    v_mfma_f32_32x32x16_bf16 v[80:95], v[20:23], v[248:251], v[80:95]
    ds_read_b64_tr_b16 v[20:21], v1 offset:45056
    ds_read_b64_tr_b16 v[22:23], v1 offset:46080
    s_waitcnt lgkmcnt(6)
    v_mfma_f32_32x32x16_bf16 v[96:111], v[24:27], v[248:251], v[96:111]
    ds_read_b64_tr_b16 v[24:25], v2 offset:45056
    ds_read_b64_tr_b16 v[26:27], v2 offset:46080
    s_waitcnt lgkmcnt(6)
    v_mfma_f32_32x32x16_bf16 v[112:127], v[28:31], v[248:251], v[112:127]
    ds_read_b64_tr_b16 v[28:29], v3 offset:45056
    ds_read_b64_tr_b16 v[30:31], v3 offset:46080
    v_mov_b32 v7, 20
    ds_write_b32 v5, v7 offset:48
    s_waitcnt lgkmcnt(7)
    v_mfma_f32_32x32x16_bf16 v[64:79], v[16:19], v[252:255], v[64:79]
    s_waitcnt lgkmcnt(5)
    v_mfma_f32_32x32x16_bf16 v[80:95], v[20:23], v[252:255], v[80:95]
    s_waitcnt lgkmcnt(3)
    v_mfma_f32_32x32x16_bf16 v[96:111], v[24:27], v[252:255], v[96:111]
    s_waitcnt lgkmcnt(1)
    v_mfma_f32_32x32x16_bf16 v[112:127], v[28:31], v[252:255], v[112:127]
    s_nop 5
    v_cvt_pk_bf16_f32 v32, v64, v65
    v_cvt_pk_bf16_f32 v33, v66, v67
    v_cvt_pk_bf16_f32 v34, v68, v69
    v_cvt_pk_bf16_f32 v35, v70, v71
    v_cvt_pk_bf16_f32 v36, v72, v73
    v_cvt_pk_bf16_f32 v37, v74, v75
    v_cvt_pk_bf16_f32 v38, v76, v77
    v_cvt_pk_bf16_f32 v39, v78, v79
    v_cvt_pk_bf16_f32 v40, v80, v81
    v_cvt_pk_bf16_f32 v41, v82, v83
    v_cvt_pk_bf16_f32 v42, v84, v85
    v_cvt_pk_bf16_f32 v43, v86, v87
    v_cvt_pk_bf16_f32 v44, v88, v89
    v_cvt_pk_bf16_f32 v45, v90, v91
    v_cvt_pk_bf16_f32 v46, v92, v93
    v_cvt_pk_bf16_f32 v47, v94, v95
    v_cvt_pk_bf16_f32 v48, v96, v97
    v_cvt_pk_bf16_f32 v49, v98, v99
    v_cvt_pk_bf16_f32 v50, v100, v101
    v_cvt_pk_bf16_f32 v51, v102, v103
    v_cvt_pk_bf16_f32 v52, v104, v105
    v_cvt_pk_bf16_f32 v53, v106, v107
    v_cvt_pk_bf16_f32 v54, v108, v109
    v_cvt_pk_bf16_f32 v55, v110, v111
    v_cvt_pk_bf16_f32 v56, v112, v113
    v_cvt_pk_bf16_f32 v57, v114, v115
    v_cvt_pk_bf16_f32 v58, v116, v117
    v_cvt_pk_bf16_f32 v59, v118, v119
    v_cvt_pk_bf16_f32 v60, v120, v121
    v_cvt_pk_bf16_f32 v61, v122, v123
    v_cvt_pk_bf16_f32 v62, v124, v125
    v_cvt_pk_bf16_f32 v63, v126, v127
    s_setprio 2
    s_nop 0
LA_attn:
    s_mov_b32 s53, 0
    s_lshl_b32 s55, s9, 4
    v_mov_b32 v11, v5
    s_nop 1
LA_unit:
    ds_read_b32 v255, v10 offset:0
    s_add_u32 s55, s55, 1
    v_add_u32 v0, s10, v8
    v_xor_b32 v1, 32, v0
    v_xor_b32 v2, 64, v0
    v_xor_b32 v3, 96, v0
    v_xor_b32 v4, 128, v0
    v_xor_b32 v5, 160, v0
    v_xor_b32 v6, 192, v0
    v_xor_b32 v7, 224, v0
    s_add_u32 s10, s10, 16384
    s_cmp_eq_u32 s10, 98304
    s_cselect_b32 s10, 0, s10
    s_waitcnt lgkmcnt(0)
    v_readfirstlane_b32 s54, v255
    s_nop 0
    s_cmp_ge_u32 s54, s55
    s_cbranch_scc0 LC89
LC89_ret:
    ds_read_b128 v[16:19], v0 offset:0
    ds_read_b128 v[20:23], v1 offset:0
    ds_read_b128 v[24:27], v2 offset:0
    ds_read_b128 v[28:31], v3 offset:0
    s_waitcnt lgkmcnt(3)
    v_mfma_f32_32x32x16_bf16 v[128:143], v[16:19], v[32:35], 0
    ds_read_b128 v[16:19], v4 offset:0
    s_waitcnt lgkmcnt(3)
    v_mfma_f32_32x32x16_bf16 v[128:143], v[20:23], v[36:39], v[128:143]
    ds_read_b128 v[20:23], v5 offset:0
    s_waitcnt lgkmcnt(3)
    v_mfma_f32_32x32x16_bf16 v[128:143], v[24:27], v[40:43], v[128:143]
    ds_read_b128 v[24:27], v6 offset:0
    s_waitcnt lgkmcnt(3)
    v_mfma_f32_32x32x16_bf16 v[128:143], v[28:31], v[44:47], v[128:143]
    ds_read_b128 v[28:31], v7 offset:0
    s_waitcnt lgkmcnt(3)
    v_mfma_f32_32x32x16_bf16 v[128:143], v[16:19], v[48:51], v[128:143]
    ds_read_b128 v[16:19], v0 offset:8192
    s_waitcnt lgkmcnt(3)
    v_mfma_f32_32x32x16_bf16 v[128:143], v[20:23], v[52:55], v[128:143]
    ds_read_b128 v[20:23], v1 offset:8192
    s_waitcnt lgkmcnt(3)
    v_mfma_f32_32x32x16_bf16 v[128:143], v[24:27], v[56:59], v[128:143]
    ds_read_b128 v[24:27], v2 offset:8192
    s_waitcnt lgkmcnt(3)
    v_mfma_f32_32x32x16_bf16 v[128:143], v[28:31], v[60:63], v[128:143]
    ds_read_b128 v[28:31], v3 offset:8192
    ds_read_b32 v255, v10 offset:0
    s_waitcnt lgkmcnt(4)
    v_mfma_f32_32x32x16_bf16 v[144:159], v[16:19], v[32:35], 0
    ds_read_b128 v[16:19], v4 offset:8192
    s_waitcnt lgkmcnt(4)
    v_mfma_f32_32x32x16_bf16 v[144:159], v[20:23], v[36:39], v[144:159]
    ds_read_b128 v[20:23], v5 offset:8192
    s_waitcnt lgkmcnt(4)
    v_mfma_f32_32x32x16_bf16 v[144:159], v[24:27], v[40:43], v[144:159]
    ds_read_b128 v[24:27], v6 offset:8192
    s_waitcnt lgkmcnt(4)
    v_mfma_f32_32x32x16_bf16 v[144:159], v[28:31], v[44:47], v[144:159]
    ds_read_b128 v[28:31], v7 offset:8192
    v_mov_b32 v254, s55
    ds_write_b32 v11, v254 offset:16
    s_waitcnt lgkmcnt(4)
    v_mfma_f32_32x32x16_bf16 v[144:159], v[16:19], v[48:51], v[144:159]
    s_add_u32 s55, s55, 1
    v_add_u32 v0, s10, v8
    v_xor_b32 v1, 32, v0
    v_xor_b32 v2, 64, v0
    v_xor_b32 v3, 96, v0
    v_xor_b32 v4, 128, v0
    v_xor_b32 v5, 160, v0
    v_xor_b32 v6, 192, v0
    v_xor_b32 v7, 224, v0
    s_add_u32 s10, s10, 16384
    s_cmp_eq_u32 s10, 98304
    s_cselect_b32 s10, 0, s10
    v_readfirstlane_b32 s54, v255
    s_nop 0
    s_cmp_ge_u32 s54, s55
    s_cbranch_scc0 LC90
LC90_ret:
    ds_read_b128 v[16:19], v0 offset:0
    v_max_f32 v14, v128, v129
    v_max_f32 v15, v130, v131
    s_waitcnt lgkmcnt(4)
    v_mfma_f32_32x32x16_bf16 v[144:159], v[20:23], v[52:55], v[144:159]
    ds_read_b128 v[20:23], v1 offset:0
    v_max3_f32 v14, v14, v132, v133
    v_max3_f32 v15, v15, v134, v135
    s_waitcnt lgkmcnt(4)
    v_mfma_f32_32x32x16_bf16 v[144:159], v[24:27], v[56:59], v[144:159]
    ds_read_b128 v[24:27], v2 offset:0
    v_max3_f32 v14, v14, v136, v137
    v_max3_f32 v15, v15, v138, v139
    s_waitcnt lgkmcnt(4)
    v_mfma_f32_32x32x16_bf16 v[144:159], v[28:31], v[60:63], v[144:159]
    ds_read_b128 v[28:31], v3 offset:0
    v_max3_f32 v14, v14, v140, v141
    v_max3_f32 v15, v15, v142, v143
    s_waitcnt lgkmcnt(3)
    v_mfma_f32_32x32x16_bf16 v[160:175], v[16:19], v[32:35], 0
    ds_read_b128 v[16:19], v4 offset:0
    s_waitcnt lgkmcnt(3)
    v_mfma_f32_32x32x16_bf16 v[160:175], v[20:23], v[36:39], v[160:175]
    ds_read_b128 v[20:23], v5 offset:0
    s_waitcnt lgkmcnt(3)
    v_mfma_f32_32x32x16_bf16 v[160:175], v[24:27], v[40:43], v[160:175]
    ds_read_b128 v[24:27], v6 offset:0
    s_waitcnt lgkmcnt(3)
    v_mfma_f32_32x32x16_bf16 v[160:175], v[28:31], v[44:47], v[160:175]
    ds_read_b128 v[28:31], v7 offset:0
    s_waitcnt lgkmcnt(3)
    v_mfma_f32_32x32x16_bf16 v[160:175], v[16:19], v[48:51], v[160:175]
    ds_read_b128 v[16:19], v0 offset:8192
    v_max3_f32 v14, v14, v144, v145
    v_max3_f32 v15, v15, v146, v147
    s_waitcnt lgkmcnt(3)
    v_mfma_f32_32x32x16_bf16 v[160:175], v[20:23], v[52:55], v[160:175]
    ds_read_b128 v[20:23], v1 offset:8192
    v_max3_f32 v14, v14, v148, v149
    v_max3_f32 v15, v15, v150, v151
    s_waitcnt lgkmcnt(3)
    v_mfma_f32_32x32x16_bf16 v[160:175], v[24:27], v[56:59], v[160:175]
    ds_read_b128 v[24:27], v2 offset:8192
    v_max3_f32 v14, v14, v152, v153
    v_max3_f32 v15, v15, v154, v155
    s_waitcnt lgkmcnt(3)
    v_mfma_f32_32x32x16_bf16 v[160:175], v[28:31], v[60:63], v[160:175]
    ds_read_b128 v[28:31], v3 offset:8192
    ds_read_b32 v255, v10 offset:0
    v_max3_f32 v14, v14, v156, v157
    v_max3_f32 v15, v15, v158, v159
    s_waitcnt lgkmcnt(4)
    v_mfma_f32_32x32x16_bf16 v[176:191], v[16:19], v[32:35], 0
    ds_read_b128 v[16:19], v4 offset:8192
    s_waitcnt lgkmcnt(4)
    v_mfma_f32_32x32x16_bf16 v[176:191], v[20:23], v[36:39], v[176:191]
    ds_read_b128 v[20:23], v5 offset:8192
    s_waitcnt lgkmcnt(4)
    v_mfma_f32_32x32x16_bf16 v[176:191], v[24:27], v[40:43], v[176:191]
    ds_read_b128 v[24:27], v6 offset:8192
    s_waitcnt lgkmcnt(4)
    v_mfma_f32_32x32x16_bf16 v[176:191], v[28:31], v[44:47], v[176:191]
    ds_read_b128 v[28:31], v7 offset:8192
    v_mov_b32 v254, s55
    ds_write_b32 v11, v254 offset:16
    s_waitcnt lgkmcnt(4)
    v_mfma_f32_32x32x16_bf16 v[176:191], v[16:19], v[48:51], v[176:191]
    s_add_u32 s55, s55, 1
    v_add_u32 v0, s10, v8
    v_xor_b32 v1, 32, v0
    v_xor_b32 v2, 64, v0
    v_xor_b32 v3, 96, v0
    v_xor_b32 v4, 128, v0
    v_xor_b32 v5, 160, v0
    v_xor_b32 v6, 192, v0
    v_xor_b32 v7, 224, v0
    s_add_u32 s10, s10, 16384
    s_cmp_eq_u32 s10, 98304
    s_cselect_b32 s10, 0, s10
    v_readfirstlane_b32 s54, v255
    s_nop 0
    s_cmp_ge_u32 s54, s55
    s_cbranch_scc0 LC91
LC91_ret:
    ds_read_b128 v[16:19], v0 offset:0
    v_max3_f32 v14, v14, v160, v161
    v_max3_f32 v15, v15, v162, v163
    s_waitcnt lgkmcnt(4)
    v_mfma_f32_32x32x16_bf16 v[176:191], v[20:23], v[52:55], v[176:191]
    ds_read_b128 v[20:23], v1 offset:0
    v_max3_f32 v14, v14, v164, v165
    v_max3_f32 v15, v15, v166, v167
    s_waitcnt lgkmcnt(4)
    v_mfma_f32_32x32x16_bf16 v[176:191], v[24:27], v[56:59], v[176:191]
    ds_read_b128 v[24:27], v2 offset:0
    v_max3_f32 v14, v14, v168, v169
    v_max3_f32 v15, v15, v170, v171
    s_waitcnt lgkmcnt(4)
    v_mfma_f32_32x32x16_bf16 v[176:191], v[28:31], v[60:63], v[176:191]
    ds_read_b128 v[28:31], v3 offset:0
    v_max3_f32 v14, v14, v172, v173
    v_max3_f32 v15, v15, v174, v175
    s_waitcnt lgkmcnt(3)
    v_mfma_f32_32x32x16_bf16 v[192:207], v[16:19], v[32:35], 0
    ds_read_b128 v[16:19], v4 offset:0
    s_waitcnt lgkmcnt(3)
    v_mfma_f32_32x32x16_bf16 v[192:207], v[20:23], v[36:39], v[192:207]
    ds_read_b128 v[20:23], v5 offset:0
    s_waitcnt lgkmcnt(3)
    v_mfma_f32_32x32x16_bf16 v[192:207], v[24:27], v[40:43], v[192:207]
    ds_read_b128 v[24:27], v6 offset:0
    s_waitcnt lgkmcnt(3)
    v_mfma_f32_32x32x16_bf16 v[192:207], v[28:31], v[44:47], v[192:207]
    ds_read_b128 v[28:31], v7 offset:0
    s_waitcnt lgkmcnt(3)
    v_mfma_f32_32x32x16_bf16 v[192:207], v[16:19], v[48:51], v[192:207]
    ds_read_b128 v[16:19], v0 offset:8192
    v_max3_f32 v14, v14, v176, v177
    v_max3_f32 v15, v15, v178, v179
    s_waitcnt lgkmcnt(3)
    v_mfma_f32_32x32x16_bf16 v[192:207], v[20:23], v[52:55], v[192:207]
    ds_read_b128 v[20:23], v1 offset:8192
    v_max3_f32 v14, v14, v180, v181
    v_max3_f32 v15, v15, v182, v183
    s_waitcnt lgkmcnt(3)
    v_mfma_f32_32x32x16_bf16 v[192:207], v[24:27], v[56:59], v[192:207]
    ds_read_b128 v[24:27], v2 offset:8192
    v_max3_f32 v14, v14, v184, v185
    v_max3_f32 v15, v15, v186, v187
    s_waitcnt lgkmcnt(3)
    v_mfma_f32_32x32x16_bf16 v[192:207], v[28:31], v[60:63], v[192:207]
    ds_read_b128 v[28:31], v3 offset:8192
    ds_read_b32 v255, v10 offset:0
    v_max3_f32 v14, v14, v188, v189
    v_max3_f32 v15, v15, v190, v191
    s_waitcnt lgkmcnt(4)
    v_mfma_f32_32x32x16_bf16 v[208:223], v[16:19], v[32:35], 0
    ds_read_b128 v[16:19], v4 offset:8192
    s_waitcnt lgkmcnt(4)
    v_mfma_f32_32x32x16_bf16 v[208:223], v[20:23], v[36:39], v[208:223]
    ds_read_b128 v[20:23], v5 offset:8192
    s_waitcnt lgkmcnt(4)
    v_mfma_f32_32x32x16_bf16 v[208:223], v[24:27], v[40:43], v[208:223]
    ds_read_b128 v[24:27], v6 offset:8192
    s_waitcnt lgkmcnt(4)
    v_mfma_f32_32x32x16_bf16 v[208:223], v[28:31], v[44:47], v[208:223]
    ds_read_b128 v[28:31], v7 offset:8192
    v_mov_b32 v254, s55
    ds_write_b32 v11, v254 offset:16
    s_waitcnt lgkmcnt(4)
    v_mfma_f32_32x32x16_bf16 v[208:223], v[16:19], v[48:51], v[208:223]
    s_add_u32 s55, s55, 1
    v_add_u32 v0, s10, v8
    v_xor_b32 v1, 32, v0
    v_xor_b32 v2, 64, v0
    v_xor_b32 v3, 96, v0
    v_xor_b32 v4, 128, v0
    v_xor_b32 v5, 160, v0
    v_xor_b32 v6, 192, v0
    v_xor_b32 v7, 224, v0
    s_add_u32 s10, s10, 16384
    s_cmp_eq_u32 s10, 98304
    s_cselect_b32 s10, 0, s10
    v_readfirstlane_b32 s54, v255
    s_nop 0
    s_cmp_ge_u32 s54, s55
    s_cbranch_scc0 LC92
LC92_ret:
    ds_read_b128 v[16:19], v0 offset:0
    v_max3_f32 v14, v14, v192, v193
    v_max3_f32 v15, v15, v194, v195
    s_waitcnt lgkmcnt(4)
    v_mfma_f32_32x32x16_bf16 v[208:223], v[20:23], v[52:55], v[208:223]
    ds_read_b128 v[20:23], v1 offset:0
    v_max3_f32 v14, v14, v196, v197
    v_max3_f32 v15, v15, v198, v199
    s_waitcnt lgkmcnt(4)
    v_mfma_f32_32x32x16_bf16 v[208:223], v[24:27], v[56:59], v[208:223]
    ds_read_b128 v[24:27], v2 offset:0
    v_max3_f32 v14, v14, v200, v201
    v_max3_f32 v15, v15, v202, v203
    s_waitcnt lgkmcnt(4)
    v_mfma_f32_32x32x16_bf16 v[208:223], v[28:31], v[60:63], v[208:223]
    ds_read_b128 v[28:31], v3 offset:0
    v_max3_f32 v14, v14, v204, v205
    v_max3_f32 v15, v15, v206, v207
    s_waitcnt lgkmcnt(3)
    v_mfma_f32_32x32x16_bf16 v[224:239], v[16:19], v[32:35], 0
    ds_read_b128 v[16:19], v4 offset:0
    s_waitcnt lgkmcnt(3)
    v_mfma_f32_32x32x16_bf16 v[224:239], v[20:23], v[36:39], v[224:239]
    ds_read_b128 v[20:23], v5 offset:0
    s_waitcnt lgkmcnt(3)
    v_mfma_f32_32x32x16_bf16 v[224:239], v[24:27], v[40:43], v[224:239]
    ds_read_b128 v[24:27], v6 offset:0
    s_waitcnt lgkmcnt(3)
    v_mfma_f32_32x32x16_bf16 v[224:239], v[28:31], v[44:47], v[224:239]
    ds_read_b128 v[28:31], v7 offset:0
    s_waitcnt lgkmcnt(3)
    v_mfma_f32_32x32x16_bf16 v[224:239], v[16:19], v[48:51], v[224:239]
    ds_read_b128 v[16:19], v0 offset:8192
    v_max3_f32 v14, v14, v208, v209
    v_max3_f32 v15, v15, v210, v211
    s_waitcnt lgkmcnt(3)
    v_mfma_f32_32x32x16_bf16 v[224:239], v[20:23], v[52:55], v[224:239]
    ds_read_b128 v[20:23], v1 offset:8192
    v_max3_f32 v14, v14, v212, v213
    v_max3_f32 v15, v15, v214, v215
    s_waitcnt lgkmcnt(3)
    v_mfma_f32_32x32x16_bf16 v[224:239], v[24:27], v[56:59], v[224:239]
    ds_read_b128 v[24:27], v2 offset:8192
    v_max3_f32 v14, v14, v216, v217
    v_max3_f32 v15, v15, v218, v219
    s_waitcnt lgkmcnt(3)
    v_mfma_f32_32x32x16_bf16 v[224:239], v[28:31], v[60:63], v[224:239]
    ds_read_b128 v[28:31], v3 offset:8192
    v_max3_f32 v14, v14, v220, v221
    v_max3_f32 v15, v15, v222, v223
    s_waitcnt lgkmcnt(3)
    v_mfma_f32_32x32x16_bf16 v[240:255], v[16:19], v[32:35], 0
    ds_read_b128 v[16:19], v4 offset:8192
    s_waitcnt lgkmcnt(3)
    v_mfma_f32_32x32x16_bf16 v[240:255], v[20:23], v[36:39], v[240:255]
    ds_read_b128 v[20:23], v5 offset:8192
    s_waitcnt lgkmcnt(3)
    v_mfma_f32_32x32x16_bf16 v[240:255], v[24:27], v[40:43], v[240:255]
    ds_read_b128 v[24:27], v6 offset:8192
    s_waitcnt lgkmcnt(3)
    v_mfma_f32_32x32x16_bf16 v[240:255], v[28:31], v[44:47], v[240:255]
    ds_read_b128 v[28:31], v7 offset:8192
    v_mov_b32 v0, s55
    ds_write_b32 v11, v0 offset:16
    s_waitcnt lgkmcnt(4)
    v_mfma_f32_32x32x16_bf16 v[240:255], v[16:19], v[48:51], v[240:255]
    v_max3_f32 v14, v14, v224, v225
    v_max3_f32 v15, v15, v226, v227
    s_waitcnt lgkmcnt(3)
    v_mfma_f32_32x32x16_bf16 v[240:255], v[20:23], v[52:55], v[240:255]
    v_max3_f32 v14, v14, v228, v229
    v_max3_f32 v15, v15, v230, v231
    s_waitcnt lgkmcnt(2)
    v_mfma_f32_32x32x16_bf16 v[240:255], v[24:27], v[56:59], v[240:255]
    v_max3_f32 v14, v14, v232, v233
    v_max3_f32 v15, v15, v234, v235
    s_waitcnt lgkmcnt(1)
    v_mfma_f32_32x32x16_bf16 v[240:255], v[28:31], v[60:63], v[240:255]
    v_max3_f32 v14, v14, v236, v237
    v_max3_f32 v15, v15, v238, v239
    s_nop 9
    v_max3_f32 v14, v14, v240, v241
    v_max3_f32 v15, v15, v242, v243
    v_max3_f32 v14, v14, v244, v245
    v_max3_f32 v15, v15, v246, v247
    v_max3_f32 v14, v14, v248, v249
    v_max3_f32 v15, v15, v250, v251
    v_max3_f32 v14, v14, v252, v253
    v_max3_f32 v15, v15, v254, v255
    v_max_f32 v14, v14, v15
    v_mov_b32 v15, v14
    s_nop 1
    v_permlane32_swap_b32 v14, v15
    v_max3_f32 v14, v14, v15, v12
    v_sub_f32 v5, v12, v14
    v_mul_f32 v5, s15, v5
    v_exp_f32 v5, v5
    v_mov_b32 v12, v14
    v_mul_f32 v4, s15, v14
    v_mul_f32 v13, v13, v5
    v_mul_f32 v64, v64, v5
    v_mul_f32 v65, v65, v5
    v_mul_f32 v66, v66, v5
    v_mul_f32 v67, v67, v5
    v_mul_f32 v68, v68, v5
    v_mul_f32 v69, v69, v5
    v_mul_f32 v70, v70, v5
    v_mul_f32 v71, v71, v5
    v_mul_f32 v72, v72, v5
    v_mul_f32 v73, v73, v5
    v_mul_f32 v74, v74, v5
    v_mul_f32 v75, v75, v5
    v_mul_f32 v76, v76, v5
    v_mul_f32 v77, v77, v5
    v_mul_f32 v78, v78, v5
    v_mul_f32 v79, v79, v5
    v_mul_f32 v80, v80, v5
    v_mul_f32 v81, v81, v5
    v_mul_f32 v82, v82, v5
    v_mul_f32 v83, v83, v5
    v_mul_f32 v84, v84, v5
    v_mul_f32 v85, v85, v5
    v_mul_f32 v86, v86, v5
    v_mul_f32 v87, v87, v5
    v_mul_f32 v88, v88, v5
    v_mul_f32 v89, v89, v5
    v_mul_f32 v90, v90, v5
    v_mul_f32 v91, v91, v5
    v_mul_f32 v92, v92, v5
    v_mul_f32 v93, v93, v5
    v_mul_f32 v94, v94, v5
    v_mul_f32 v95, v95, v5
    v_mul_f32 v96, v96, v5
    v_mul_f32 v97, v97, v5
    v_mul_f32 v98, v98, v5
    v_mul_f32 v99, v99, v5
    v_mul_f32 v100, v100, v5
    v_mul_f32 v101, v101, v5
    v_mul_f32 v102, v102, v5
    v_mul_f32 v103, v103, v5
    v_mul_f32 v104, v104, v5
    v_mul_f32 v105, v105, v5
    v_mul_f32 v106, v106, v5
    v_mul_f32 v107, v107, v5
    v_mul_f32 v108, v108, v5
    v_mul_f32 v109, v109, v5
    v_mul_f32 v110, v110, v5
    v_mul_f32 v111, v111, v5
    v_mul_f32 v112, v112, v5
    v_mul_f32 v113, v113, v5
    v_mul_f32 v114, v114, v5
    v_mul_f32 v115, v115, v5
    v_mul_f32 v116, v116, v5
    v_mul_f32 v117, v117, v5
    v_mul_f32 v118, v118, v5
    v_mul_f32 v119, v119, v5
    v_mul_f32 v120, v120, v5
    v_mul_f32 v121, v121, v5
    v_mul_f32 v122, v122, v5
    v_mul_f32 v123, v123, v5
    v_mul_f32 v124, v124, v5
    v_mul_f32 v125, v125, v5
    v_mul_f32 v126, v126, v5
    v_mul_f32 v127, v127, v5
    v_fma_f32 v128, v128, s15, -v4
    v_fma_f32 v129, v129, s15, -v4
    v_exp_f32 v128, v128
    v_exp_f32 v129, v129
    v_fma_f32 v130, v130, s15, -v4
    v_fma_f32 v131, v131, s15, -v4
    v_exp_f32 v130, v130
    v_exp_f32 v131, v131
    v_add_f32 v13, v13, v128
    v_add_f32 v13, v13, v129
    v_cvt_pk_bf16_f32 v128, v128, v129
    v_fma_f32 v132, v132, s15, -v4
    v_fma_f32 v133, v133, s15, -v4
    v_exp_f32 v132, v132
    v_exp_f32 v133, v133
    v_add_f32 v13, v13, v130
    v_add_f32 v13, v13, v131
    v_cvt_pk_bf16_f32 v129, v130, v131
    v_fma_f32 v134, v134, s15, -v4
    v_fma_f32 v135, v135, s15, -v4
    v_exp_f32 v134, v134
    v_exp_f32 v135, v135
    v_add_f32 v13, v13, v132
    v_add_f32 v13, v13, v133
    v_cvt_pk_bf16_f32 v130, v132, v133
    v_add_f32 v13, v13, v134
    v_add_f32 v13, v13, v135
    v_cvt_pk_bf16_f32 v131, v134, v135
    ds_read_b32 v6, v10 offset:0
    s_add_u32 s55, s55, 1
    v_add_u32 v0, s10, v9
    v_xor_b32 v1, 64, v0
    v_xor_b32 v2, 128, v0
    v_xor_b32 v3, 192, v0
    s_add_u32 s10, s10, 16384
    s_cmp_eq_u32 s10, 98304
    s_cselect_b32 s10, 0, s10
    s_waitcnt lgkmcnt(0)
    v_readfirstlane_b32 s54, v6
    s_nop 0
    s_cmp_ge_u32 s54, s55
    s_cbranch_scc0 LC93
LC93_ret:
    ds_read_b64_tr_b16 v[16:17], v0 offset:0
    ds_read_b64_tr_b16 v[18:19], v0 offset:2048
    ds_read_b64_tr_b16 v[20:21], v1 offset:0
    ds_read_b64_tr_b16 v[22:23], v1 offset:2048
    ds_read_b64_tr_b16 v[24:25], v2 offset:0
    ds_read_b64_tr_b16 v[26:27], v2 offset:2048
    ds_read_b64_tr_b16 v[28:29], v3 offset:0
    ds_read_b64_tr_b16 v[30:31], v3 offset:2048
    s_waitcnt lgkmcnt(6)
    v_mfma_f32_32x32x16_bf16 v[64:79], v[16:19], v[128:131], v[64:79]
    ds_read_b64_tr_b16 v[16:17], v0 offset:4096
    ds_read_b64_tr_b16 v[18:19], v0 offset:6144
    v_fma_f32 v136, v136, s15, -v4
    v_fma_f32 v137, v137, s15, -v4
    v_exp_f32 v136, v136
    v_exp_f32 v137, v137
    v_fma_f32 v138, v138, s15, -v4
    v_fma_f32 v139, v139, s15, -v4
    v_exp_f32 v138, v138
    s_waitcnt lgkmcnt(6)
    v_mfma_f32_32x32x16_bf16 v[80:95], v[20:23], v[128:131], v[80:95]
    ds_read_b64_tr_b16 v[20:21], v1 offset:4096
    ds_read_b64_tr_b16 v[22:23], v1 offset:6144
    v_exp_f32 v139, v139
    v_add_f32 v13, v13, v136
    v_add_f32 v13, v13, v137
    v_cvt_pk_bf16_f32 v136, v136, v137
    v_fma_f32 v140, v140, s15, -v4
    v_fma_f32 v141, v141, s15, -v4
    v_exp_f32 v140, v140
    s_waitcnt lgkmcnt(6)
    v_mfma_f32_32x32x16_bf16 v[96:111], v[24:27], v[128:131], v[96:111]
    ds_read_b64_tr_b16 v[24:25], v2 offset:4096
    ds_read_b64_tr_b16 v[26:27], v2 offset:6144
    v_exp_f32 v141, v141
    v_add_f32 v13, v13, v138
    v_add_f32 v13, v13, v139
    v_cvt_pk_bf16_f32 v137, v138, v139
    v_fma_f32 v142, v142, s15, -v4
    v_fma_f32 v143, v143, s15, -v4
    v_exp_f32 v142, v142
    s_waitcnt lgkmcnt(6)
    v_mfma_f32_32x32x16_bf16 v[112:127], v[28:31], v[128:131], v[112:127]
    ds_read_b64_tr_b16 v[28:29], v3 offset:4096
    ds_read_b64_tr_b16 v[30:31], v3 offset:6144
    v_exp_f32 v143, v143
    v_add_f32 v13, v13, v140
    v_add_f32 v13, v13, v141
    v_cvt_pk_bf16_f32 v138, v140, v141
    v_add_f32 v13, v13, v142
    v_add_f32 v13, v13, v143
    v_cvt_pk_bf16_f32 v139, v142, v143
    s_waitcnt lgkmcnt(6)
    s_nop 0
    v_mfma_f32_32x32x16_bf16 v[64:79], v[16:19], v[136:139], v[64:79]
    ds_read_b64_tr_b16 v[16:17], v0 offset:8192
    ds_read_b64_tr_b16 v[18:19], v0 offset:10240
    v_fma_f32 v144, v144, s15, -v4
    v_fma_f32 v145, v145, s15, -v4
    v_exp_f32 v144, v144
    v_exp_f32 v145, v145
    v_fma_f32 v146, v146, s15, -v4
    v_fma_f32 v147, v147, s15, -v4
    v_exp_f32 v146, v146
    s_waitcnt lgkmcnt(6)
    v_mfma_f32_32x32x16_bf16 v[80:95], v[20:23], v[136:139], v[80:95]
    ds_read_b64_tr_b16 v[20:21], v1 offset:8192
    ds_read_b64_tr_b16 v[22:23], v1 offset:10240
    v_exp_f32 v147, v147
    v_add_f32 v13, v13, v144
    v_add_f32 v13, v13, v145
    v_cvt_pk_bf16_f32 v144, v144, v145
    v_fma_f32 v148, v148, s15, -v4
    v_fma_f32 v149, v149, s15, -v4
    v_exp_f32 v148, v148
    s_waitcnt lgkmcnt(6)
    v_mfma_f32_32x32x16_bf16 v[96:111], v[24:27], v[136:139], v[96:111]
    ds_read_b64_tr_b16 v[24:25], v2 offset:8192
    ds_read_b64_tr_b16 v[26:27], v2 offset:10240
    v_exp_f32 v149, v149
    v_add_f32 v13, v13, v146
    v_add_f32 v13, v13, v147
    v_cvt_pk_bf16_f32 v145, v146, v147
    v_fma_f32 v150, v150, s15, -v4
    v_fma_f32 v151, v151, s15, -v4
    v_exp_f32 v150, v150
    s_waitcnt lgkmcnt(6)
    v_mfma_f32_32x32x16_bf16 v[112:127], v[28:31], v[136:139], v[112:127]
    ds_read_b64_tr_b16 v[28:29], v3 offset:8192
    ds_read_b64_tr_b16 v[30:31], v3 offset:10240
    ds_read_b32 v6, v10 offset:0
    v_exp_f32 v151, v151
    v_add_f32 v13, v13, v148
    v_add_f32 v13, v13, v149
    v_cvt_pk_bf16_f32 v146, v148, v149
    v_add_f32 v13, v13, v150
    v_add_f32 v13, v13, v151
    v_cvt_pk_bf16_f32 v147, v150, v151
    s_waitcnt lgkmcnt(7)
    s_nop 0
    v_mfma_f32_32x32x16_bf16 v[64:79], v[16:19], v[144:147], v[64:79]
    ds_read_b64_tr_b16 v[16:17], v0 offset:12288
    ds_read_b64_tr_b16 v[18:19], v0 offset:14336
    v_fma_f32 v152, v152, s15, -v4
    v_fma_f32 v153, v153, s15, -v4
    v_exp_f32 v152, v152
    v_exp_f32 v153, v153
    v_fma_f32 v154, v154, s15, -v4
    v_fma_f32 v155, v155, s15, -v4
    v_exp_f32 v154, v154
    s_waitcnt lgkmcnt(7)
    v_mfma_f32_32x32x16_bf16 v[80:95], v[20:23], v[144:147], v[80:95]
    ds_read_b64_tr_b16 v[20:21], v1 offset:12288
    ds_read_b64_tr_b16 v[22:23], v1 offset:14336
    v_exp_f32 v155, v155
    v_add_f32 v13, v13, v152
    v_add_f32 v13, v13, v153
    v_cvt_pk_bf16_f32 v152, v152, v153
    v_fma_f32 v156, v156, s15, -v4
    v_fma_f32 v157, v157, s15, -v4
    v_exp_f32 v156, v156
    s_waitcnt lgkmcnt(7)
    v_mfma_f32_32x32x16_bf16 v[96:111], v[24:27], v[144:147], v[96:111]
    ds_read_b64_tr_b16 v[24:25], v2 offset:12288
    ds_read_b64_tr_b16 v[26:27], v2 offset:14336
    v_exp_f32 v157, v157
    v_add_f32 v13, v13, v154
    v_add_f32 v13, v13, v155
    v_cvt_pk_bf16_f32 v153, v154, v155
    v_fma_f32 v158, v158, s15, -v4
    v_fma_f32 v159, v159, s15, -v4
    v_exp_f32 v158, v158
    s_waitcnt lgkmcnt(7)
    v_mfma_f32_32x32x16_bf16 v[112:127], v[28:31], v[144:147], v[112:127]
    ds_read_b64_tr_b16 v[28:29], v3 offset:12288
    ds_read_b64_tr_b16 v[30:31], v3 offset:14336
    v_mov_b32 v7, s55
    ds_write_b32 v11, v7 offset:16
    v_exp_f32 v159, v159
    v_add_f32 v13, v13, v156
    v_add_f32 v13, v13, v157
    v_cvt_pk_bf16_f32 v154, v156, v157
    v_add_f32 v13, v13, v158
    v_add_f32 v13, v13, v159
    v_cvt_pk_bf16_f32 v155, v158, v159
    s_waitcnt lgkmcnt(7)
    s_nop 0
    v_mfma_f32_32x32x16_bf16 v[64:79], v[16:19], v[152:155], v[64:79]
    s_add_u32 s55, s55, 1
    v_add_u32 v0, s10, v9
    v_xor_b32 v1, 64, v0
    v_xor_b32 v2, 128, v0
    v_xor_b32 v3, 192, v0
    s_add_u32 s10, s10, 16384
    s_cmp_eq_u32 s10, 98304
    s_cselect_b32 s10, 0, s10
    v_readfirstlane_b32 s54, v6
    s_nop 0
    s_cmp_ge_u32 s54, s55
    s_cbranch_scc0 LC94
LC94_ret:
    ds_read_b64_tr_b16 v[16:17], v0 offset:0
    ds_read_b64_tr_b16 v[18:19], v0 offset:2048
    v_fma_f32 v160, v160, s15, -v4
    v_fma_f32 v161, v161, s15, -v4
    v_exp_f32 v160, v160
    v_exp_f32 v161, v161
    v_fma_f32 v162, v162, s15, -v4
    v_fma_f32 v163, v163, s15, -v4
    v_exp_f32 v162, v162
    s_waitcnt lgkmcnt(7)
    v_mfma_f32_32x32x16_bf16 v[80:95], v[20:23], v[152:155], v[80:95]
    ds_read_b64_tr_b16 v[20:21], v1 offset:0
    ds_read_b64_tr_b16 v[22:23], v1 offset:2048
    v_exp_f32 v163, v163
    v_add_f32 v13, v13, v160
    v_add_f32 v13, v13, v161
    v_cvt_pk_bf16_f32 v160, v160, v161
    v_fma_f32 v164, v164, s15, -v4
    v_fma_f32 v165, v165, s15, -v4
    v_exp_f32 v164, v164
    s_waitcnt lgkmcnt(7)
    v_mfma_f32_32x32x16_bf16 v[96:111], v[24:27], v[152:155], v[96:111]
    ds_read_b64_tr_b16 v[24:25], v2 offset:0
    ds_read_b64_tr_b16 v[26:27], v2 offset:2048
    v_exp_f32 v165, v165
    v_add_f32 v13, v13, v162
    v_add_f32 v13, v13, v163
    v_cvt_pk_bf16_f32 v161, v162, v163
    v_fma_f32 v166, v166, s15, -v4
    v_fma_f32 v167, v167, s15, -v4
    v_exp_f32 v166, v166
    s_waitcnt lgkmcnt(7)
    v_mfma_f32_32x32x16_bf16 v[112:127], v[28:31], v[152:155], v[112:127]
    ds_read_b64_tr_b16 v[28:29], v3 offset:0
    ds_read_b64_tr_b16 v[30:31], v3 offset:2048
    v_exp_f32 v167, v167
    v_add_f32 v13, v13, v164
    v_add_f32 v13, v13, v165
    v_cvt_pk_bf16_f32 v162, v164, v165
    v_add_f32 v13, v13, v166
    v_add_f32 v13, v13, v167
    v_cvt_pk_bf16_f32 v163, v166, v167
    s_waitcnt lgkmcnt(6)
    s_nop 0
    v_mfma_f32_32x32x16_bf16 v[64:79], v[16:19], v[160:163], v[64:79]
    ds_read_b64_tr_b16 v[16:17], v0 offset:4096
    ds_read_b64_tr_b16 v[18:19], v0 offset:6144
    v_fma_f32 v168, v168, s15, -v4
    v_fma_f32 v169, v169, s15, -v4
    v_exp_f32 v168, v168
    v_exp_f32 v169, v169
    v_fma_f32 v170, v170, s15, -v4
    v_fma_f32 v171, v171, s15, -v4
    v_exp_f32 v170, v170
    s_waitcnt lgkmcnt(6)
    v_mfma_f32_32x32x16_bf16 v[80:95], v[20:23], v[160:163], v[80:95]
    ds_read_b64_tr_b16 v[20:21], v1 offset:4096
    ds_read_b64_tr_b16 v[22:23], v1 offset:6144
    v_exp_f32 v171, v171
    v_add_f32 v13, v13, v168
    v_add_f32 v13, v13, v169
    v_cvt_pk_bf16_f32 v168, v168, v169
    v_fma_f32 v172, v172, s15, -v4
    v_fma_f32 v173, v173, s15, -v4
    v_exp_f32 v172, v172
    s_waitcnt lgkmcnt(6)
    v_mfma_f32_32x32x16_bf16 v[96:111], v[24:27], v[160:163], v[96:111]
    ds_read_b64_tr_b16 v[24:25], v2 offset:4096
    ds_read_b64_tr_b16 v[26:27], v2 offset:6144
    v_exp_f32 v173, v173
    v_add_f32 v13, v13, v170
    v_add_f32 v13, v13, v171
    v_cvt_pk_bf16_f32 v169, v170, v171
    v_fma_f32 v174, v174, s15, -v4
    v_fma_f32 v175, v175, s15, -v4
    v_exp_f32 v174, v174
    s_waitcnt lgkmcnt(6)
    v_mfma_f32_32x32x16_bf16 v[112:127], v[28:31], v[160:163], v[112:127]
    ds_read_b64_tr_b16 v[28:29], v3 offset:4096
    ds_read_b64_tr_b16 v[30:31], v3 offset:6144
    v_exp_f32 v175, v175
    v_add_f32 v13, v13, v172
    v_add_f32 v13, v13, v173
    v_cvt_pk_bf16_f32 v170, v172, v173
    v_add_f32 v13, v13, v174
    v_add_f32 v13, v13, v175
    v_cvt_pk_bf16_f32 v171, v174, v175
    s_waitcnt lgkmcnt(6)
    s_nop 0
    v_mfma_f32_32x32x16_bf16 v[64:79], v[16:19], v[168:171], v[64:79]
    ds_read_b64_tr_b16 v[16:17], v0 offset:8192
    ds_read_b64_tr_b16 v[18:19], v0 offset:10240
    v_fma_f32 v176, v176, s15, -v4
    v_fma_f32 v177, v177, s15, -v4
    v_exp_f32 v176, v176
    v_exp_f32 v177, v177
    v_fma_f32 v178, v178, s15, -v4
    v_fma_f32 v179, v179, s15, -v4
    v_exp_f32 v178, v178
    s_waitcnt lgkmcnt(6)
    v_mfma_f32_32x32x16_bf16 v[80:95], v[20:23], v[168:171], v[80:95]
    ds_read_b64_tr_b16 v[20:21], v1 offset:8192
    ds_read_b64_tr_b16 v[22:23], v1 offset:10240
    v_exp_f32 v179, v179
    v_add_f32 v13, v13, v176
    v_add_f32 v13, v13, v177
    v_cvt_pk_bf16_f32 v176, v176, v177
    v_fma_f32 v180, v180, s15, -v4
    v_fma_f32 v181, v181, s15, -v4
    v_exp_f32 v180, v180
    s_waitcnt lgkmcnt(6)
    v_mfma_f32_32x32x16_bf16 v[96:111], v[24:27], v[168:171], v[96:111]
    ds_read_b64_tr_b16 v[24:25], v2 offset:8192
    ds_read_b64_tr_b16 v[26:27], v2 offset:10240
    v_exp_f32 v181, v181
    v_add_f32 v13, v13, v178
    v_add_f32 v13, v13, v179
    v_cvt_pk_bf16_f32 v177, v178, v179
    v_fma_f32 v182, v182, s15, -v4
    v_fma_f32 v183, v183, s15, -v4
    v_exp_f32 v182, v182
    s_waitcnt lgkmcnt(6)
    v_mfma_f32_32x32x16_bf16 v[112:127], v[28:31], v[168:171], v[112:127]
    ds_read_b64_tr_b16 v[28:29], v3 offset:8192
    ds_read_b64_tr_b16 v[30:31], v3 offset:10240
    ds_read_b32 v6, v10 offset:0
    v_exp_f32 v183, v183
    v_add_f32 v13, v13, v180
    v_add_f32 v13, v13, v181
    v_cvt_pk_bf16_f32 v178, v180, v181
    v_add_f32 v13, v13, v182
    v_add_f32 v13, v13, v183
    v_cvt_pk_bf16_f32 v179, v182, v183
    s_waitcnt lgkmcnt(7)
    s_nop 0
    v_mfma_f32_32x32x16_bf16 v[64:79], v[16:19], v[176:179], v[64:79]
    ds_read_b64_tr_b16 v[16:17], v0 offset:12288
    ds_read_b64_tr_b16 v[18:19], v0 offset:14336
    v_fma_f32 v184, v184, s15, -v4
    v_fma_f32 v185, v185, s15, -v4
    v_exp_f32 v184, v184
    v_exp_f32 v185, v185
    v_fma_f32 v186, v186, s15, -v4
    v_fma_f32 v187, v187, s15, -v4
    v_exp_f32 v186, v186
    s_waitcnt lgkmcnt(7)
    v_mfma_f32_32x32x16_bf16 v[80:95], v[20:23], v[176:179], v[80:95]
    ds_read_b64_tr_b16 v[20:21], v1 offset:12288
    ds_read_b64_tr_b16 v[22:23], v1 offset:14336
    v_exp_f32 v187, v187
    v_add_f32 v13, v13, v184
    v_add_f32 v13, v13, v185
    v_cvt_pk_bf16_f32 v184, v184, v185
    v_fma_f32 v188, v188, s15, -v4
    v_fma_f32 v189, v189, s15, -v4
    v_exp_f32 v188, v188
    s_waitcnt lgkmcnt(7)
    v_mfma_f32_32x32x16_bf16 v[96:111], v[24:27], v[176:179], v[96:111]
    ds_read_b64_tr_b16 v[24:25], v2 offset:12288
    ds_read_b64_tr_b16 v[26:27], v2 offset:14336
    v_exp_f32 v189, v189
    v_add_f32 v13, v13, v186
    v_add_f32 v13, v13, v187
    v_cvt_pk_bf16_f32 v185, v186, v187
    v_fma_f32 v190, v190, s15, -v4
    v_fma_f32 v191, v191, s15, -v4
    v_exp_f32 v190, v190
    s_waitcnt lgkmcnt(7)
    v_mfma_f32_32x32x16_bf16 v[112:127], v[28:31], v[176:179], v[112:127]
    ds_read_b64_tr_b16 v[28:29], v3 offset:12288
    ds_read_b64_tr_b16 v[30:31], v3 offset:14336
    v_mov_b32 v7, s55
    ds_write_b32 v11, v7 offset:16
    v_exp_f32 v191, v191
    v_add_f32 v13, v13, v188
    v_add_f32 v13, v13, v189
    v_cvt_pk_bf16_f32 v186, v188, v189
    v_add_f32 v13, v13, v190
    v_add_f32 v13, v13, v191
    v_cvt_pk_bf16_f32 v187, v190, v191
    s_waitcnt lgkmcnt(7)
    s_nop 0
    v_mfma_f32_32x32x16_bf16 v[64:79], v[16:19], v[184:187], v[64:79]
    s_add_u32 s55, s55, 1
    v_add_u32 v0, s10, v9
    v_xor_b32 v1, 64, v0
    v_xor_b32 v2, 128, v0
    v_xor_b32 v3, 192, v0
    s_add_u32 s10, s10, 16384
    s_cmp_eq_u32 s10, 98304
    s_cselect_b32 s10, 0, s10
    v_readfirstlane_b32 s54, v6
    s_nop 0
    s_cmp_ge_u32 s54, s55
    s_cbranch_scc0 LC95
LC95_ret:
    ds_read_b64_tr_b16 v[16:17], v0 offset:0
    ds_read_b64_tr_b16 v[18:19], v0 offset:2048
    v_fma_f32 v192, v192, s15, -v4
    v_fma_f32 v193, v193, s15, -v4
    v_exp_f32 v192, v192
    v_exp_f32 v193, v193
    v_fma_f32 v194, v194, s15, -v4
    v_fma_f32 v195, v195, s15, -v4
    v_exp_f32 v194, v194
    s_waitcnt lgkmcnt(7)
    v_mfma_f32_32x32x16_bf16 v[80:95], v[20:23], v[184:187], v[80:95]
    ds_read_b64_tr_b16 v[20:21], v1 offset:0
    ds_read_b64_tr_b16 v[22:23], v1 offset:2048
    v_exp_f32 v195, v195
    v_add_f32 v13, v13, v192
    v_add_f32 v13, v13, v193
    v_cvt_pk_bf16_f32 v192, v192, v193
    v_fma_f32 v196, v196, s15, -v4
    v_fma_f32 v197, v197, s15, -v4
    v_exp_f32 v196, v196
    s_waitcnt lgkmcnt(7)
    v_mfma_f32_32x32x16_bf16 v[96:111], v[24:27], v[184:187], v[96:111]
    ds_read_b64_tr_b16 v[24:25], v2 offset:0
    ds_read_b64_tr_b16 v[26:27], v2 offset:2048
    v_exp_f32 v197, v197
    v_add_f32 v13, v13, v194
    v_add_f32 v13, v13, v195
    v_cvt_pk_bf16_f32 v193, v194, v195
    v_fma_f32 v198, v198, s15, -v4
    v_fma_f32 v199, v199, s15, -v4
    v_exp_f32 v198, v198
    s_waitcnt lgkmcnt(7)
    v_mfma_f32_32x32x16_bf16 v[112:127], v[28:31], v[184:187], v[112:127]
    ds_read_b64_tr_b16 v[28:29], v3 offset:0
    ds_read_b64_tr_b16 v[30:31], v3 offset:2048
    v_exp_f32 v199, v199
    v_add_f32 v13, v13, v196
    v_add_f32 v13, v13, v197
    v_cvt_pk_bf16_f32 v194, v196, v197
    v_add_f32 v13, v13, v198
    v_add_f32 v13, v13, v199
    v_cvt_pk_bf16_f32 v195, v198, v199
    s_waitcnt lgkmcnt(6)
    s_nop 0
    v_mfma_f32_32x32x16_bf16 v[64:79], v[16:19], v[192:195], v[64:79]
    ds_read_b64_tr_b16 v[16:17], v0 offset:4096
    ds_read_b64_tr_b16 v[18:19], v0 offset:6144
    v_fma_f32 v200, v200, s15, -v4
    v_fma_f32 v201, v201, s15, -v4
    v_exp_f32 v200, v200
    v_exp_f32 v201, v201
    v_fma_f32 v202, v202, s15, -v4
    v_fma_f32 v203, v203, s15, -v4
    v_exp_f32 v202, v202
    s_waitcnt lgkmcnt(6)
    v_mfma_f32_32x32x16_bf16 v[80:95], v[20:23], v[192:195], v[80:95]
    ds_read_b64_tr_b16 v[20:21], v1 offset:4096
    ds_read_b64_tr_b16 v[22:23], v1 offset:6144
    v_exp_f32 v203, v203
    v_add_f32 v13, v13, v200
    v_add_f32 v13, v13, v201
    v_cvt_pk_bf16_f32 v200, v200, v201
    v_fma_f32 v204, v204, s15, -v4
    v_fma_f32 v205, v205, s15, -v4
    v_exp_f32 v204, v204
    s_waitcnt lgkmcnt(6)
    v_mfma_f32_32x32x16_bf16 v[96:111], v[24:27], v[192:195], v[96:111]
    ds_read_b64_tr_b16 v[24:25], v2 offset:4096
    ds_read_b64_tr_b16 v[26:27], v2 offset:6144
    v_exp_f32 v205, v205
    v_add_f32 v13, v13, v202
    v_add_f32 v13, v13, v203
    v_cvt_pk_bf16_f32 v201, v202, v203
    v_fma_f32 v206, v206, s15, -v4
    v_fma_f32 v207, v207, s15, -v4
    v_exp_f32 v206, v206
    s_waitcnt lgkmcnt(6)
    v_mfma_f32_32x32x16_bf16 v[112:127], v[28:31], v[192:195], v[112:127]
    ds_read_b64_tr_b16 v[28:29], v3 offset:4096
    ds_read_b64_tr_b16 v[30:31], v3 offset:6144
    v_exp_f32 v207, v207
    v_add_f32 v13, v13, v204
    v_add_f32 v13, v13, v205
    v_cvt_pk_bf16_f32 v202, v204, v205
    v_add_f32 v13, v13, v206
    v_add_f32 v13, v13, v207
    v_cvt_pk_bf16_f32 v203, v206, v207
    s_waitcnt lgkmcnt(6)
    s_nop 0
    v_mfma_f32_32x32x16_bf16 v[64:79], v[16:19], v[200:203], v[64:79]
    ds_read_b64_tr_b16 v[16:17], v0 offset:8192
    ds_read_b64_tr_b16 v[18:19], v0 offset:10240
    v_fma_f32 v208, v208, s15, -v4
    v_fma_f32 v209, v209, s15, -v4
    v_exp_f32 v208, v208
    v_exp_f32 v209, v209
    v_fma_f32 v210, v210, s15, -v4
    v_fma_f32 v211, v211, s15, -v4
    v_exp_f32 v210, v210
    s_waitcnt lgkmcnt(6)
    v_mfma_f32_32x32x16_bf16 v[80:95], v[20:23], v[200:203], v[80:95]
    ds_read_b64_tr_b16 v[20:21], v1 offset:8192
    ds_read_b64_tr_b16 v[22:23], v1 offset:10240
    v_exp_f32 v211, v211
    v_add_f32 v13, v13, v208
    v_add_f32 v13, v13, v209
    v_cvt_pk_bf16_f32 v208, v208, v209
    v_fma_f32 v212, v212, s15, -v4
    v_fma_f32 v213, v213, s15, -v4
    v_exp_f32 v212, v212
    s_waitcnt lgkmcnt(6)
    v_mfma_f32_32x32x16_bf16 v[96:111], v[24:27], v[200:203], v[96:111]
    ds_read_b64_tr_b16 v[24:25], v2 offset:8192
    ds_read_b64_tr_b16 v[26:27], v2 offset:10240
    v_exp_f32 v213, v213
    v_add_f32 v13, v13, v210
    v_add_f32 v13, v13, v211
    v_cvt_pk_bf16_f32 v209, v210, v211
    v_fma_f32 v214, v214, s15, -v4
    v_fma_f32 v215, v215, s15, -v4
    v_exp_f32 v214, v214
    s_waitcnt lgkmcnt(6)
    v_mfma_f32_32x32x16_bf16 v[112:127], v[28:31], v[200:203], v[112:127]
    ds_read_b64_tr_b16 v[28:29], v3 offset:8192
    ds_read_b64_tr_b16 v[30:31], v3 offset:10240
    ds_read_b32 v6, v10 offset:0
    v_exp_f32 v215, v215
    v_add_f32 v13, v13, v212
    v_add_f32 v13, v13, v213
    v_cvt_pk_bf16_f32 v210, v212, v213
    v_add_f32 v13, v13, v214
    v_add_f32 v13, v13, v215
    v_cvt_pk_bf16_f32 v211, v214, v215
    s_waitcnt lgkmcnt(7)
    s_nop 0
    v_mfma_f32_32x32x16_bf16 v[64:79], v[16:19], v[208:211], v[64:79]
    ds_read_b64_tr_b16 v[16:17], v0 offset:12288
    ds_read_b64_tr_b16 v[18:19], v0 offset:14336
    v_fma_f32 v216, v216, s15, -v4
    v_fma_f32 v217, v217, s15, -v4
    v_exp_f32 v216, v216
    v_exp_f32 v217, v217
    v_fma_f32 v218, v218, s15, -v4
    v_fma_f32 v219, v219, s15, -v4
    v_exp_f32 v218, v218
    s_waitcnt lgkmcnt(7)
    v_mfma_f32_32x32x16_bf16 v[80:95], v[20:23], v[208:211], v[80:95]
    ds_read_b64_tr_b16 v[20:21], v1 offset:12288
    ds_read_b64_tr_b16 v[22:23], v1 offset:14336
    v_exp_f32 v219, v219
    v_add_f32 v13, v13, v216
    v_add_f32 v13, v13, v217
    v_cvt_pk_bf16_f32 v216, v216, v217
    v_fma_f32 v220, v220, s15, -v4
    v_fma_f32 v221, v221, s15, -v4
    v_exp_f32 v220, v220
    s_waitcnt lgkmcnt(7)
    v_mfma_f32_32x32x16_bf16 v[96:111], v[24:27], v[208:211], v[96:111]
    ds_read_b64_tr_b16 v[24:25], v2 offset:12288
    ds_read_b64_tr_b16 v[26:27], v2 offset:14336
    v_exp_f32 v221, v221
    v_add_f32 v13, v13, v218
    v_add_f32 v13, v13, v219
    v_cvt_pk_bf16_f32 v217, v218, v219
    v_fma_f32 v222, v222, s15, -v4
    v_fma_f32 v223, v223, s15, -v4
    v_exp_f32 v222, v222
    s_waitcnt lgkmcnt(7)
    v_mfma_f32_32x32x16_bf16 v[112:127], v[28:31], v[208:211], v[112:127]
    ds_read_b64_tr_b16 v[28:29], v3 offset:12288
    ds_read_b64_tr_b16 v[30:31], v3 offset:14336
    v_mov_b32 v7, s55
    ds_write_b32 v11, v7 offset:16
    v_exp_f32 v223, v223
    v_add_f32 v13, v13, v220
    v_add_f32 v13, v13, v221
    v_cvt_pk_bf16_f32 v218, v220, v221
    v_add_f32 v13, v13, v222
    v_add_f32 v13, v13, v223
    v_cvt_pk_bf16_f32 v219, v222, v223
    s_waitcnt lgkmcnt(7)
    s_nop 0
    v_mfma_f32_32x32x16_bf16 v[64:79], v[16:19], v[216:219], v[64:79]
    s_add_u32 s55, s55, 1
    v_add_u32 v0, s10, v9
    v_xor_b32 v1, 64, v0
    v_xor_b32 v2, 128, v0
    v_xor_b32 v3, 192, v0
    s_add_u32 s10, s10, 16384
    s_cmp_eq_u32 s10, 98304
    s_cselect_b32 s10, 0, s10
    v_readfirstlane_b32 s54, v6
    s_nop 0
    s_cmp_ge_u32 s54, s55
    s_cbranch_scc0 LC96
LC96_ret:
    ds_read_b64_tr_b16 v[16:17], v0 offset:0
    ds_read_b64_tr_b16 v[18:19], v0 offset:2048
    v_fma_f32 v224, v224, s15, -v4
    v_fma_f32 v225, v225, s15, -v4
    v_exp_f32 v224, v224
    v_exp_f32 v225, v225
    v_fma_f32 v226, v226, s15, -v4
    v_fma_f32 v227, v227, s15, -v4
    v_exp_f32 v226, v226
    s_waitcnt lgkmcnt(7)
    v_mfma_f32_32x32x16_bf16 v[80:95], v[20:23], v[216:219], v[80:95]
    ds_read_b64_tr_b16 v[20:21], v1 offset:0
    ds_read_b64_tr_b16 v[22:23], v1 offset:2048
    v_exp_f32 v227, v227
    v_add_f32 v13, v13, v224
    v_add_f32 v13, v13, v225
    v_cvt_pk_bf16_f32 v224, v224, v225
    v_fma_f32 v228, v228, s15, -v4
    v_fma_f32 v229, v229, s15, -v4
    v_exp_f32 v228, v228
    s_waitcnt lgkmcnt(7)
    v_mfma_f32_32x32x16_bf16 v[96:111], v[24:27], v[216:219], v[96:111]
    ds_read_b64_tr_b16 v[24:25], v2 offset:0
    ds_read_b64_tr_b16 v[26:27], v2 offset:2048
    v_exp_f32 v229, v229
    v_add_f32 v13, v13, v226
    v_add_f32 v13, v13, v227
    v_cvt_pk_bf16_f32 v225, v226, v227
    v_fma_f32 v230, v230, s15, -v4
    v_fma_f32 v231, v231, s15, -v4
    v_exp_f32 v230, v230
    s_waitcnt lgkmcnt(7)
    v_mfma_f32_32x32x16_bf16 v[112:127], v[28:31], v[216:219], v[112:127]
    ds_read_b64_tr_b16 v[28:29], v3 offset:0
    ds_read_b64_tr_b16 v[30:31], v3 offset:2048
    v_exp_f32 v231, v231
    v_add_f32 v13, v13, v228
    v_add_f32 v13, v13, v229
    v_cvt_pk_bf16_f32 v226, v228, v229
    v_add_f32 v13, v13, v230
    v_add_f32 v13, v13, v231
    v_cvt_pk_bf16_f32 v227, v230, v231
    s_waitcnt lgkmcnt(6)
    s_nop 0
    v_mfma_f32_32x32x16_bf16 v[64:79], v[16:19], v[224:227], v[64:79]
    ds_read_b64_tr_b16 v[16:17], v0 offset:4096
    ds_read_b64_tr_b16 v[18:19], v0 offset:6144
    v_fma_f32 v232, v232, s15, -v4
    v_fma_f32 v233, v233, s15, -v4
    v_exp_f32 v232, v232
    v_exp_f32 v233, v233
    v_fma_f32 v234, v234, s15, -v4
    v_fma_f32 v235, v235, s15, -v4
    v_exp_f32 v234, v234
    s_waitcnt lgkmcnt(6)
    v_mfma_f32_32x32x16_bf16 v[80:95], v[20:23], v[224:227], v[80:95]
    ds_read_b64_tr_b16 v[20:21], v1 offset:4096
    ds_read_b64_tr_b16 v[22:23], v1 offset:6144
    v_exp_f32 v235, v235
    v_add_f32 v13, v13, v232
    v_add_f32 v13, v13, v233
    v_cvt_pk_bf16_f32 v232, v232, v233
    v_fma_f32 v236, v236, s15, -v4
    v_fma_f32 v237, v237, s15, -v4
    v_exp_f32 v236, v236
    s_waitcnt lgkmcnt(6)
    v_mfma_f32_32x32x16_bf16 v[96:111], v[24:27], v[224:227], v[96:111]
    ds_read_b64_tr_b16 v[24:25], v2 offset:4096
    ds_read_b64_tr_b16 v[26:27], v2 offset:6144
    v_exp_f32 v237, v237
    v_add_f32 v13, v13, v234
    v_add_f32 v13, v13, v235
    v_cvt_pk_bf16_f32 v233, v234, v235
    v_fma_f32 v238, v238, s15, -v4
    v_fma_f32 v239, v239, s15, -v4
    v_exp_f32 v238, v238
    s_waitcnt lgkmcnt(6)
    v_mfma_f32_32x32x16_bf16 v[112:127], v[28:31], v[224:227], v[112:127]
    ds_read_b64_tr_b16 v[28:29], v3 offset:4096
    ds_read_b64_tr_b16 v[30:31], v3 offset:6144
    v_exp_f32 v239, v239
    v_add_f32 v13, v13, v236
    v_add_f32 v13, v13, v237
    v_cvt_pk_bf16_f32 v234, v236, v237
    v_add_f32 v13, v13, v238
    v_add_f32 v13, v13, v239
    v_cvt_pk_bf16_f32 v235, v238, v239
    s_waitcnt lgkmcnt(6)
    s_nop 0
    v_mfma_f32_32x32x16_bf16 v[64:79], v[16:19], v[232:235], v[64:79]
    ds_read_b64_tr_b16 v[16:17], v0 offset:8192
    ds_read_b64_tr_b16 v[18:19], v0 offset:10240
    v_fma_f32 v240, v240, s15, -v4
    v_fma_f32 v241, v241, s15, -v4
    v_exp_f32 v240, v240
    v_exp_f32 v241, v241
    v_fma_f32 v242, v242, s15, -v4
    v_fma_f32 v243, v243, s15, -v4
    v_exp_f32 v242, v242
    s_waitcnt lgkmcnt(6)
    v_mfma_f32_32x32x16_bf16 v[80:95], v[20:23], v[232:235], v[80:95]
    ds_read_b64_tr_b16 v[20:21], v1 offset:8192
    ds_read_b64_tr_b16 v[22:23], v1 offset:10240
    v_exp_f32 v243, v243
    v_add_f32 v13, v13, v240
    v_add_f32 v13, v13, v241
    v_cvt_pk_bf16_f32 v240, v240, v241
    v_fma_f32 v244, v244, s15, -v4
    v_fma_f32 v245, v245, s15, -v4
    v_exp_f32 v244, v244
    s_waitcnt lgkmcnt(6)
    v_mfma_f32_32x32x16_bf16 v[96:111], v[24:27], v[232:235], v[96:111]
    ds_read_b64_tr_b16 v[24:25], v2 offset:8192
    ds_read_b64_tr_b16 v[26:27], v2 offset:10240
    v_exp_f32 v245, v245
    v_add_f32 v13, v13, v242
    v_add_f32 v13, v13, v243
    v_cvt_pk_bf16_f32 v241, v242, v243
    v_fma_f32 v246, v246, s15, -v4
    v_fma_f32 v247, v247, s15, -v4
    v_exp_f32 v246, v246
    s_waitcnt lgkmcnt(6)
    v_mfma_f32_32x32x16_bf16 v[112:127], v[28:31], v[232:235], v[112:127]
    ds_read_b64_tr_b16 v[28:29], v3 offset:8192
    ds_read_b64_tr_b16 v[30:31], v3 offset:10240
    v_exp_f32 v247, v247
    v_add_f32 v13, v13, v244
    v_add_f32 v13, v13, v245
    v_cvt_pk_bf16_f32 v242, v244, v245
    v_add_f32 v13, v13, v246
    v_add_f32 v13, v13, v247
    v_cvt_pk_bf16_f32 v243, v246, v247
    s_waitcnt lgkmcnt(6)
    s_nop 0
    v_mfma_f32_32x32x16_bf16 v[64:79], v[16:19], v[240:243], v[64:79]
    ds_read_b64_tr_b16 v[16:17], v0 offset:12288
    ds_read_b64_tr_b16 v[18:19], v0 offset:14336
    v_fma_f32 v248, v248, s15, -v4
    v_fma_f32 v249, v249, s15, -v4
    v_exp_f32 v248, v248
    v_exp_f32 v249, v249
    v_fma_f32 v250, v250, s15, -v4
    v_fma_f32 v251, v251, s15, -v4
    v_exp_f32 v250, v250
    s_waitcnt lgkmcnt(6)
    v_mfma_f32_32x32x16_bf16 v[80:95], v[20:23], v[240:243], v[80:95]
    ds_read_b64_tr_b16 v[20:21], v1 offset:12288
    ds_read_b64_tr_b16 v[22:23], v1 offset:14336
    v_exp_f32 v251, v251
    v_add_f32 v13, v13, v248
    v_add_f32 v13, v13, v249
    v_cvt_pk_bf16_f32 v248, v248, v249
    v_fma_f32 v252, v252, s15, -v4
    v_fma_f32 v253, v253, s15, -v4
    v_exp_f32 v252, v252
    s_waitcnt lgkmcnt(6)
    v_mfma_f32_32x32x16_bf16 v[96:111], v[24:27], v[240:243], v[96:111]
    ds_read_b64_tr_b16 v[24:25], v2 offset:12288
    ds_read_b64_tr_b16 v[26:27], v2 offset:14336
    v_exp_f32 v253, v253
    v_add_f32 v13, v13, v250
    v_add_f32 v13, v13, v251
    v_cvt_pk_bf16_f32 v249, v250, v251
    v_fma_f32 v254, v254, s15, -v4
    v_fma_f32 v255, v255, s15, -v4
    v_exp_f32 v254, v254
    s_waitcnt lgkmcnt(6)
    v_mfma_f32_32x32x16_bf16 v[112:127], v[28:31], v[240:243], v[112:127]
    ds_read_b64_tr_b16 v[28:29], v3 offset:12288
    ds_read_b64_tr_b16 v[30:31], v3 offset:14336
    v_mov_b32 v7, s55
    ds_write_b32 v11, v7 offset:16
    v_exp_f32 v255, v255
    v_add_f32 v13, v13, v252
    v_add_f32 v13, v13, v253
    v_cvt_pk_bf16_f32 v250, v252, v253
    v_add_f32 v13, v13, v254
    v_add_f32 v13, v13, v255
    v_cvt_pk_bf16_f32 v251, v254, v255
    s_waitcnt lgkmcnt(7)
    s_nop 0
    v_mfma_f32_32x32x16_bf16 v[64:79], v[16:19], v[248:251], v[64:79]
    s_waitcnt lgkmcnt(5)
    v_mfma_f32_32x32x16_bf16 v[80:95], v[20:23], v[248:251], v[80:95]
    s_waitcnt lgkmcnt(3)
    v_mfma_f32_32x32x16_bf16 v[96:111], v[24:27], v[248:251], v[96:111]
    s_waitcnt lgkmcnt(1)
    v_mfma_f32_32x32x16_bf16 v[112:127], v[28:31], v[248:251], v[112:127]
    s_add_u32 s53, s53, 1
    s_cmp_lt_u32 s53, 2
    s_nop 9
    s_cbranch_scc1 LA_unit
    v_mov_b32 v15, v13
    s_nop 1
    v_permlane32_swap_b32 v13, v15
    v_add_f32 v13, v13, v15
    v_rcp_f32 v13, v13
    v_mbcnt_lo_u32_b32 v0, -1, 0
    v_mbcnt_hi_u32_b32 v0, -1, v0
    v_lshlrev_b32 v2, 4, v0
    s_add_u32 s12, s14, 4096
    v_mul_f32 v64, v64, v13
    v_mul_f32 v65, v65, v13
    v_mul_f32 v66, v66, v13
    v_mul_f32 v67, v67, v13
    v_mul_f32 v68, v68, v13
    v_mul_f32 v69, v69, v13
    v_mul_f32 v70, v70, v13
    v_mul_f32 v71, v71, v13
    v_cvt_pk_bf16_f32 v64, v64, v65
    v_cvt_pk_bf16_f32 v65, v66, v67
    v_cvt_pk_bf16_f32 v66, v68, v69
    v_cvt_pk_bf16_f32 v67, v70, v71
    buffer_store_dwordx4 v[64:67], v2, s[48:51], s14 offen offset:0 sc1
    v_mul_f32 v72, v72, v13
    v_mul_f32 v73, v73, v13
    v_mul_f32 v74, v74, v13
    v_mul_f32 v75, v75, v13
    v_mul_f32 v76, v76, v13
    v_mul_f32 v77, v77, v13
    v_mul_f32 v78, v78, v13
    v_mul_f32 v79, v79, v13
    v_cvt_pk_bf16_f32 v72, v72, v73
    v_cvt_pk_bf16_f32 v73, v74, v75
    v_cvt_pk_bf16_f32 v74, v76, v77
    v_cvt_pk_bf16_f32 v75, v78, v79
    buffer_store_dwordx4 v[72:75], v2, s[48:51], s14 offen offset:1024 sc1
    v_mul_f32 v80, v80, v13
    v_mul_f32 v81, v81, v13
    v_mul_f32 v82, v82, v13
    v_mul_f32 v83, v83, v13
    v_mul_f32 v84, v84, v13
    v_mul_f32 v85, v85, v13
    v_mul_f32 v86, v86, v13
    v_mul_f32 v87, v87, v13
    v_cvt_pk_bf16_f32 v80, v80, v81
    v_cvt_pk_bf16_f32 v81, v82, v83
    v_cvt_pk_bf16_f32 v82, v84, v85
    v_cvt_pk_bf16_f32 v83, v86, v87
    buffer_store_dwordx4 v[80:83], v2, s[48:51], s14 offen offset:2048 sc1
    v_mul_f32 v88, v88, v13
    v_mul_f32 v89, v89, v13
    v_mul_f32 v90, v90, v13
    v_mul_f32 v91, v91, v13
    v_mul_f32 v92, v92, v13
    v_mul_f32 v93, v93, v13
    v_mul_f32 v94, v94, v13
    v_mul_f32 v95, v95, v13
    v_cvt_pk_bf16_f32 v88, v88, v89
    v_cvt_pk_bf16_f32 v89, v90, v91
    v_cvt_pk_bf16_f32 v90, v92, v93
    v_cvt_pk_bf16_f32 v91, v94, v95
    buffer_store_dwordx4 v[88:91], v2, s[48:51], s14 offen offset:3072 sc1
    v_mul_f32 v96, v96, v13
    v_mul_f32 v97, v97, v13
    v_mul_f32 v98, v98, v13
    v_mul_f32 v99, v99, v13
    v_mul_f32 v100, v100, v13
    v_mul_f32 v101, v101, v13
    v_mul_f32 v102, v102, v13
    v_mul_f32 v103, v103, v13
    v_cvt_pk_bf16_f32 v96, v96, v97
    v_cvt_pk_bf16_f32 v97, v98, v99
    v_cvt_pk_bf16_f32 v98, v100, v101
    v_cvt_pk_bf16_f32 v99, v102, v103
    buffer_store_dwordx4 v[96:99], v2, s[48:51], s12 offen offset:0 sc1
    v_mul_f32 v104, v104, v13
    v_mul_f32 v105, v105, v13
    v_mul_f32 v106, v106, v13
    v_mul_f32 v107, v107, v13
    v_mul_f32 v108, v108, v13
    v_mul_f32 v109, v109, v13
    v_mul_f32 v110, v110, v13
    v_mul_f32 v111, v111, v13
    v_cvt_pk_bf16_f32 v104, v104, v105
    v_cvt_pk_bf16_f32 v105, v106, v107
    v_cvt_pk_bf16_f32 v106, v108, v109
    v_cvt_pk_bf16_f32 v107, v110, v111
    buffer_store_dwordx4 v[104:107], v2, s[48:51], s12 offen offset:1024 sc1
    v_mul_f32 v112, v112, v13
    v_mul_f32 v113, v113, v13
    v_mul_f32 v114, v114, v13
    v_mul_f32 v115, v115, v13
    v_mul_f32 v116, v116, v13
    v_mul_f32 v117, v117, v13
    v_mul_f32 v118, v118, v13
    v_mul_f32 v119, v119, v13
    v_cvt_pk_bf16_f32 v112, v112, v113
    v_cvt_pk_bf16_f32 v113, v114, v115
    v_cvt_pk_bf16_f32 v114, v116, v117
    v_cvt_pk_bf16_f32 v115, v118, v119
    buffer_store_dwordx4 v[112:115], v2, s[48:51], s12 offen offset:2048 sc1
    v_mul_f32 v120, v120, v13
    v_mul_f32 v121, v121, v13
    v_mul_f32 v122, v122, v13
    v_mul_f32 v123, v123, v13
    v_mul_f32 v124, v124, v13
    v_mul_f32 v125, v125, v13
    v_mul_f32 v126, v126, v13
    v_mul_f32 v127, v127, v13
    v_cvt_pk_bf16_f32 v120, v120, v121
    v_cvt_pk_bf16_f32 v121, v122, v123
    v_cvt_pk_bf16_f32 v122, v124, v125
    v_cvt_pk_bf16_f32 v123, v126, v127
    buffer_store_dwordx4 v[120:123], v2, s[48:51], s12 offen offset:3072 sc1
    s_nop 1
LP97:
    ds_read_b32 v3, v10 offset:92
    s_waitcnt lgkmcnt(0)
    v_readfirstlane_b32 s12, v3
    s_nop 0
    s_cmp_ge_u32 s12, 1
    s_nop 2
    s_cbranch_scc1 LP97_ok
    s_sleep 1
    s_branch LP97
LP97_ok:
    s_lshl_b32 s12, s8, 2
    v_add_u32 v4, s12, v10
    s_mul_i32 s40, s6, 3
    s_add_u32 s40, s40, s8
    s_lshl_b32 s40, s40, 7
    s_add_u32 s40, s40, 41943040
    s_add_u32 s13, s7, s9
    s_lshl_b32 s13, s13, 2
    s_add_u32 s13, s13, s40
    s_lshl_b32 s12, s8, 13
    s_add_u32 s12, s12, 49152
    v_add_u32 v5, s12, v2
    s_cmp_eq_u32 s9, 0
    s_waitcnt lgkmcnt(0)
    s_cbranch_scc1 LA_opA
LP98:
    ds_read_b96 v[6:8], v10 offset:32
    s_waitcnt lgkmcnt(0)
    v_min3_u32 v6, v6, v7, v8
    s_nop 0
    v_readfirstlane_b32 s12, v6
    s_nop 0
    s_cmp_ge_u32 s12, 28
    s_nop 2
    s_cbranch_scc1 LP98_ok
    s_sleep 1
    s_branch LP98
LP98_ok:
    ds_write_b128 v5, v[64:67] offset:0
    ds_write_b128 v5, v[72:75] offset:1024
    ds_write_b128 v5, v[80:83] offset:2048
    ds_write_b128 v5, v[88:91] offset:3072
    ds_write_b128 v5, v[96:99] offset:4096
    ds_write_b128 v5, v[104:107] offset:5120
    ds_write_b128 v5, v[112:115] offset:6144
    ds_write_b128 v5, v[120:123] offset:7168
    v_mov_b32 v6, 9
    ds_write_b32 v4, v6 offset:80
    s_waitcnt vmcnt(0)
    s_mov_b64 exec, 1
    buffer_store_dword v3, off, s[48:51], s13 sc1
    s_mov_b64 exec, -1
    s_endpgm
LA_opA:
    v_mov_b32 v32, v64
    v_mov_b32 v33, v65
    v_mov_b32 v34, v66
    v_mov_b32 v35, v67
    v_mov_b32 v36, v72
    v_mov_b32 v37, v73
    v_mov_b32 v38, v74
    v_mov_b32 v39, v75
    v_mov_b32 v40, v80
    v_mov_b32 v41, v81
    v_mov_b32 v42, v82
    v_mov_b32 v43, v83
    v_mov_b32 v44, v88
    v_mov_b32 v45, v89
    v_mov_b32 v46, v90
    v_mov_b32 v47, v91
    v_mov_b32 v48, v96
    v_mov_b32 v49, v97
    v_mov_b32 v50, v98
    v_mov_b32 v51, v99
    v_mov_b32 v52, v104
    v_mov_b32 v53, v105
    v_mov_b32 v54, v106
    v_mov_b32 v55, v107
    v_mov_b32 v56, v112
    v_mov_b32 v57, v113
    v_mov_b32 v58, v114
    v_mov_b32 v59, v115
    v_mov_b32 v60, v120
    v_mov_b32 v61, v121
    v_mov_b32 v62, v122
    v_mov_b32 v63, v123
    s_setprio 0
    v_mov_b32 v12, v3
    v_mov_b32 v13, v2
    v_lshrrev_b32 v1, 5, v0
    v_bfe_u32 v6, v0, 2, 2
    v_lshl_add_u32 v6, v1, 2, v6
    v_mul_u32_u24 v6, 320, v6
    v_bfe_u32 v7, v0, 1, 1
    v_bfe_u32 v14, v0, 4, 1
    v_lshl_add_u32 v7, v14, 1, v7
    v_lshl_add_u32 v6, v7, 3, v6
    v_and_b32 v7, 1, v0
    v_mul_u32_u24 v7, 160, v7
    v_add_u32 v9, v7, v6
    v_and_b32 v6, 31, v0
    v_mul_u32_u24 v6, 320, v6
    v_mul_u32_u24 v7, 160, v1
    s_mul_i32 s12, s8, 10240
    s_add_u32 s12, s12, 40960
    v_add3_u32 v240, v6, v7, s12
    v_add_u32 v241, s12, v2
    v_and_b32 v7, 3, v0
    v_lshlrev_b32 v8, 3, v7
    s_lshl_b32 s12, s92, 5
    s_add_u32 s40, s40, s12
    s_mov_b32 s10, 98304
    s_mov_b32 s55, 0
    s_mov_b32 s52, 0
    s_mov_b32 s43, 24
    s_mov_b32 s53, 0
    s_mul_i32 s41, s6, 3
    s_add_u32 s41, s41, s8
    s_lshl_b32 s41, s41, 4
    s_lshl_b32 s12, s92, 2
    s_add_u32 s41, s41, s12
    s_lshl_b32 s41, s41, 13
    s_waitcnt vmcnt(0)
    s_mov_b64 exec, 1
    buffer_store_dword v3, off, s[48:51], s13 sc1
    s_mov_b64 exec, -1
    v_mov_b32 v128, 0
    v_mov_b32 v129, 0
    v_mov_b32 v130, 0
    v_mov_b32 v131, 0
    v_mov_b32 v132, 0
    v_mov_b32 v133, 0
    v_mov_b32 v134, 0
    v_mov_b32 v135, 0
    v_mov_b32 v136, 0
    v_mov_b32 v137, 0
    v_mov_b32 v138, 0
    v_mov_b32 v139, 0
    v_mov_b32 v140, 0
    v_mov_b32 v141, 0
    v_mov_b32 v142, 0
    v_mov_b32 v143, 0
    v_mov_b32 v144, 0
    v_mov_b32 v145, 0
    v_mov_b32 v146, 0
    v_mov_b32 v147, 0
    v_mov_b32 v148, 0
    v_mov_b32 v149, 0
    v_mov_b32 v150, 0
    v_mov_b32 v151, 0
    v_mov_b32 v152, 0
    v_mov_b32 v153, 0
    v_mov_b32 v154, 0
    v_mov_b32 v155, 0
    v_mov_b32 v156, 0
    v_mov_b32 v157, 0
    v_mov_b32 v158, 0
    v_mov_b32 v159, 0
    v_mov_b32 v160, 0
    v_mov_b32 v161, 0
    v_mov_b32 v162, 0
    v_mov_b32 v163, 0
    v_mov_b32 v164, 0
    v_mov_b32 v165, 0
    v_mov_b32 v166, 0
    v_mov_b32 v167, 0
    v_mov_b32 v168, 0
    v_mov_b32 v169, 0
    v_mov_b32 v170, 0
    v_mov_b32 v171, 0
    v_mov_b32 v172, 0
    v_mov_b32 v173, 0
    v_mov_b32 v174, 0
    v_mov_b32 v175, 0
    v_mov_b32 v176, 0
    v_mov_b32 v177, 0
    v_mov_b32 v178, 0
    v_mov_b32 v179, 0
    v_mov_b32 v180, 0
    v_mov_b32 v181, 0
    v_mov_b32 v182, 0
    v_mov_b32 v183, 0
    v_mov_b32 v184, 0
    v_mov_b32 v185, 0
    v_mov_b32 v186, 0
    v_mov_b32 v187, 0
    v_mov_b32 v188, 0
    v_mov_b32 v189, 0
    v_mov_b32 v190, 0
    v_mov_b32 v191, 0
    v_mov_b32 v192, 0
    v_mov_b32 v193, 0
    v_mov_b32 v194, 0
    v_mov_b32 v195, 0
    v_mov_b32 v196, 0
    v_mov_b32 v197, 0
    v_mov_b32 v198, 0
    v_mov_b32 v199, 0
    v_mov_b32 v200, 0
    v_mov_b32 v201, 0
    v_mov_b32 v202, 0
    v_mov_b32 v203, 0
    v_mov_b32 v204, 0
    v_mov_b32 v205, 0
    v_mov_b32 v206, 0
    v_mov_b32 v207, 0
    s_nop 1
LA_part:
    ds_read_b32 v6, v10 offset:108
    s_add_u32 s55, s55, 1
    s_cmp_eq_u32 s52, 0
    s_mov_b32 s10, 139264
    s_cselect_b32 s10, 98304, s10
    v_add_u32 v0, s10, v9
    s_waitcnt lgkmcnt(0)
    v_readfirstlane_b32 s54, v6
    s_nop 0
    s_cmp_ge_u32 s54, s55
    s_cbranch_scc0 LC99
LC99_ret:
    ds_read_b64_tr_b16 v[16:17], v0 offset:0
    ds_read_b64_tr_b16 v[18:19], v0 offset:2560
    ds_read_b64_tr_b16 v[20:21], v0 offset:32
    ds_read_b64_tr_b16 v[22:23], v0 offset:2592
    ds_read_b64_tr_b16 v[24:25], v0 offset:64
    ds_read_b64_tr_b16 v[26:27], v0 offset:2624
    ds_read_b64_tr_b16 v[28:29], v0 offset:96
    ds_read_b64_tr_b16 v[30:31], v0 offset:2656
    s_waitcnt lgkmcnt(6)
    v_mfma_f32_32x32x16_bf16 v[128:143], v[16:19], v[32:35], v[128:143]
    ds_read_b64_tr_b16 v[16:17], v0 offset:128
    ds_read_b64_tr_b16 v[18:19], v0 offset:2688
    s_waitcnt lgkmcnt(6)
    v_mfma_f32_32x32x16_bf16 v[144:159], v[20:23], v[32:35], v[144:159]
    ds_read_b64_tr_b16 v[20:21], v0 offset:5120
    ds_read_b64_tr_b16 v[22:23], v0 offset:7680
    s_waitcnt lgkmcnt(6)
    v_mfma_f32_32x32x16_bf16 v[160:175], v[24:27], v[32:35], v[160:175]
    ds_read_b64_tr_b16 v[24:25], v0 offset:5152
    ds_read_b64_tr_b16 v[26:27], v0 offset:7712
    s_waitcnt lgkmcnt(6)
    v_mfma_f32_32x32x16_bf16 v[176:191], v[28:31], v[32:35], v[176:191]
    ds_read_b64_tr_b16 v[28:29], v0 offset:5184
    ds_read_b64_tr_b16 v[30:31], v0 offset:7744
    s_waitcnt lgkmcnt(6)
    v_mfma_f32_32x32x16_bf16 v[192:207], v[16:19], v[32:35], v[192:207]
    ds_read_b64_tr_b16 v[16:17], v0 offset:5216
    ds_read_b64_tr_b16 v[18:19], v0 offset:7776
    s_waitcnt lgkmcnt(6)
    v_mfma_f32_32x32x16_bf16 v[128:143], v[20:23], v[36:39], v[128:143]
    ds_read_b64_tr_b16 v[20:21], v0 offset:5248
    ds_read_b64_tr_b16 v[22:23], v0 offset:7808
    s_waitcnt lgkmcnt(6)
    v_mfma_f32_32x32x16_bf16 v[144:159], v[24:27], v[36:39], v[144:159]
    ds_read_b64_tr_b16 v[24:25], v0 offset:10240
    ds_read_b64_tr_b16 v[26:27], v0 offset:12800
    s_waitcnt lgkmcnt(6)
    v_mfma_f32_32x32x16_bf16 v[160:175], v[28:31], v[36:39], v[160:175]
    ds_read_b64_tr_b16 v[28:29], v0 offset:10272
    ds_read_b64_tr_b16 v[30:31], v0 offset:12832
    s_waitcnt lgkmcnt(6)
    v_mfma_f32_32x32x16_bf16 v[176:191], v[16:19], v[36:39], v[176:191]
    ds_read_b64_tr_b16 v[16:17], v0 offset:10304
    ds_read_b64_tr_b16 v[18:19], v0 offset:12864
    s_waitcnt lgkmcnt(6)
    v_mfma_f32_32x32x16_bf16 v[192:207], v[20:23], v[36:39], v[192:207]
    ds_read_b64_tr_b16 v[20:21], v0 offset:10336
    ds_read_b64_tr_b16 v[22:23], v0 offset:12896
    s_waitcnt lgkmcnt(6)
    v_mfma_f32_32x32x16_bf16 v[128:143], v[24:27], v[40:43], v[128:143]
    ds_read_b64_tr_b16 v[24:25], v0 offset:10368
    ds_read_b64_tr_b16 v[26:27], v0 offset:12928
    s_waitcnt lgkmcnt(6)
    v_mfma_f32_32x32x16_bf16 v[144:159], v[28:31], v[40:43], v[144:159]
    ds_read_b64_tr_b16 v[28:29], v0 offset:15360
    ds_read_b64_tr_b16 v[30:31], v0 offset:17920
    ds_read_b32 v6, v10 offset:108
    s_waitcnt lgkmcnt(7)
    v_mfma_f32_32x32x16_bf16 v[160:175], v[16:19], v[40:43], v[160:175]
    ds_read_b64_tr_b16 v[16:17], v0 offset:15392
    ds_read_b64_tr_b16 v[18:19], v0 offset:17952
    s_waitcnt lgkmcnt(7)
    v_mfma_f32_32x32x16_bf16 v[176:191], v[20:23], v[40:43], v[176:191]
    ds_read_b64_tr_b16 v[20:21], v0 offset:15424
    ds_read_b64_tr_b16 v[22:23], v0 offset:17984
    s_waitcnt lgkmcnt(7)
    v_mfma_f32_32x32x16_bf16 v[192:207], v[24:27], v[40:43], v[192:207]
    ds_read_b64_tr_b16 v[24:25], v0 offset:15456
    ds_read_b64_tr_b16 v[26:27], v0 offset:18016
    s_waitcnt lgkmcnt(7)
    v_mfma_f32_32x32x16_bf16 v[128:143], v[28:31], v[44:47], v[128:143]
    ds_read_b64_tr_b16 v[28:29], v0 offset:15488
    ds_read_b64_tr_b16 v[30:31], v0 offset:18048
    s_add_u32 s12, s55, 20
    v_mov_b32 v7, s12
    ds_write_b32 v4, v7 offset:48
    s_waitcnt lgkmcnt(7)
    v_mfma_f32_32x32x16_bf16 v[144:159], v[16:19], v[44:47], v[144:159]
    s_add_u32 s55, s55, 1
    s_cmp_eq_u32 s52, 0
    s_mov_b32 s10, 98304
    s_cselect_b32 s10, 118784, s10
    v_add_u32 v0, s10, v9
    v_readfirstlane_b32 s54, v6
    s_nop 0
    s_cmp_ge_u32 s54, s55
    s_cbranch_scc0 LC100
LC100_ret:
    ds_read_b64_tr_b16 v[16:17], v0 offset:0
    ds_read_b64_tr_b16 v[18:19], v0 offset:2560
    s_waitcnt lgkmcnt(7)
    v_mfma_f32_32x32x16_bf16 v[160:175], v[20:23], v[44:47], v[160:175]
    ds_read_b64_tr_b16 v[20:21], v0 offset:32
    ds_read_b64_tr_b16 v[22:23], v0 offset:2592
    s_waitcnt lgkmcnt(7)
    v_mfma_f32_32x32x16_bf16 v[176:191], v[24:27], v[44:47], v[176:191]
    ds_read_b64_tr_b16 v[24:25], v0 offset:64
    ds_read_b64_tr_b16 v[26:27], v0 offset:2624
    s_waitcnt lgkmcnt(7)
    v_mfma_f32_32x32x16_bf16 v[192:207], v[28:31], v[44:47], v[192:207]
    ds_read_b64_tr_b16 v[28:29], v0 offset:96
    ds_read_b64_tr_b16 v[30:31], v0 offset:2656
    s_waitcnt lgkmcnt(6)
    v_mfma_f32_32x32x16_bf16 v[128:143], v[16:19], v[48:51], v[128:143]
    ds_read_b64_tr_b16 v[16:17], v0 offset:128
    ds_read_b64_tr_b16 v[18:19], v0 offset:2688
    s_waitcnt lgkmcnt(6)
    v_mfma_f32_32x32x16_bf16 v[144:159], v[20:23], v[48:51], v[144:159]
    ds_read_b64_tr_b16 v[20:21], v0 offset:5120
    ds_read_b64_tr_b16 v[22:23], v0 offset:7680
    s_waitcnt lgkmcnt(6)
    v_mfma_f32_32x32x16_bf16 v[160:175], v[24:27], v[48:51], v[160:175]
    ds_read_b64_tr_b16 v[24:25], v0 offset:5152
    ds_read_b64_tr_b16 v[26:27], v0 offset:7712
    s_waitcnt lgkmcnt(6)
    v_mfma_f32_32x32x16_bf16 v[176:191], v[28:31], v[48:51], v[176:191]
    ds_read_b64_tr_b16 v[28:29], v0 offset:5184
    ds_read_b64_tr_b16 v[30:31], v0 offset:7744
    s_waitcnt lgkmcnt(6)
    v_mfma_f32_32x32x16_bf16 v[192:207], v[16:19], v[48:51], v[192:207]
    ds_read_b64_tr_b16 v[16:17], v0 offset:5216
    ds_read_b64_tr_b16 v[18:19], v0 offset:7776
    s_waitcnt lgkmcnt(6)
    v_mfma_f32_32x32x16_bf16 v[128:143], v[20:23], v[52:55], v[128:143]
    ds_read_b64_tr_b16 v[20:21], v0 offset:5248
    ds_read_b64_tr_b16 v[22:23], v0 offset:7808
    s_waitcnt lgkmcnt(6)
    v_mfma_f32_32x32x16_bf16 v[144:159], v[24:27], v[52:55], v[144:159]
    ds_read_b64_tr_b16 v[24:25], v0 offset:10240
    ds_read_b64_tr_b16 v[26:27], v0 offset:12800
    s_waitcnt lgkmcnt(6)
    v_mfma_f32_32x32x16_bf16 v[160:175], v[28:31], v[52:55], v[160:175]
    ds_read_b64_tr_b16 v[28:29], v0 offset:10272
    ds_read_b64_tr_b16 v[30:31], v0 offset:12832
    s_waitcnt lgkmcnt(6)
    v_mfma_f32_32x32x16_bf16 v[176:191], v[16:19], v[52:55], v[176:191]
    ds_read_b64_tr_b16 v[16:17], v0 offset:10304
    ds_read_b64_tr_b16 v[18:19], v0 offset:12864
    s_waitcnt lgkmcnt(6)
    v_mfma_f32_32x32x16_bf16 v[192:207], v[20:23], v[52:55], v[192:207]
    ds_read_b64_tr_b16 v[20:21], v0 offset:10336
    ds_read_b64_tr_b16 v[22:23], v0 offset:12896
    s_waitcnt lgkmcnt(6)
    v_mfma_f32_32x32x16_bf16 v[128:143], v[24:27], v[56:59], v[128:143]
    ds_read_b64_tr_b16 v[24:25], v0 offset:10368
    ds_read_b64_tr_b16 v[26:27], v0 offset:12928
    s_waitcnt lgkmcnt(6)
    v_mfma_f32_32x32x16_bf16 v[144:159], v[28:31], v[56:59], v[144:159]
    ds_read_b64_tr_b16 v[28:29], v0 offset:15360
    ds_read_b64_tr_b16 v[30:31], v0 offset:17920
    s_waitcnt lgkmcnt(6)
    v_mfma_f32_32x32x16_bf16 v[160:175], v[16:19], v[56:59], v[160:175]
    ds_read_b64_tr_b16 v[16:17], v0 offset:15392
    ds_read_b64_tr_b16 v[18:19], v0 offset:17952
    s_waitcnt lgkmcnt(6)
    v_mfma_f32_32x32x16_bf16 v[176:191], v[20:23], v[56:59], v[176:191]
    ds_read_b64_tr_b16 v[20:21], v0 offset:15424
    ds_read_b64_tr_b16 v[22:23], v0 offset:17984
    s_waitcnt lgkmcnt(6)
    v_mfma_f32_32x32x16_bf16 v[192:207], v[24:27], v[56:59], v[192:207]
    ds_read_b64_tr_b16 v[24:25], v0 offset:15456
    ds_read_b64_tr_b16 v[26:27], v0 offset:18016
    s_waitcnt lgkmcnt(6)
    v_mfma_f32_32x32x16_bf16 v[128:143], v[28:31], v[60:63], v[128:143]
    ds_read_b64_tr_b16 v[28:29], v0 offset:15488
    ds_read_b64_tr_b16 v[30:31], v0 offset:18048
    s_add_u32 s12, s55, 20
    v_mov_b32 v7, s12
    ds_write_b32 v4, v7 offset:48
    s_waitcnt lgkmcnt(7)
    v_mfma_f32_32x32x16_bf16 v[144:159], v[16:19], v[60:63], v[144:159]
    s_waitcnt lgkmcnt(5)
    v_mfma_f32_32x32x16_bf16 v[160:175], v[20:23], v[60:63], v[160:175]
    s_waitcnt lgkmcnt(3)
    v_mfma_f32_32x32x16_bf16 v[176:191], v[24:27], v[60:63], v[176:191]
    s_waitcnt lgkmcnt(1)
    v_mfma_f32_32x32x16_bf16 v[192:207], v[28:31], v[60:63], v[192:207]
    s_nop 11
LA_pf:
LP101:
    ds_read_b32 v6, v10 offset:0
    s_waitcnt lgkmcnt(0)
    v_readfirstlane_b32 s12, v6
    s_nop 0
    s_cmp_ge_u32 s12, s43
    s_nop 2
    s_cbranch_scc1 LP101_ok
    s_sleep 4
    s_branch LP101
LP101_ok:
    buffer_load_dword v6, v8, s[48:51], s40 offen sc1
    s_add_u32 s53, s53, 1
    s_add_u32 s43, s43, 3
    s_min_u32 s43, s43, 32
    s_waitcnt vmcnt(0)
    v_cmp_eq_u32 vcc, v6, v12
    s_nop 0
    s_cmp_eq_u32 vcc_lo, -1
    s_nop 2
    s_cbranch_scc1 LA_pfok
    s_cmp_ge_u32 s53, 131072
    s_cbranch_scc1 LA_pfok
    s_sleep 4
    s_cmp_eq_u32 s52, 0
    s_cbranch_scc0 LA_pf
    s_sleep 12
    s_branch LA_pf
LA_pfok:
    s_add_u32 s12, s93, 1
    s_and_b32 s12, s12, 3
    s_lshl_b32 s12, s12, 13
    s_add_u32 s12, s12, s41
    s_add_u32 s13, s12, 4096
    buffer_load_dwordx4 v[64:67], v13, s[48:51], s12 offen offset:0 sc1
    buffer_load_dwordx4 v[68:71], v13, s[48:51], s12 offen offset:1024 sc1
    buffer_load_dwordx4 v[72:75], v13, s[48:51], s12 offen offset:2048 sc1
    buffer_load_dwordx4 v[76:79], v13, s[48:51], s12 offen offset:3072 sc1
    buffer_load_dwordx4 v[80:83], v13, s[48:51], s13 offen offset:0 sc1
    buffer_load_dwordx4 v[84:87], v13, s[48:51], s13 offen offset:1024 sc1
    buffer_load_dwordx4 v[88:91], v13, s[48:51], s13 offen offset:2048 sc1
    buffer_load_dwordx4 v[92:95], v13, s[48:51], s13 offen offset:3072 sc1
    s_add_u32 s12, s93, 2
    s_and_b32 s12, s12, 3
    s_lshl_b32 s12, s12, 13
    s_add_u32 s12, s12, s41
    s_add_u32 s13, s12, 4096
    buffer_load_dwordx4 v[96:99], v13, s[48:51], s12 offen offset:0 sc1
    buffer_load_dwordx4 v[100:103], v13, s[48:51], s12 offen offset:1024 sc1
    buffer_load_dwordx4 v[104:107], v13, s[48:51], s12 offen offset:2048 sc1
    buffer_load_dwordx4 v[108:111], v13, s[48:51], s12 offen offset:3072 sc1
    buffer_load_dwordx4 v[112:115], v13, s[48:51], s13 offen offset:0 sc1
    buffer_load_dwordx4 v[116:119], v13, s[48:51], s13 offen offset:1024 sc1
    buffer_load_dwordx4 v[120:123], v13, s[48:51], s13 offen offset:2048 sc1
    buffer_load_dwordx4 v[124:127], v13, s[48:51], s13 offen offset:3072 sc1
    s_add_u32 s12, s93, 3
    s_and_b32 s12, s12, 3
    s_lshl_b32 s12, s12, 13
    s_add_u32 s12, s12, s41
    s_add_u32 s13, s12, 4096
    buffer_load_dwordx4 v[208:211], v13, s[48:51], s12 offen offset:0 sc1
    buffer_load_dwordx4 v[212:215], v13, s[48:51], s12 offen offset:1024 sc1
    buffer_load_dwordx4 v[216:219], v13, s[48:51], s12 offen offset:2048 sc1
    buffer_load_dwordx4 v[220:223], v13, s[48:51], s12 offen offset:3072 sc1
    buffer_load_dwordx4 v[224:227], v13, s[48:51], s13 offen offset:0 sc1
    buffer_load_dwordx4 v[228:231], v13, s[48:51], s13 offen offset:1024 sc1
    buffer_load_dwordx4 v[232:235], v13, s[48:51], s13 offen offset:2048 sc1
    buffer_load_dwordx4 v[236:239], v13, s[48:51], s13 offen offset:3072 sc1
    ds_read_b32 v6, v10 offset:108
    s_add_u32 s55, s55, 1
    s_cmp_eq_u32 s52, 0
    s_mov_b32 s10, 118784
    s_cselect_b32 s10, 139264, s10
    v_add_u32 v0, s10, v9
    s_waitcnt lgkmcnt(0)
    v_readfirstlane_b32 s54, v6
    s_nop 0
    s_cmp_ge_u32 s54, s55
    s_cbranch_scc0 LC102
LC102_ret:
    ds_read_b64_tr_b16 v[16:17], v0 offset:0
    ds_read_b64_tr_b16 v[18:19], v0 offset:2560
    ds_read_b64_tr_b16 v[20:21], v0 offset:32
    ds_read_b64_tr_b16 v[22:23], v0 offset:2592
    ds_read_b64_tr_b16 v[24:25], v0 offset:64
    ds_read_b64_tr_b16 v[26:27], v0 offset:2624
    ds_read_b64_tr_b16 v[28:29], v0 offset:96
    ds_read_b64_tr_b16 v[30:31], v0 offset:2656
    s_waitcnt vmcnt(23) lgkmcnt(6)
    v_mfma_f32_32x32x16_bf16 v[128:143], v[16:19], v[64:67], v[128:143]
    ds_read_b64_tr_b16 v[16:17], v0 offset:128
    ds_read_b64_tr_b16 v[18:19], v0 offset:2688
    s_waitcnt lgkmcnt(6)
    v_mfma_f32_32x32x16_bf16 v[144:159], v[20:23], v[64:67], v[144:159]
    ds_read_b64_tr_b16 v[20:21], v0 offset:5120
    ds_read_b64_tr_b16 v[22:23], v0 offset:7680
    s_waitcnt lgkmcnt(6)
    v_mfma_f32_32x32x16_bf16 v[160:175], v[24:27], v[64:67], v[160:175]
    ds_read_b64_tr_b16 v[24:25], v0 offset:5152
    ds_read_b64_tr_b16 v[26:27], v0 offset:7712
    s_waitcnt lgkmcnt(6)
    v_mfma_f32_32x32x16_bf16 v[176:191], v[28:31], v[64:67], v[176:191]
    ds_read_b64_tr_b16 v[28:29], v0 offset:5184
    ds_read_b64_tr_b16 v[30:31], v0 offset:7744
    s_waitcnt lgkmcnt(6)
    v_mfma_f32_32x32x16_bf16 v[192:207], v[16:19], v[64:67], v[192:207]
    ds_read_b64_tr_b16 v[16:17], v0 offset:5216
    ds_read_b64_tr_b16 v[18:19], v0 offset:7776
    s_waitcnt vmcnt(22) lgkmcnt(6)
    v_mfma_f32_32x32x16_bf16 v[128:143], v[20:23], v[68:71], v[128:143]
    ds_read_b64_tr_b16 v[20:21], v0 offset:5248
    ds_read_b64_tr_b16 v[22:23], v0 offset:7808
    s_waitcnt lgkmcnt(6)
    v_mfma_f32_32x32x16_bf16 v[144:159], v[24:27], v[68:71], v[144:159]
    ds_read_b64_tr_b16 v[24:25], v0 offset:10240
    ds_read_b64_tr_b16 v[26:27], v0 offset:12800
    s_waitcnt lgkmcnt(6)
    v_mfma_f32_32x32x16_bf16 v[160:175], v[28:31], v[68:71], v[160:175]
    ds_read_b64_tr_b16 v[28:29], v0 offset:10272
    ds_read_b64_tr_b16 v[30:31], v0 offset:12832
    s_waitcnt lgkmcnt(6)
    v_mfma_f32_32x32x16_bf16 v[176:191], v[16:19], v[68:71], v[176:191]
    ds_read_b64_tr_b16 v[16:17], v0 offset:10304
    ds_read_b64_tr_b16 v[18:19], v0 offset:12864
    s_waitcnt lgkmcnt(6)
    v_mfma_f32_32x32x16_bf16 v[192:207], v[20:23], v[68:71], v[192:207]
    ds_read_b64_tr_b16 v[20:21], v0 offset:10336
    ds_read_b64_tr_b16 v[22:23], v0 offset:12896
    s_waitcnt vmcnt(21) lgkmcnt(6)
    v_mfma_f32_32x32x16_bf16 v[128:143], v[24:27], v[72:75], v[128:143]
    ds_read_b64_tr_b16 v[24:25], v0 offset:10368
    ds_read_b64_tr_b16 v[26:27], v0 offset:12928
    s_waitcnt lgkmcnt(6)
    v_mfma_f32_32x32x16_bf16 v[144:159], v[28:31], v[72:75], v[144:159]
    ds_read_b64_tr_b16 v[28:29], v0 offset:15360
    ds_read_b64_tr_b16 v[30:31], v0 offset:17920
    ds_read_b32 v6, v10 offset:108
    s_waitcnt lgkmcnt(7)
    v_mfma_f32_32x32x16_bf16 v[160:175], v[16:19], v[72:75], v[160:175]
    ds_read_b64_tr_b16 v[16:17], v0 offset:15392
    ds_read_b64_tr_b16 v[18:19], v0 offset:17952
    s_waitcnt lgkmcnt(7)
    v_mfma_f32_32x32x16_bf16 v[176:191], v[20:23], v[72:75], v[176:191]
    ds_read_b64_tr_b16 v[20:21], v0 offset:15424
    ds_read_b64_tr_b16 v[22:23], v0 offset:17984
    s_waitcnt lgkmcnt(7)
    v_mfma_f32_32x32x16_bf16 v[192:207], v[24:27], v[72:75], v[192:207]
    ds_read_b64_tr_b16 v[24:25], v0 offset:15456
    ds_read_b64_tr_b16 v[26:27], v0 offset:18016
    s_waitcnt vmcnt(20) lgkmcnt(7)
    v_mfma_f32_32x32x16_bf16 v[128:143], v[28:31], v[76:79], v[128:143]
    ds_read_b64_tr_b16 v[28:29], v0 offset:15488
    ds_read_b64_tr_b16 v[30:31], v0 offset:18048
    s_add_u32 s12, s55, 20
    v_mov_b32 v7, s12
    ds_write_b32 v4, v7 offset:48
    s_waitcnt lgkmcnt(7)
    v_mfma_f32_32x32x16_bf16 v[144:159], v[16:19], v[76:79], v[144:159]
    s_add_u32 s55, s55, 1
    s_cmp_eq_u32 s52, 0
    s_mov_b32 s10, 73728
    s_cselect_b32 s10, 98304, s10
    v_add_u32 v0, s10, v9
    v_readfirstlane_b32 s54, v6
    s_nop 0
    s_cmp_ge_u32 s54, s55
    s_cbranch_scc0 LC103
LC103_ret:
    ds_read_b64_tr_b16 v[16:17], v0 offset:0
    ds_read_b64_tr_b16 v[18:19], v0 offset:2560
    s_waitcnt lgkmcnt(7)
    v_mfma_f32_32x32x16_bf16 v[160:175], v[20:23], v[76:79], v[160:175]
    ds_read_b64_tr_b16 v[20:21], v0 offset:32
    ds_read_b64_tr_b16 v[22:23], v0 offset:2592
    s_waitcnt lgkmcnt(7)
    v_mfma_f32_32x32x16_bf16 v[176:191], v[24:27], v[76:79], v[176:191]
    ds_read_b64_tr_b16 v[24:25], v0 offset:64
    ds_read_b64_tr_b16 v[26:27], v0 offset:2624
    s_waitcnt lgkmcnt(7)
    v_mfma_f32_32x32x16_bf16 v[192:207], v[28:31], v[76:79], v[192:207]
    ds_read_b64_tr_b16 v[28:29], v0 offset:96
    ds_read_b64_tr_b16 v[30:31], v0 offset:2656
    s_waitcnt vmcnt(19) lgkmcnt(6)
    v_mfma_f32_32x32x16_bf16 v[128:143], v[16:19], v[80:83], v[128:143]
    ds_read_b64_tr_b16 v[16:17], v0 offset:128
    ds_read_b64_tr_b16 v[18:19], v0 offset:2688
    s_waitcnt lgkmcnt(6)
    v_mfma_f32_32x32x16_bf16 v[144:159], v[20:23], v[80:83], v[144:159]
    ds_read_b64_tr_b16 v[20:21], v0 offset:5120
    ds_read_b64_tr_b16 v[22:23], v0 offset:7680
    s_waitcnt lgkmcnt(6)
    v_mfma_f32_32x32x16_bf16 v[160:175], v[24:27], v[80:83], v[160:175]
    ds_read_b64_tr_b16 v[24:25], v0 offset:5152
    ds_read_b64_tr_b16 v[26:27], v0 offset:7712
    s_waitcnt lgkmcnt(6)
    v_mfma_f32_32x32x16_bf16 v[176:191], v[28:31], v[80:83], v[176:191]
    ds_read_b64_tr_b16 v[28:29], v0 offset:5184
    ds_read_b64_tr_b16 v[30:31], v0 offset:7744
    s_waitcnt lgkmcnt(6)
    v_mfma_f32_32x32x16_bf16 v[192:207], v[16:19], v[80:83], v[192:207]
    ds_read_b64_tr_b16 v[16:17], v0 offset:5216
    ds_read_b64_tr_b16 v[18:19], v0 offset:7776
    s_waitcnt vmcnt(18) lgkmcnt(6)
    v_mfma_f32_32x32x16_bf16 v[128:143], v[20:23], v[84:87], v[128:143]
    ds_read_b64_tr_b16 v[20:21], v0 offset:5248
    ds_read_b64_tr_b16 v[22:23], v0 offset:7808
    s_waitcnt lgkmcnt(6)
    v_mfma_f32_32x32x16_bf16 v[144:159], v[24:27], v[84:87], v[144:159]
    ds_read_b64_tr_b16 v[24:25], v0 offset:10240
    ds_read_b64_tr_b16 v[26:27], v0 offset:12800
    s_waitcnt lgkmcnt(6)
    v_mfma_f32_32x32x16_bf16 v[160:175], v[28:31], v[84:87], v[160:175]
    ds_read_b64_tr_b16 v[28:29], v0 offset:10272
    ds_read_b64_tr_b16 v[30:31], v0 offset:12832
    s_waitcnt lgkmcnt(6)
    v_mfma_f32_32x32x16_bf16 v[176:191], v[16:19], v[84:87], v[176:191]
    ds_read_b64_tr_b16 v[16:17], v0 offset:10304
    ds_read_b64_tr_b16 v[18:19], v0 offset:12864
    s_waitcnt lgkmcnt(6)
    v_mfma_f32_32x32x16_bf16 v[192:207], v[20:23], v[84:87], v[192:207]
    ds_read_b64_tr_b16 v[20:21], v0 offset:10336
    ds_read_b64_tr_b16 v[22:23], v0 offset:12896
    s_waitcnt vmcnt(17) lgkmcnt(6)
    v_mfma_f32_32x32x16_bf16 v[128:143], v[24:27], v[88:91], v[128:143]
    ds_read_b64_tr_b16 v[24:25], v0 offset:10368
    ds_read_b64_tr_b16 v[26:27], v0 offset:12928
    s_waitcnt lgkmcnt(6)
    v_mfma_f32_32x32x16_bf16 v[144:159], v[28:31], v[88:91], v[144:159]
    ds_read_b64_tr_b16 v[28:29], v0 offset:15360
    ds_read_b64_tr_b16 v[30:31], v0 offset:17920
    ds_read_b32 v6, v10 offset:108
    s_waitcnt lgkmcnt(7)
    v_mfma_f32_32x32x16_bf16 v[160:175], v[16:19], v[88:91], v[160:175]
    ds_read_b64_tr_b16 v[16:17], v0 offset:15392
    ds_read_b64_tr_b16 v[18:19], v0 offset:17952
    s_waitcnt lgkmcnt(7)
    v_mfma_f32_32x32x16_bf16 v[176:191], v[20:23], v[88:91], v[176:191]
    ds_read_b64_tr_b16 v[20:21], v0 offset:15424
    ds_read_b64_tr_b16 v[22:23], v0 offset:17984
    s_waitcnt lgkmcnt(7)
    v_mfma_f32_32x32x16_bf16 v[192:207], v[24:27], v[88:91], v[192:207]
    ds_read_b64_tr_b16 v[24:25], v0 offset:15456
    ds_read_b64_tr_b16 v[26:27], v0 offset:18016
    s_waitcnt vmcnt(16) lgkmcnt(7)
    v_mfma_f32_32x32x16_bf16 v[128:143], v[28:31], v[92:95], v[128:143]
    ds_read_b64_tr_b16 v[28:29], v0 offset:15488
    ds_read_b64_tr_b16 v[30:31], v0 offset:18048
    s_add_u32 s12, s55, 20
    v_mov_b32 v7, s12
    ds_write_b32 v4, v7 offset:48
    s_waitcnt lgkmcnt(7)
    v_mfma_f32_32x32x16_bf16 v[144:159], v[16:19], v[92:95], v[144:159]
    s_add_u32 s55, s55, 1
    s_cmp_eq_u32 s52, 0
    s_mov_b32 s10, 0
    s_cselect_b32 s10, 118784, s10
    v_add_u32 v0, s10, v9
    v_readfirstlane_b32 s54, v6
    s_nop 0
    s_cmp_ge_u32 s54, s55
    s_cbranch_scc0 LC104
LC104_ret:
    ds_read_b64_tr_b16 v[16:17], v0 offset:0
    ds_read_b64_tr_b16 v[18:19], v0 offset:2560
    s_waitcnt lgkmcnt(7)
    v_mfma_f32_32x32x16_bf16 v[160:175], v[20:23], v[92:95], v[160:175]
    ds_read_b64_tr_b16 v[20:21], v0 offset:32
    ds_read_b64_tr_b16 v[22:23], v0 offset:2592
    s_waitcnt lgkmcnt(7)
    v_mfma_f32_32x32x16_bf16 v[176:191], v[24:27], v[92:95], v[176:191]
    ds_read_b64_tr_b16 v[24:25], v0 offset:64
    ds_read_b64_tr_b16 v[26:27], v0 offset:2624
    s_waitcnt lgkmcnt(7)
    v_mfma_f32_32x32x16_bf16 v[192:207], v[28:31], v[92:95], v[192:207]
    ds_read_b64_tr_b16 v[28:29], v0 offset:96
    ds_read_b64_tr_b16 v[30:31], v0 offset:2656
    s_waitcnt vmcnt(15) lgkmcnt(6)
    v_mfma_f32_32x32x16_bf16 v[128:143], v[16:19], v[96:99], v[128:143]
    ds_read_b64_tr_b16 v[16:17], v0 offset:128
    ds_read_b64_tr_b16 v[18:19], v0 offset:2688
    s_waitcnt lgkmcnt(6)
    v_mfma_f32_32x32x16_bf16 v[144:159], v[20:23], v[96:99], v[144:159]
    ds_read_b64_tr_b16 v[20:21], v0 offset:5120
    ds_read_b64_tr_b16 v[22:23], v0 offset:7680
    s_waitcnt lgkmcnt(6)
    v_mfma_f32_32x32x16_bf16 v[160:175], v[24:27], v[96:99], v[160:175]
    ds_read_b64_tr_b16 v[24:25], v0 offset:5152
    ds_read_b64_tr_b16 v[26:27], v0 offset:7712
    s_waitcnt lgkmcnt(6)
    v_mfma_f32_32x32x16_bf16 v[176:191], v[28:31], v[96:99], v[176:191]
    ds_read_b64_tr_b16 v[28:29], v0 offset:5184
    ds_read_b64_tr_b16 v[30:31], v0 offset:7744
    s_waitcnt lgkmcnt(6)
    v_mfma_f32_32x32x16_bf16 v[192:207], v[16:19], v[96:99], v[192:207]
    ds_read_b64_tr_b16 v[16:17], v0 offset:5216
    ds_read_b64_tr_b16 v[18:19], v0 offset:7776
    s_waitcnt vmcnt(14) lgkmcnt(6)
    v_mfma_f32_32x32x16_bf16 v[128:143], v[20:23], v[100:103], v[128:143]
    ds_read_b64_tr_b16 v[20:21], v0 offset:5248
    ds_read_b64_tr_b16 v[22:23], v0 offset:7808
    s_waitcnt lgkmcnt(6)
    v_mfma_f32_32x32x16_bf16 v[144:159], v[24:27], v[100:103], v[144:159]
    ds_read_b64_tr_b16 v[24:25], v0 offset:10240
    ds_read_b64_tr_b16 v[26:27], v0 offset:12800
    s_waitcnt lgkmcnt(6)
    v_mfma_f32_32x32x16_bf16 v[160:175], v[28:31], v[100:103], v[160:175]
    ds_read_b64_tr_b16 v[28:29], v0 offset:10272
    ds_read_b64_tr_b16 v[30:31], v0 offset:12832
    s_waitcnt lgkmcnt(6)
    v_mfma_f32_32x32x16_bf16 v[176:191], v[16:19], v[100:103], v[176:191]
    ds_read_b64_tr_b16 v[16:17], v0 offset:10304
    ds_read_b64_tr_b16 v[18:19], v0 offset:12864
    s_waitcnt lgkmcnt(6)
    v_mfma_f32_32x32x16_bf16 v[192:207], v[20:23], v[100:103], v[192:207]
    ds_read_b64_tr_b16 v[20:21], v0 offset:10336
    ds_read_b64_tr_b16 v[22:23], v0 offset:12896
    s_waitcnt vmcnt(13) lgkmcnt(6)
    v_mfma_f32_32x32x16_bf16 v[128:143], v[24:27], v[104:107], v[128:143]
    ds_read_b64_tr_b16 v[24:25], v0 offset:10368
    ds_read_b64_tr_b16 v[26:27], v0 offset:12928
    s_waitcnt lgkmcnt(6)
    v_mfma_f32_32x32x16_bf16 v[144:159], v[28:31], v[104:107], v[144:159]
    ds_read_b64_tr_b16 v[28:29], v0 offset:15360
    ds_read_b64_tr_b16 v[30:31], v0 offset:17920
    ds_read_b32 v6, v10 offset:108
    s_waitcnt lgkmcnt(7)
    v_mfma_f32_32x32x16_bf16 v[160:175], v[16:19], v[104:107], v[160:175]
    ds_read_b64_tr_b16 v[16:17], v0 offset:15392
    ds_read_b64_tr_b16 v[18:19], v0 offset:17952
    s_waitcnt lgkmcnt(7)
    v_mfma_f32_32x32x16_bf16 v[176:191], v[20:23], v[104:107], v[176:191]
    ds_read_b64_tr_b16 v[20:21], v0 offset:15424
    ds_read_b64_tr_b16 v[22:23], v0 offset:17984
    s_waitcnt lgkmcnt(7)
    v_mfma_f32_32x32x16_bf16 v[192:207], v[24:27], v[104:107], v[192:207]
    ds_read_b64_tr_b16 v[24:25], v0 offset:15456
    ds_read_b64_tr_b16 v[26:27], v0 offset:18016
    s_waitcnt vmcnt(12) lgkmcnt(7)
    v_mfma_f32_32x32x16_bf16 v[128:143], v[28:31], v[108:111], v[128:143]
    ds_read_b64_tr_b16 v[28:29], v0 offset:15488
    ds_read_b64_tr_b16 v[30:31], v0 offset:18048
    s_add_u32 s12, s55, 20
    v_mov_b32 v7, s12
    ds_write_b32 v4, v7 offset:48
    s_waitcnt lgkmcnt(7)
    v_mfma_f32_32x32x16_bf16 v[144:159], v[16:19], v[108:111], v[144:159]
    s_add_u32 s55, s55, 1
    s_cmp_eq_u32 s52, 0
    s_mov_b32 s10, 20480
    s_cselect_b32 s10, 139264, s10
    v_add_u32 v0, s10, v9
    v_readfirstlane_b32 s54, v6
    s_nop 0
    s_cmp_ge_u32 s54, s55
    s_cbranch_scc0 LC105
LC105_ret:
    ds_read_b64_tr_b16 v[16:17], v0 offset:0
    ds_read_b64_tr_b16 v[18:19], v0 offset:2560
    s_waitcnt lgkmcnt(7)
    v_mfma_f32_32x32x16_bf16 v[160:175], v[20:23], v[108:111], v[160:175]
    ds_read_b64_tr_b16 v[20:21], v0 offset:32
    ds_read_b64_tr_b16 v[22:23], v0 offset:2592
    s_waitcnt lgkmcnt(7)
    v_mfma_f32_32x32x16_bf16 v[176:191], v[24:27], v[108:111], v[176:191]
    ds_read_b64_tr_b16 v[24:25], v0 offset:64
    ds_read_b64_tr_b16 v[26:27], v0 offset:2624
    s_waitcnt lgkmcnt(7)
    v_mfma_f32_32x32x16_bf16 v[192:207], v[28:31], v[108:111], v[192:207]
    ds_read_b64_tr_b16 v[28:29], v0 offset:96
    ds_read_b64_tr_b16 v[30:31], v0 offset:2656
    s_waitcnt vmcnt(11) lgkmcnt(6)
    v_mfma_f32_32x32x16_bf16 v[128:143], v[16:19], v[112:115], v[128:143]
    ds_read_b64_tr_b16 v[16:17], v0 offset:128
    ds_read_b64_tr_b16 v[18:19], v0 offset:2688
    s_waitcnt lgkmcnt(6)
    v_mfma_f32_32x32x16_bf16 v[144:159], v[20:23], v[112:115], v[144:159]
    ds_read_b64_tr_b16 v[20:21], v0 offset:5120
    ds_read_b64_tr_b16 v[22:23], v0 offset:7680
    s_waitcnt lgkmcnt(6)
    v_mfma_f32_32x32x16_bf16 v[160:175], v[24:27], v[112:115], v[160:175]
    ds_read_b64_tr_b16 v[24:25], v0 offset:5152
    ds_read_b64_tr_b16 v[26:27], v0 offset:7712
    s_waitcnt lgkmcnt(6)
    v_mfma_f32_32x32x16_bf16 v[176:191], v[28:31], v[112:115], v[176:191]
    ds_read_b64_tr_b16 v[28:29], v0 offset:5184
    ds_read_b64_tr_b16 v[30:31], v0 offset:7744
    s_waitcnt lgkmcnt(6)
    v_mfma_f32_32x32x16_bf16 v[192:207], v[16:19], v[112:115], v[192:207]
    ds_read_b64_tr_b16 v[16:17], v0 offset:5216
    ds_read_b64_tr_b16 v[18:19], v0 offset:7776
    s_waitcnt vmcnt(10) lgkmcnt(6)
    v_mfma_f32_32x32x16_bf16 v[128:143], v[20:23], v[116:119], v[128:143]
    ds_read_b64_tr_b16 v[20:21], v0 offset:5248
    ds_read_b64_tr_b16 v[22:23], v0 offset:7808
    s_waitcnt lgkmcnt(6)
    v_mfma_f32_32x32x16_bf16 v[144:159], v[24:27], v[116:119], v[144:159]
    ds_read_b64_tr_b16 v[24:25], v0 offset:10240
    ds_read_b64_tr_b16 v[26:27], v0 offset:12800
    s_waitcnt lgkmcnt(6)
    v_mfma_f32_32x32x16_bf16 v[160:175], v[28:31], v[116:119], v[160:175]
    ds_read_b64_tr_b16 v[28:29], v0 offset:10272
    ds_read_b64_tr_b16 v[30:31], v0 offset:12832
    s_waitcnt lgkmcnt(6)
    v_mfma_f32_32x32x16_bf16 v[176:191], v[16:19], v[116:119], v[176:191]
    ds_read_b64_tr_b16 v[16:17], v0 offset:10304
    ds_read_b64_tr_b16 v[18:19], v0 offset:12864
    s_waitcnt lgkmcnt(6)
    v_mfma_f32_32x32x16_bf16 v[192:207], v[20:23], v[116:119], v[192:207]
    ds_read_b64_tr_b16 v[20:21], v0 offset:10336
    ds_read_b64_tr_b16 v[22:23], v0 offset:12896
    s_waitcnt vmcnt(9) lgkmcnt(6)
    v_mfma_f32_32x32x16_bf16 v[128:143], v[24:27], v[120:123], v[128:143]
    ds_read_b64_tr_b16 v[24:25], v0 offset:10368
    ds_read_b64_tr_b16 v[26:27], v0 offset:12928
    s_waitcnt lgkmcnt(6)
    v_mfma_f32_32x32x16_bf16 v[144:159], v[28:31], v[120:123], v[144:159]
    ds_read_b64_tr_b16 v[28:29], v0 offset:15360
    ds_read_b64_tr_b16 v[30:31], v0 offset:17920
    ds_read_b32 v6, v10 offset:108
    s_waitcnt lgkmcnt(7)
    v_mfma_f32_32x32x16_bf16 v[160:175], v[16:19], v[120:123], v[160:175]
    ds_read_b64_tr_b16 v[16:17], v0 offset:15392
    ds_read_b64_tr_b16 v[18:19], v0 offset:17952
    s_waitcnt lgkmcnt(7)
    v_mfma_f32_32x32x16_bf16 v[176:191], v[20:23], v[120:123], v[176:191]
    ds_read_b64_tr_b16 v[20:21], v0 offset:15424
    ds_read_b64_tr_b16 v[22:23], v0 offset:17984
    s_waitcnt lgkmcnt(7)
    v_mfma_f32_32x32x16_bf16 v[192:207], v[24:27], v[120:123], v[192:207]
    ds_read_b64_tr_b16 v[24:25], v0 offset:15456
    ds_read_b64_tr_b16 v[26:27], v0 offset:18016
    s_waitcnt vmcnt(8) lgkmcnt(7)
    v_mfma_f32_32x32x16_bf16 v[128:143], v[28:31], v[124:127], v[128:143]
    ds_read_b64_tr_b16 v[28:29], v0 offset:15488
    ds_read_b64_tr_b16 v[30:31], v0 offset:18048
    s_add_u32 s12, s55, 20
    v_mov_b32 v7, s12
    ds_write_b32 v4, v7 offset:48
    s_waitcnt lgkmcnt(7)
    v_mfma_f32_32x32x16_bf16 v[144:159], v[16:19], v[124:127], v[144:159]
    s_add_u32 s55, s55, 1
    s_cmp_eq_u32 s52, 0
    s_mov_b32 s10, 139264
    s_cselect_b32 s10, 98304, s10
    v_add_u32 v0, s10, v9
    v_readfirstlane_b32 s54, v6
    s_nop 0
    s_cmp_ge_u32 s54, s55
    s_cbranch_scc0 LC106
LC106_ret:
    ds_read_b64_tr_b16 v[16:17], v0 offset:0
    ds_read_b64_tr_b16 v[18:19], v0 offset:2560
    s_waitcnt lgkmcnt(7)
    v_mfma_f32_32x32x16_bf16 v[160:175], v[20:23], v[124:127], v[160:175]
    ds_read_b64_tr_b16 v[20:21], v0 offset:32
    ds_read_b64_tr_b16 v[22:23], v0 offset:2592
    s_waitcnt lgkmcnt(7)
    v_mfma_f32_32x32x16_bf16 v[176:191], v[24:27], v[124:127], v[176:191]
    ds_read_b64_tr_b16 v[24:25], v0 offset:64
    ds_read_b64_tr_b16 v[26:27], v0 offset:2624
    s_waitcnt lgkmcnt(7)
    v_mfma_f32_32x32x16_bf16 v[192:207], v[28:31], v[124:127], v[192:207]
    ds_read_b64_tr_b16 v[28:29], v0 offset:96
    ds_read_b64_tr_b16 v[30:31], v0 offset:2656
    s_waitcnt vmcnt(7) lgkmcnt(6)
    v_mfma_f32_32x32x16_bf16 v[128:143], v[16:19], v[208:211], v[128:143]
    ds_read_b64_tr_b16 v[16:17], v0 offset:128
    ds_read_b64_tr_b16 v[18:19], v0 offset:2688
    s_waitcnt lgkmcnt(6)
    v_mfma_f32_32x32x16_bf16 v[144:159], v[20:23], v[208:211], v[144:159]
    ds_read_b64_tr_b16 v[20:21], v0 offset:5120
    ds_read_b64_tr_b16 v[22:23], v0 offset:7680
    s_waitcnt lgkmcnt(6)
    v_mfma_f32_32x32x16_bf16 v[160:175], v[24:27], v[208:211], v[160:175]
    ds_read_b64_tr_b16 v[24:25], v0 offset:5152
    ds_read_b64_tr_b16 v[26:27], v0 offset:7712
    s_waitcnt lgkmcnt(6)
    v_mfma_f32_32x32x16_bf16 v[176:191], v[28:31], v[208:211], v[176:191]
    ds_read_b64_tr_b16 v[28:29], v0 offset:5184
    ds_read_b64_tr_b16 v[30:31], v0 offset:7744
    s_waitcnt lgkmcnt(6)
    v_mfma_f32_32x32x16_bf16 v[192:207], v[16:19], v[208:211], v[192:207]
    ds_read_b64_tr_b16 v[16:17], v0 offset:5216
    ds_read_b64_tr_b16 v[18:19], v0 offset:7776
    s_waitcnt vmcnt(6) lgkmcnt(6)
    v_mfma_f32_32x32x16_bf16 v[128:143], v[20:23], v[212:215], v[128:143]
    ds_read_b64_tr_b16 v[20:21], v0 offset:5248
    ds_read_b64_tr_b16 v[22:23], v0 offset:7808
    s_waitcnt lgkmcnt(6)
    v_mfma_f32_32x32x16_bf16 v[144:159], v[24:27], v[212:215], v[144:159]
    ds_read_b64_tr_b16 v[24:25], v0 offset:10240
    ds_read_b64_tr_b16 v[26:27], v0 offset:12800
    s_waitcnt lgkmcnt(6)
    v_mfma_f32_32x32x16_bf16 v[160:175], v[28:31], v[212:215], v[160:175]
    ds_read_b64_tr_b16 v[28:29], v0 offset:10272
    ds_read_b64_tr_b16 v[30:31], v0 offset:12832
    s_waitcnt lgkmcnt(6)
    v_mfma_f32_32x32x16_bf16 v[176:191], v[16:19], v[212:215], v[176:191]
    ds_read_b64_tr_b16 v[16:17], v0 offset:10304
    ds_read_b64_tr_b16 v[18:19], v0 offset:12864
    s_waitcnt lgkmcnt(6)
    v_mfma_f32_32x32x16_bf16 v[192:207], v[20:23], v[212:215], v[192:207]
    ds_read_b64_tr_b16 v[20:21], v0 offset:10336
    ds_read_b64_tr_b16 v[22:23], v0 offset:12896
    s_waitcnt vmcnt(5) lgkmcnt(6)
    v_mfma_f32_32x32x16_bf16 v[128:143], v[24:27], v[216:219], v[128:143]
    ds_read_b64_tr_b16 v[24:25], v0 offset:10368
    ds_read_b64_tr_b16 v[26:27], v0 offset:12928
    s_waitcnt lgkmcnt(6)
    v_mfma_f32_32x32x16_bf16 v[144:159], v[28:31], v[216:219], v[144:159]
    ds_read_b64_tr_b16 v[28:29], v0 offset:15360
    ds_read_b64_tr_b16 v[30:31], v0 offset:17920
    ds_read_b32 v6, v10 offset:108
    s_waitcnt lgkmcnt(7)
    v_mfma_f32_32x32x16_bf16 v[160:175], v[16:19], v[216:219], v[160:175]
    ds_read_b64_tr_b16 v[16:17], v0 offset:15392
    ds_read_b64_tr_b16 v[18:19], v0 offset:17952
    s_waitcnt lgkmcnt(7)
    v_mfma_f32_32x32x16_bf16 v[176:191], v[20:23], v[216:219], v[176:191]
    ds_read_b64_tr_b16 v[20:21], v0 offset:15424
    ds_read_b64_tr_b16 v[22:23], v0 offset:17984
    s_waitcnt lgkmcnt(7)
    v_mfma_f32_32x32x16_bf16 v[192:207], v[24:27], v[216:219], v[192:207]
    ds_read_b64_tr_b16 v[24:25], v0 offset:15456
    ds_read_b64_tr_b16 v[26:27], v0 offset:18016
    s_waitcnt vmcnt(4) lgkmcnt(7)
    v_mfma_f32_32x32x16_bf16 v[128:143], v[28:31], v[220:223], v[128:143]
    ds_read_b64_tr_b16 v[28:29], v0 offset:15488
    ds_read_b64_tr_b16 v[30:31], v0 offset:18048
    s_add_u32 s12, s55, 20
    v_mov_b32 v7, s12
    ds_write_b32 v4, v7 offset:48
    s_waitcnt lgkmcnt(7)
    v_mfma_f32_32x32x16_bf16 v[144:159], v[16:19], v[220:223], v[144:159]
    s_add_u32 s55, s55, 1
    s_cmp_eq_u32 s52, 0
    s_mov_b32 s10, 98304
    s_cselect_b32 s10, 118784, s10
    v_add_u32 v0, s10, v9
    v_readfirstlane_b32 s54, v6
    s_nop 0
    s_cmp_ge_u32 s54, s55
    s_cbranch_scc0 LC107
LC107_ret:
    ds_read_b64_tr_b16 v[16:17], v0 offset:0
    ds_read_b64_tr_b16 v[18:19], v0 offset:2560
    s_waitcnt lgkmcnt(7)
    v_mfma_f32_32x32x16_bf16 v[160:175], v[20:23], v[220:223], v[160:175]
    ds_read_b64_tr_b16 v[20:21], v0 offset:32
    ds_read_b64_tr_b16 v[22:23], v0 offset:2592
    s_waitcnt lgkmcnt(7)
    v_mfma_f32_32x32x16_bf16 v[176:191], v[24:27], v[220:223], v[176:191]
    ds_read_b64_tr_b16 v[24:25], v0 offset:64
    ds_read_b64_tr_b16 v[26:27], v0 offset:2624
    s_waitcnt lgkmcnt(7)
    v_mfma_f32_32x32x16_bf16 v[192:207], v[28:31], v[220:223], v[192:207]
    ds_read_b64_tr_b16 v[28:29], v0 offset:96
    ds_read_b64_tr_b16 v[30:31], v0 offset:2656
    s_waitcnt vmcnt(3) lgkmcnt(6)
    v_mfma_f32_32x32x16_bf16 v[128:143], v[16:19], v[224:227], v[128:143]
    ds_read_b64_tr_b16 v[16:17], v0 offset:128
    ds_read_b64_tr_b16 v[18:19], v0 offset:2688
    s_waitcnt lgkmcnt(6)
    v_mfma_f32_32x32x16_bf16 v[144:159], v[20:23], v[224:227], v[144:159]
    ds_read_b64_tr_b16 v[20:21], v0 offset:5120
    ds_read_b64_tr_b16 v[22:23], v0 offset:7680
    s_waitcnt lgkmcnt(6)
    v_mfma_f32_32x32x16_bf16 v[160:175], v[24:27], v[224:227], v[160:175]
    ds_read_b64_tr_b16 v[24:25], v0 offset:5152
    ds_read_b64_tr_b16 v[26:27], v0 offset:7712
    s_waitcnt lgkmcnt(6)
    v_mfma_f32_32x32x16_bf16 v[176:191], v[28:31], v[224:227], v[176:191]
    ds_read_b64_tr_b16 v[28:29], v0 offset:5184
    ds_read_b64_tr_b16 v[30:31], v0 offset:7744
    s_waitcnt lgkmcnt(6)
    v_mfma_f32_32x32x16_bf16 v[192:207], v[16:19], v[224:227], v[192:207]
    ds_read_b64_tr_b16 v[16:17], v0 offset:5216
    ds_read_b64_tr_b16 v[18:19], v0 offset:7776
    s_waitcnt vmcnt(2) lgkmcnt(6)
    v_mfma_f32_32x32x16_bf16 v[128:143], v[20:23], v[228:231], v[128:143]
    ds_read_b64_tr_b16 v[20:21], v0 offset:5248
    ds_read_b64_tr_b16 v[22:23], v0 offset:7808
    s_waitcnt lgkmcnt(6)
    v_mfma_f32_32x32x16_bf16 v[144:159], v[24:27], v[228:231], v[144:159]
    ds_read_b64_tr_b16 v[24:25], v0 offset:10240
    ds_read_b64_tr_b16 v[26:27], v0 offset:12800
    s_waitcnt lgkmcnt(6)
    v_mfma_f32_32x32x16_bf16 v[160:175], v[28:31], v[228:231], v[160:175]
    ds_read_b64_tr_b16 v[28:29], v0 offset:10272
    ds_read_b64_tr_b16 v[30:31], v0 offset:12832
    s_waitcnt lgkmcnt(6)
    v_mfma_f32_32x32x16_bf16 v[176:191], v[16:19], v[228:231], v[176:191]
    ds_read_b64_tr_b16 v[16:17], v0 offset:10304
    ds_read_b64_tr_b16 v[18:19], v0 offset:12864
    s_waitcnt lgkmcnt(6)
    v_mfma_f32_32x32x16_bf16 v[192:207], v[20:23], v[228:231], v[192:207]
    ds_read_b64_tr_b16 v[20:21], v0 offset:10336
    ds_read_b64_tr_b16 v[22:23], v0 offset:12896
    s_waitcnt vmcnt(1) lgkmcnt(6)
    v_mfma_f32_32x32x16_bf16 v[128:143], v[24:27], v[232:235], v[128:143]
    ds_read_b64_tr_b16 v[24:25], v0 offset:10368
    ds_read_b64_tr_b16 v[26:27], v0 offset:12928
    s_waitcnt lgkmcnt(6)
    v_mfma_f32_32x32x16_bf16 v[144:159], v[28:31], v[232:235], v[144:159]
    ds_read_b64_tr_b16 v[28:29], v0 offset:15360
    ds_read_b64_tr_b16 v[30:31], v0 offset:17920
    s_waitcnt lgkmcnt(6)
    v_mfma_f32_32x32x16_bf16 v[160:175], v[16:19], v[232:235], v[160:175]
    ds_read_b64_tr_b16 v[16:17], v0 offset:15392
    ds_read_b64_tr_b16 v[18:19], v0 offset:17952
    s_waitcnt lgkmcnt(6)
    v_mfma_f32_32x32x16_bf16 v[176:191], v[20:23], v[232:235], v[176:191]
    ds_read_b64_tr_b16 v[20:21], v0 offset:15424
    ds_read_b64_tr_b16 v[22:23], v0 offset:17984
    s_waitcnt lgkmcnt(6)
    v_mfma_f32_32x32x16_bf16 v[192:207], v[24:27], v[232:235], v[192:207]
    ds_read_b64_tr_b16 v[24:25], v0 offset:15456
    ds_read_b64_tr_b16 v[26:27], v0 offset:18016
    s_waitcnt vmcnt(0) lgkmcnt(6)
    v_mfma_f32_32x32x16_bf16 v[128:143], v[28:31], v[236:239], v[128:143]
    ds_read_b64_tr_b16 v[28:29], v0 offset:15488
    ds_read_b64_tr_b16 v[30:31], v0 offset:18048
    s_add_u32 s12, s55, 20
    v_mov_b32 v7, s12
    ds_write_b32 v4, v7 offset:48
    s_waitcnt lgkmcnt(7)
    v_mfma_f32_32x32x16_bf16 v[144:159], v[16:19], v[236:239], v[144:159]
    s_waitcnt lgkmcnt(5)
    v_mfma_f32_32x32x16_bf16 v[160:175], v[20:23], v[236:239], v[160:175]
    s_waitcnt lgkmcnt(3)
    v_mfma_f32_32x32x16_bf16 v[176:191], v[24:27], v[236:239], v[176:191]
    s_waitcnt lgkmcnt(1)
    v_mfma_f32_32x32x16_bf16 v[192:207], v[28:31], v[236:239], v[192:207]
    s_cmp_eq_u32 s52, 1
    s_nop 10
    s_cbranch_scc1 LA_xchg
    s_mov_b32 s52, 1
    s_add_u32 s40, s40, 4
    s_add_u32 s41, s41, 6291456
LP108:
    ds_read_b32 v6, v4 offset:80
    s_waitcnt lgkmcnt(0)
    v_readfirstlane_b32 s12, v6
    s_nop 0
    s_cmp_ge_u32 s12, 9
    s_nop 2
    s_cbranch_scc1 LP108_ok
    s_sleep 2
    s_branch LP108
LP108_ok:
    ds_read_b128 v[32:35], v5 offset:0
    ds_read_b128 v[36:39], v5 offset:1024
    ds_read_b128 v[40:43], v5 offset:2048
    ds_read_b128 v[44:47], v5 offset:3072
    ds_read_b128 v[48:51], v5 offset:4096
    ds_read_b128 v[52:55], v5 offset:5120
    ds_read_b128 v[56:59], v5 offset:6144
    ds_read_b128 v[60:63], v5 offset:7168
    s_waitcnt lgkmcnt(0)
    s_branch LA_part
LA_xchg:
    v_cvt_pk_bf16_f32 v32, v128, v129
    v_cvt_pk_bf16_f32 v33, v130, v131
    v_cvt_pk_bf16_f32 v34, v132, v133
    v_cvt_pk_bf16_f32 v35, v134, v135
    ds_write_b128 v240, v[32:35] offset:0
    v_cvt_pk_bf16_f32 v36, v136, v137
    v_cvt_pk_bf16_f32 v37, v138, v139
    v_cvt_pk_bf16_f32 v38, v140, v141
    v_cvt_pk_bf16_f32 v39, v142, v143
    ds_write_b128 v240, v[36:39] offset:16
    v_cvt_pk_bf16_f32 v40, v144, v145
    v_cvt_pk_bf16_f32 v41, v146, v147
    v_cvt_pk_bf16_f32 v42, v148, v149
    v_cvt_pk_bf16_f32 v43, v150, v151
    ds_write_b128 v240, v[40:43] offset:32
    v_cvt_pk_bf16_f32 v44, v152, v153
    v_cvt_pk_bf16_f32 v45, v154, v155
    v_cvt_pk_bf16_f32 v46, v156, v157
    v_cvt_pk_bf16_f32 v47, v158, v159
    ds_write_b128 v240, v[44:47] offset:48
    v_cvt_pk_bf16_f32 v48, v160, v161
    v_cvt_pk_bf16_f32 v49, v162, v163
    v_cvt_pk_bf16_f32 v50, v164, v165
    v_cvt_pk_bf16_f32 v51, v166, v167
    ds_write_b128 v240, v[48:51] offset:64
    v_cvt_pk_bf16_f32 v52, v168, v169
    v_cvt_pk_bf16_f32 v53, v170, v171
    v_cvt_pk_bf16_f32 v54, v172, v173
    v_cvt_pk_bf16_f32 v55, v174, v175
    ds_write_b128 v240, v[52:55] offset:80
    v_cvt_pk_bf16_f32 v56, v176, v177
    v_cvt_pk_bf16_f32 v57, v178, v179
    v_cvt_pk_bf16_f32 v58, v180, v181
    v_cvt_pk_bf16_f32 v59, v182, v183
    ds_write_b128 v240, v[56:59] offset:96
    v_cvt_pk_bf16_f32 v60, v184, v185
    v_cvt_pk_bf16_f32 v61, v186, v187
    v_cvt_pk_bf16_f32 v62, v188, v189
    v_cvt_pk_bf16_f32 v63, v190, v191
    ds_write_b128 v240, v[60:63] offset:112
    v_cvt_pk_bf16_f32 v64, v192, v193
    v_cvt_pk_bf16_f32 v65, v194, v195
    v_cvt_pk_bf16_f32 v66, v196, v197
    v_cvt_pk_bf16_f32 v67, v198, v199
    ds_write_b128 v240, v[64:67] offset:128
    v_cvt_pk_bf16_f32 v68, v200, v201
    v_cvt_pk_bf16_f32 v69, v202, v203
    v_cvt_pk_bf16_f32 v70, v204, v205
    v_cvt_pk_bf16_f32 v71, v206, v207
    ds_write_b128 v240, v[68:71] offset:144
    s_lshl_b32 s40, s6, 2
    s_add_u32 s40, s40, s93
    s_mul_i32 s40, s40, 3
    s_add_u32 s40, s40, s8
    s_mul_i32 s41, s40, 49152
    s_add_u32 s41, s41, 16777216
    s_lshl_b32 s40, s40, 6
    s_add_u32 s40, s40, 41951232
    s_mul_i32 s42, s92, 3072
    s_add_u32 s12, s92, 1
    s_and_b32 s12, s12, 3
    s_mul_i32 s13, s12, 2560
    v_add_u32 v7, s13, v241
    ds_read_b128 v[92:95], v7 offset:0
    ds_read_b128 v[96:99], v7 offset:1024
    ds_read_b128 v[100:103], v7 offset:2048
    s_add_u32 s12, s92, 2
    s_and_b32 s12, s12, 3
    s_mul_i32 s13, s12, 2560
    v_add_u32 v7, s13, v241
    ds_read_b128 v[104:107], v7 offset:0
    ds_read_b128 v[108:111], v7 offset:1024
    ds_read_b128 v[112:115], v7 offset:2048
    s_add_u32 s12, s92, 3
    s_and_b32 s12, s12, 3
    s_mul_i32 s13, s12, 2560
    v_add_u32 v7, s13, v241
    ds_read_b128 v[116:119], v7 offset:0
    ds_read_b128 v[120:123], v7 offset:1024
    ds_read_b128 v[124:127], v7 offset:2048
    s_add_u32 s12, s92, 0
    s_and_b32 s12, s12, 3
    s_mul_i32 s13, s12, 2560
    v_add_u32 v7, s13, v241
    ds_read_b128 v[80:83], v7 offset:0
    ds_read_b128 v[84:87], v7 offset:1024
    ds_read_b128 v[88:91], v7 offset:2048
    s_add_u32 s12, s92, 1
    s_and_b32 s12, s12, 3
    s_mul_i32 s12, s12, 12288
    s_add_u32 s12, s12, s42
    s_add_u32 s12, s12, s41
    s_waitcnt lgkmcnt(11)
    buffer_store_dwordx4 v[92:95], v13, s[48:51], s12 offen offset:0 sc1
    s_waitcnt lgkmcnt(10)
    buffer_store_dwordx4 v[96:99], v13, s[48:51], s12 offen offset:1024 sc1
    s_mov_b32 exec_hi, 0
    s_waitcnt lgkmcnt(9)
    buffer_store_dwordx4 v[100:103], v13, s[48:51], s12 offen offset:2048 sc1
    s_mov_b64 exec, -1
    s_add_u32 s12, s92, 2
    s_and_b32 s12, s12, 3
    s_mul_i32 s12, s12, 12288
    s_add_u32 s12, s12, s42
    s_add_u32 s12, s12, s41
    s_waitcnt lgkmcnt(8)
    buffer_store_dwordx4 v[104:107], v13, s[48:51], s12 offen offset:0 sc1
    s_waitcnt lgkmcnt(7)
    buffer_store_dwordx4 v[108:111], v13, s[48:51], s12 offen offset:1024 sc1
    s_mov_b32 exec_hi, 0
    s_waitcnt lgkmcnt(6)
    buffer_store_dwordx4 v[112:115], v13, s[48:51], s12 offen offset:2048 sc1
    s_mov_b64 exec, -1
    s_add_u32 s12, s92, 3
    s_and_b32 s12, s12, 3
    s_mul_i32 s12, s12, 12288
    s_add_u32 s12, s12, s42
    s_add_u32 s12, s12, s41
    s_waitcnt lgkmcnt(5)
    buffer_store_dwordx4 v[116:119], v13, s[48:51], s12 offen offset:0 sc1
    s_waitcnt lgkmcnt(4)
    buffer_store_dwordx4 v[120:123], v13, s[48:51], s12 offen offset:1024 sc1
    s_mov_b32 exec_hi, 0
    s_waitcnt lgkmcnt(3)
    buffer_store_dwordx4 v[124:127], v13, s[48:51], s12 offen offset:2048 sc1
    s_mov_b64 exec, -1
    v_lshrrev_b32 v0, 4, v13
    s_mul_i32 s14, s6, 3
    s_add_u32 s14, s14, s8
    s_lshl_b32 s14, s14, 2
    s_add_u32 s14, s14, s92
    s_mul_i32 s14, s14, 10240
    s_mul_i32 s12, s93, 320
    s_add_u32 s14, s14, s12
    v_add_u32 v14, 0, v0
    v_mul_u32_u24 v15, 205, v14
    v_lshrrev_b32 v15, 12, v15
    v_mul_u32_u24 v15, 960, v15
    v_lshl_add_u32 v1, v14, 4, v15
    v_add_u32 v14, 64, v0
    v_mul_u32_u24 v15, 205, v14
    v_lshrrev_b32 v15, 12, v15
    v_mul_u32_u24 v15, 960, v15
    v_lshl_add_u32 v2, v14, 4, v15
    v_add_u32 v14, 128, v0
    v_mul_u32_u24 v15, 205, v14
    v_lshrrev_b32 v15, 12, v15
    v_mul_u32_u24 v15, 960, v15
    v_lshl_add_u32 v3, v14, 4, v15
    s_mov_b32 s44, s26
    s_and_b32 s45, s27, 0xffff
    s_mov_b32 s46, 1966080
    s_mov_b32 s47, 0x20000
    s_lshl_b32 s12, s92, 2
    s_add_u32 s12, s12, s40
    v_lshrrev_b32 v8, 1, v8
    s_waitcnt vmcnt(0) lgkmcnt(0)
    s_mov_b64 exec, 1
    buffer_store_dword v12, off, s[48:51], s12 sc1
    s_mov_b64 exec, -1
    v_lshlrev_b32 v128, 16, v80
    v_and_b32 v129, 0xffff0000, v80
    v_lshlrev_b32 v130, 16, v81
    v_and_b32 v131, 0xffff0000, v81
    v_lshlrev_b32 v132, 16, v82
    v_and_b32 v133, 0xffff0000, v82
    v_lshlrev_b32 v134, 16, v83
    v_and_b32 v135, 0xffff0000, v83
    v_lshlrev_b32 v136, 16, v84
    v_and_b32 v137, 0xffff0000, v84
    v_lshlrev_b32 v138, 16, v85
    v_and_b32 v139, 0xffff0000, v85
    v_lshlrev_b32 v140, 16, v86
    v_and_b32 v141, 0xffff0000, v86
    v_lshlrev_b32 v142, 16, v87
    v_and_b32 v143, 0xffff0000, v87
    v_lshlrev_b32 v144, 16, v88
    v_and_b32 v145, 0xffff0000, v88
    v_lshlrev_b32 v146, 16, v89
    v_and_b32 v147, 0xffff0000, v89
    v_lshlrev_b32 v148, 16, v90
    v_and_b32 v149, 0xffff0000, v90
    v_lshlrev_b32 v150, 16, v91
    v_and_b32 v151, 0xffff0000, v91
    s_nop 1
LA_xf:
    buffer_load_dword v6, v8, s[48:51], s40 offen sc1
    s_add_u32 s53, s53, 1
    s_waitcnt vmcnt(0)
    v_cmp_eq_u32 vcc, v6, v12
    s_nop 0
    s_cmp_eq_u32 vcc_lo, -1
    s_nop 2
    s_cbranch_scc1 LA_xfok
    s_cmp_ge_u32 s53, 131072
    s_cbranch_scc1 LA_xfok
    s_sleep 4
    s_branch LA_xf
LA_xfok:
    s_mul_i32 s42, s92, 12288
    s_add_u32 s42, s42, s41
    s_add_u32 s12, s92, 1
    s_and_b32 s12, s12, 3
    s_mul_i32 s12, s12, 3072
    s_add_u32 s12, s12, s42
    buffer_load_dwordx4 v[92:95], v13, s[48:51], s12 offen offset:0 sc1
    s_add_u32 s12, s92, 2
    s_and_b32 s12, s12, 3
    s_mul_i32 s12, s12, 3072
    s_add_u32 s12, s12, s42
    buffer_load_dwordx4 v[104:107], v13, s[48:51], s12 offen offset:0 sc1
    s_add_u32 s12, s92, 3
    s_and_b32 s12, s12, 3
    s_mul_i32 s12, s12, 3072
    s_add_u32 s12, s12, s42
    buffer_load_dwordx4 v[116:119], v13, s[48:51], s12 offen offset:0 sc1
    s_add_u32 s12, s92, 1
    s_and_b32 s12, s12, 3
    s_mul_i32 s12, s12, 3072
    s_add_u32 s12, s12, s42
    buffer_load_dwordx4 v[96:99], v13, s[48:51], s12 offen offset:1024 sc1
    s_add_u32 s12, s92, 2
    s_and_b32 s12, s12, 3
    s_mul_i32 s12, s12, 3072
    s_add_u32 s12, s12, s42
    buffer_load_dwordx4 v[108:111], v13, s[48:51], s12 offen offset:1024 sc1
    s_add_u32 s12, s92, 3
    s_and_b32 s12, s12, 3
    s_mul_i32 s12, s12, 3072
    s_add_u32 s12, s12, s42
    buffer_load_dwordx4 v[120:123], v13, s[48:51], s12 offen offset:1024 sc1
    s_mov_b32 exec_hi, 0
    s_add_u32 s12, s92, 1
    s_and_b32 s12, s12, 3
    s_mul_i32 s12, s12, 3072
    s_add_u32 s12, s12, s42
    buffer_load_dwordx4 v[100:103], v13, s[48:51], s12 offen offset:2048 sc1
    s_add_u32 s12, s92, 2
    s_and_b32 s12, s12, 3
    s_mul_i32 s12, s12, 3072
    s_add_u32 s12, s12, s42
    buffer_load_dwordx4 v[112:115], v13, s[48:51], s12 offen offset:2048 sc1
    s_add_u32 s12, s92, 3
    s_and_b32 s12, s12, 3
    s_mul_i32 s12, s12, 3072
    s_add_u32 s12, s12, s42
    buffer_load_dwordx4 v[124:127], v13, s[48:51], s12 offen offset:2048 sc1
    s_mov_b64 exec, -1
    s_waitcnt vmcnt(8)
    v_lshlrev_b32 v32, 16, v92
    v_and_b32 v33, 0xffff0000, v92
    v_lshlrev_b32 v34, 16, v93
    v_and_b32 v35, 0xffff0000, v93
    v_lshlrev_b32 v36, 16, v94
    v_and_b32 v37, 0xffff0000, v94
    v_lshlrev_b32 v38, 16, v95
    v_and_b32 v39, 0xffff0000, v95
    v_add_f32 v128, v128, v32
    v_add_f32 v129, v129, v33
    v_add_f32 v130, v130, v34
    v_add_f32 v131, v131, v35
    v_add_f32 v132, v132, v36
    v_add_f32 v133, v133, v37
    v_add_f32 v134, v134, v38
    v_add_f32 v135, v135, v39
    s_waitcnt vmcnt(7)
    v_lshlrev_b32 v32, 16, v104
    v_and_b32 v33, 0xffff0000, v104
    v_lshlrev_b32 v34, 16, v105
    v_and_b32 v35, 0xffff0000, v105
    v_lshlrev_b32 v36, 16, v106
    v_and_b32 v37, 0xffff0000, v106
    v_lshlrev_b32 v38, 16, v107
    v_and_b32 v39, 0xffff0000, v107
    v_add_f32 v128, v128, v32
    v_add_f32 v129, v129, v33
    v_add_f32 v130, v130, v34
    v_add_f32 v131, v131, v35
    v_add_f32 v132, v132, v36
    v_add_f32 v133, v133, v37
    v_add_f32 v134, v134, v38
    v_add_f32 v135, v135, v39
    s_waitcnt vmcnt(6)
    v_lshlrev_b32 v32, 16, v116
    v_and_b32 v33, 0xffff0000, v116
    v_lshlrev_b32 v34, 16, v117
    v_and_b32 v35, 0xffff0000, v117
    v_lshlrev_b32 v36, 16, v118
    v_and_b32 v37, 0xffff0000, v118
    v_lshlrev_b32 v38, 16, v119
    v_and_b32 v39, 0xffff0000, v119
    v_add_f32 v128, v128, v32
    v_add_f32 v129, v129, v33
    v_add_f32 v130, v130, v34
    v_add_f32 v131, v131, v35
    v_add_f32 v132, v132, v36
    v_add_f32 v133, v133, v37
    v_add_f32 v134, v134, v38
    v_add_f32 v135, v135, v39
    v_cvt_pk_bf16_f32 v40, v128, v129
    v_cvt_pk_bf16_f32 v41, v130, v131
    v_cvt_pk_bf16_f32 v42, v132, v133
    v_cvt_pk_bf16_f32 v43, v134, v135
    buffer_store_dwordx4 v[40:43], v1, s[44:47], s14 offen
    s_waitcnt vmcnt(6)
    v_lshlrev_b32 v32, 16, v96
    v_and_b32 v33, 0xffff0000, v96
    v_lshlrev_b32 v34, 16, v97
    v_and_b32 v35, 0xffff0000, v97
    v_lshlrev_b32 v36, 16, v98
    v_and_b32 v37, 0xffff0000, v98
    v_lshlrev_b32 v38, 16, v99
    v_and_b32 v39, 0xffff0000, v99
    v_add_f32 v136, v136, v32
    v_add_f32 v137, v137, v33
    v_add_f32 v138, v138, v34
    v_add_f32 v139, v139, v35
    v_add_f32 v140, v140, v36
    v_add_f32 v141, v141, v37
    v_add_f32 v142, v142, v38
    v_add_f32 v143, v143, v39
    s_waitcnt vmcnt(5)
    v_lshlrev_b32 v32, 16, v108
    v_and_b32 v33, 0xffff0000, v108
    v_lshlrev_b32 v34, 16, v109
    v_and_b32 v35, 0xffff0000, v109
    v_lshlrev_b32 v36, 16, v110
    v_and_b32 v37, 0xffff0000, v110
    v_lshlrev_b32 v38, 16, v111
    v_and_b32 v39, 0xffff0000, v111
    v_add_f32 v136, v136, v32
    v_add_f32 v137, v137, v33
    v_add_f32 v138, v138, v34
    v_add_f32 v139, v139, v35
    v_add_f32 v140, v140, v36
    v_add_f32 v141, v141, v37
    v_add_f32 v142, v142, v38
    v_add_f32 v143, v143, v39
    s_waitcnt vmcnt(4)
    v_lshlrev_b32 v32, 16, v120
    v_and_b32 v33, 0xffff0000, v120
    v_lshlrev_b32 v34, 16, v121
    v_and_b32 v35, 0xffff0000, v121
    v_lshlrev_b32 v36, 16, v122
    v_and_b32 v37, 0xffff0000, v122
    v_lshlrev_b32 v38, 16, v123
    v_and_b32 v39, 0xffff0000, v123
    v_add_f32 v136, v136, v32
    v_add_f32 v137, v137, v33
    v_add_f32 v138, v138, v34
    v_add_f32 v139, v139, v35
    v_add_f32 v140, v140, v36
    v_add_f32 v141, v141, v37
    v_add_f32 v142, v142, v38
    v_add_f32 v143, v143, v39
    v_cvt_pk_bf16_f32 v44, v136, v137
    v_cvt_pk_bf16_f32 v45, v138, v139
    v_cvt_pk_bf16_f32 v46, v140, v141
    v_cvt_pk_bf16_f32 v47, v142, v143
    buffer_store_dwordx4 v[44:47], v2, s[44:47], s14 offen
    s_waitcnt vmcnt(4)
    v_lshlrev_b32 v32, 16, v100
    v_and_b32 v33, 0xffff0000, v100
    v_lshlrev_b32 v34, 16, v101
    v_and_b32 v35, 0xffff0000, v101
    v_lshlrev_b32 v36, 16, v102
    v_and_b32 v37, 0xffff0000, v102
    v_lshlrev_b32 v38, 16, v103
    v_and_b32 v39, 0xffff0000, v103
    v_add_f32 v144, v144, v32
    v_add_f32 v145, v145, v33
    v_add_f32 v146, v146, v34
    v_add_f32 v147, v147, v35
    v_add_f32 v148, v148, v36
    v_add_f32 v149, v149, v37
    v_add_f32 v150, v150, v38
    v_add_f32 v151, v151, v39
    s_waitcnt vmcnt(3)
    v_lshlrev_b32 v32, 16, v112
    v_and_b32 v33, 0xffff0000, v112
    v_lshlrev_b32 v34, 16, v113
    v_and_b32 v35, 0xffff0000, v113
    v_lshlrev_b32 v36, 16, v114
    v_and_b32 v37, 0xffff0000, v114
    v_lshlrev_b32 v38, 16, v115
    v_and_b32 v39, 0xffff0000, v115
    v_add_f32 v144, v144, v32
    v_add_f32 v145, v145, v33
    v_add_f32 v146, v146, v34
    v_add_f32 v147, v147, v35
    v_add_f32 v148, v148, v36
    v_add_f32 v149, v149, v37
    v_add_f32 v150, v150, v38
    v_add_f32 v151, v151, v39
    s_waitcnt vmcnt(2)
    v_lshlrev_b32 v32, 16, v124
    v_and_b32 v33, 0xffff0000, v124
    v_lshlrev_b32 v34, 16, v125
    v_and_b32 v35, 0xffff0000, v125
    v_lshlrev_b32 v36, 16, v126
    v_and_b32 v37, 0xffff0000, v126
    v_lshlrev_b32 v38, 16, v127
    v_and_b32 v39, 0xffff0000, v127
    v_add_f32 v144, v144, v32
    v_add_f32 v145, v145, v33
    v_add_f32 v146, v146, v34
    v_add_f32 v147, v147, v35
    v_add_f32 v148, v148, v36
    v_add_f32 v149, v149, v37
    v_add_f32 v150, v150, v38
    v_add_f32 v151, v151, v39
    v_cvt_pk_bf16_f32 v48, v144, v145
    v_cvt_pk_bf16_f32 v49, v146, v147
    v_cvt_pk_bf16_f32 v50, v148, v149
    v_cvt_pk_bf16_f32 v51, v150, v151
    s_mov_b32 exec_hi, 0
    buffer_store_dwordx4 v[48:51], v3, s[44:47], s14 offen
    s_mov_b64 exec, -1
    s_nop 0
LA_end:
    s_endpgm
LC61:
    s_sleep 1
    ds_read_b32 v6, v10 offset:4
    s_waitcnt lgkmcnt(0)
    v_readfirstlane_b32 s54, v6
    s_nop 3
    s_cmp_ge_u32 s54, 1
    s_cbranch_scc0 LC61
    s_branch LC61_ret
LC62:
    s_sleep 1
    ds_read_b32 v6, v4 offset:80
    s_waitcnt lgkmcnt(0)
    v_readfirstlane_b32 s54, v6
    s_nop 3
    s_cmp_ge_u32 s54, 1
    s_cbranch_scc0 LC62
    s_branch LC62_ret
LC63:
    s_sleep 1
    ds_read_b32 v6, v10 offset:4
    s_waitcnt lgkmcnt(0)
    v_readfirstlane_b32 s54, v6
    s_nop 3
    s_cmp_ge_u32 s54, 2
    s_cbranch_scc0 LC63
    s_branch LC63_ret
LC64:
    s_sleep 1
    ds_read_b32 v15, v4 offset:80
    s_waitcnt lgkmcnt(0)
    v_readfirstlane_b32 s54, v15
    s_nop 3
    s_cmp_ge_u32 s54, 2
    s_cbranch_scc0 LC64
    s_branch LC64_ret
LC65:
    s_sleep 1
    ds_read_b32 v6, v10 offset:4
    s_waitcnt lgkmcnt(0)
    v_readfirstlane_b32 s54, v6
    s_nop 3
    s_cmp_ge_u32 s54, 3
    s_cbranch_scc0 LC65
    s_branch LC65_ret
LC66:
    s_sleep 1
    ds_read_b32 v15, v4 offset:80
    s_waitcnt lgkmcnt(0)
    v_readfirstlane_b32 s54, v15
    s_nop 3
    s_cmp_ge_u32 s54, 3
    s_cbranch_scc0 LC66
    s_branch LC66_ret
LC67:
    s_sleep 1
    ds_read_b32 v6, v10 offset:4
    s_waitcnt lgkmcnt(0)
    v_readfirstlane_b32 s54, v6
    s_nop 3
    s_cmp_ge_u32 s54, 4
    s_cbranch_scc0 LC67
    s_branch LC67_ret
LC68:
    s_sleep 1
    ds_read_b32 v6, v10 offset:4
    s_waitcnt lgkmcnt(0)
    v_readfirstlane_b32 s54, v6
    s_nop 3
    s_cmp_ge_u32 s54, 5
    s_cbranch_scc0 LC68
    s_branch LC68_ret
LC69:
    s_sleep 1
    ds_read_b32 v15, v4 offset:80
    s_waitcnt lgkmcnt(0)
    v_readfirstlane_b32 s54, v15
    s_nop 3
    s_cmp_ge_u32 s54, 4
    s_cbranch_scc0 LC69
    s_branch LC69_ret
LC70:
    s_sleep 1
    ds_read_b32 v6, v10 offset:4
    s_waitcnt lgkmcnt(0)
    v_readfirstlane_b32 s54, v6
    s_nop 3
    s_cmp_ge_u32 s54, 6
    s_cbranch_scc0 LC70
    s_branch LC70_ret
LC71:
    s_sleep 1
    ds_read_b32 v6, v10 offset:4
    s_waitcnt lgkmcnt(0)
    v_readfirstlane_b32 s54, v6
    s_nop 3
    s_cmp_ge_u32 s54, 7
    s_cbranch_scc0 LC71
    s_branch LC71_ret
LC72:
    s_sleep 1
    ds_read_b32 v15, v4 offset:80
    s_waitcnt lgkmcnt(0)
    v_readfirstlane_b32 s54, v15
    s_nop 3
    s_cmp_ge_u32 s54, 5
    s_cbranch_scc0 LC72
    s_branch LC72_ret
LC73:
    s_sleep 1
    ds_read_b32 v6, v10 offset:4
    s_waitcnt lgkmcnt(0)
    v_readfirstlane_b32 s54, v6
    s_nop 3
    s_cmp_ge_u32 s54, 8
    s_cbranch_scc0 LC73
    s_branch LC73_ret
LC74:
    s_sleep 1
    ds_read_b32 v6, v10 offset:4
    s_waitcnt lgkmcnt(0)
    v_readfirstlane_b32 s54, v6
    s_nop 3
    s_cmp_ge_u32 s54, 9
    s_cbranch_scc0 LC74
    s_branch LC74_ret
LC75:
    s_sleep 1
    ds_read_b32 v6, v10 offset:4
    s_waitcnt lgkmcnt(0)
    v_readfirstlane_b32 s54, v6
    s_nop 3
    s_cmp_ge_u32 s54, 10
    s_cbranch_scc0 LC75
    s_branch LC75_ret
LC79:
    s_sleep 1
    ds_read_b32 v6, v10 offset:4
    s_waitcnt lgkmcnt(0)
    v_readfirstlane_b32 s54, v6
    s_nop 3
    s_cmp_ge_u32 s54, 11
    s_cbranch_scc0 LC79
    s_branch LC79_ret
LC80:
    s_sleep 1
    ds_read_b32 v6, v10 offset:4
    s_waitcnt lgkmcnt(0)
    v_readfirstlane_b32 s54, v6
    s_nop 3
    s_cmp_ge_u32 s54, 12
    s_cbranch_scc0 LC80
    s_branch LC80_ret
LC81:
    s_sleep 1
    ds_read_b32 v6, v10 offset:4
    s_waitcnt lgkmcnt(0)
    v_readfirstlane_b32 s54, v6
    s_nop 3
    s_cmp_ge_u32 s54, 13
    s_cbranch_scc0 LC81
    s_branch LC81_ret
LC82:
    s_sleep 1
    ds_read_b32 v6, v10 offset:4
    s_waitcnt lgkmcnt(0)
    v_readfirstlane_b32 s54, v6
    s_nop 3
    s_cmp_ge_u32 s54, 14
    s_cbranch_scc0 LC82
    s_branch LC82_ret
LC83:
    s_sleep 1
    ds_read_b32 v6, v10 offset:4
    s_waitcnt lgkmcnt(0)
    v_readfirstlane_b32 s54, v6
    s_nop 3
    s_cmp_ge_u32 s54, 15
    s_cbranch_scc0 LC83
    s_branch LC83_ret
LC84:
    s_sleep 1
    ds_read_b32 v6, v10 offset:4
    s_waitcnt lgkmcnt(0)
    v_readfirstlane_b32 s54, v6
    s_nop 3
    s_cmp_ge_u32 s54, 16
    s_cbranch_scc0 LC84
    s_branch LC84_ret
LC85:
    s_sleep 1
    ds_read_b32 v6, v10 offset:4
    s_waitcnt lgkmcnt(0)
    v_readfirstlane_b32 s54, v6
    s_nop 3
    s_cmp_ge_u32 s54, 17
    s_cbranch_scc0 LC85
    s_branch LC85_ret
LC86:
    s_sleep 1
    ds_read_b32 v6, v10 offset:4
    s_waitcnt lgkmcnt(0)
    v_readfirstlane_b32 s54, v6
    s_nop 3
    s_cmp_ge_u32 s54, 18
    s_cbranch_scc0 LC86
    s_branch LC86_ret
LC87:
    s_sleep 1
    ds_read_b32 v6, v10 offset:4
    s_waitcnt lgkmcnt(0)
    v_readfirstlane_b32 s54, v6
    s_nop 3
    s_cmp_ge_u32 s54, 19
    s_cbranch_scc0 LC87
    s_branch LC87_ret
LC88:
    s_sleep 1
    ds_read_b32 v6, v10 offset:4
    s_waitcnt lgkmcnt(0)
    v_readfirstlane_b32 s54, v6
    s_nop 3
    s_cmp_ge_u32 s54, 20
    s_cbranch_scc0 LC88
    s_branch LC88_ret
LC89:
    s_sleep 1
    ds_read_b32 v255, v10 offset:0
    s_waitcnt lgkmcnt(0)
    v_readfirstlane_b32 s54, v255
    s_nop 3
    s_cmp_ge_u32 s54, s55
    s_cbranch_scc0 LC89
    s_branch LC89_ret
LC90:
    s_sleep 1
    ds_read_b32 v255, v10 offset:0
    s_waitcnt lgkmcnt(0)
    v_readfirstlane_b32 s54, v255
    s_nop 3
    s_cmp_ge_u32 s54, s55
    s_cbranch_scc0 LC90
    s_branch LC90_ret
LC91:
    s_sleep 1
    ds_read_b32 v255, v10 offset:0
    s_waitcnt lgkmcnt(0)
    v_readfirstlane_b32 s54, v255
    s_nop 3
    s_cmp_ge_u32 s54, s55
    s_cbranch_scc0 LC91
    s_branch LC91_ret
LC92:
    s_sleep 1
    ds_read_b32 v255, v10 offset:0
    s_waitcnt lgkmcnt(0)
    v_readfirstlane_b32 s54, v255
    s_nop 3
    s_cmp_ge_u32 s54, s55
    s_cbranch_scc0 LC92
    s_branch LC92_ret
LC93:
    s_sleep 1
    ds_read_b32 v6, v10 offset:0
    s_waitcnt lgkmcnt(0)
    v_readfirstlane_b32 s54, v6
    s_nop 3
    s_cmp_ge_u32 s54, s55
    s_cbranch_scc0 LC93
    s_branch LC93_ret
LC94:
    s_sleep 1
    ds_read_b32 v6, v10 offset:0
    s_waitcnt lgkmcnt(0)
    v_readfirstlane_b32 s54, v6
    s_nop 3
    s_cmp_ge_u32 s54, s55
    s_cbranch_scc0 LC94
    s_branch LC94_ret
LC95:
    s_sleep 1
    ds_read_b32 v6, v10 offset:0
    s_waitcnt lgkmcnt(0)
    v_readfirstlane_b32 s54, v6
    s_nop 3
    s_cmp_ge_u32 s54, s55
    s_cbranch_scc0 LC95
    s_branch LC95_ret
LC96:
    s_sleep 1
    ds_read_b32 v6, v10 offset:0
    s_waitcnt lgkmcnt(0)
    v_readfirstlane_b32 s54, v6
    s_nop 3
    s_cmp_ge_u32 s54, s55
    s_cbranch_scc0 LC96
    s_branch LC96_ret
LC99:
    s_sleep 1
    ds_read_b32 v6, v10 offset:108
    s_waitcnt lgkmcnt(0)
    v_readfirstlane_b32 s54, v6
    s_nop 3
    s_cmp_ge_u32 s54, s55
    s_cbranch_scc0 LC99
    s_branch LC99_ret
LC100:
    s_sleep 1
    ds_read_b32 v6, v10 offset:108
    s_waitcnt lgkmcnt(0)
    v_readfirstlane_b32 s54, v6
    s_nop 3
    s_cmp_ge_u32 s54, s55
    s_cbranch_scc0 LC100
    s_branch LC100_ret
LC102:
    s_sleep 4
    ds_read_b32 v6, v10 offset:108
    s_waitcnt lgkmcnt(0)
    v_readfirstlane_b32 s54, v6
    s_nop 3
    s_cmp_ge_u32 s54, s55
    s_cbranch_scc0 LC102
    s_branch LC102_ret
LC103:
    s_sleep 4
    ds_read_b32 v6, v10 offset:108
    s_waitcnt lgkmcnt(0)
    v_readfirstlane_b32 s54, v6
    s_nop 3
    s_cmp_ge_u32 s54, s55
    s_cbranch_scc0 LC103
    s_branch LC103_ret
LC104:
    s_sleep 4
    ds_read_b32 v6, v10 offset:108
    s_waitcnt lgkmcnt(0)
    v_readfirstlane_b32 s54, v6
    s_nop 3
    s_cmp_ge_u32 s54, s55
    s_cbranch_scc0 LC104
    s_branch LC104_ret
LC105:
    s_sleep 4
    ds_read_b32 v6, v10 offset:108
    s_waitcnt lgkmcnt(0)
    v_readfirstlane_b32 s54, v6
    s_nop 3
    s_cmp_ge_u32 s54, s55
    s_cbranch_scc0 LC105
    s_branch LC105_ret
LC106:
    s_sleep 4
    ds_read_b32 v6, v10 offset:108
    s_waitcnt lgkmcnt(0)
    v_readfirstlane_b32 s54, v6
    s_nop 3
    s_cmp_ge_u32 s54, s55
    s_cbranch_scc0 LC106
    s_branch LC106_ret
LC107:
    s_sleep 4
    ds_read_b32 v6, v10 offset:108
    s_waitcnt lgkmcnt(0)
    v_readfirstlane_b32 s54, v6
    s_nop 3
    s_cmp_ge_u32 s54, s55
    s_cbranch_scc0 LC107
    s_branch LC107_ret
.section .rodata,"a"
.p2align 6
.amdhsa_kernel standalone__mha_block_cached__near_ridge_kernel
  .amdhsa_next_free_vgpr 256
  .amdhsa_next_free_sgpr 102
  .amdhsa_accum_offset 256
  .amdhsa_group_segment_fixed_size 0
  .amdhsa_kernarg_size 64
  .amdhsa_user_sgpr_count 2
  .amdhsa_user_sgpr_kernarg_segment_ptr 1
  .amdhsa_system_sgpr_workgroup_id_x 1
.end_amdhsa_kernel
```
